```python
import torch

def _softmax(x, axis=-1):
    return torch.softmax(x, dim=axis)
def _gelu(x):
    return torch.nn.functional.gelu(x, approximate="tanh")
def _silu(x):
    return torch.nn.functional.silu(x)
def _sigmoid(x):
    return torch.sigmoid(x)
def _layernorm(x, axis=-1, eps=1e-5):
    m = x.mean(dim=axis, keepdim=True)
    v = x.var(dim=axis, keepdim=True, unbiased=False)
    return (x - m) / torch.sqrt(v + eps)
def _scatter_add(tgt, idx, src, axis=0):
    return tgt.clone().index_add_(axis, idx, src)
def _segment_sum(src, seg, n):
    out = torch.zeros((n,) + src.shape[1:], dtype=src.dtype)
    return out.index_add_(0, seg, src)
def _pad(x, pw):
    flat = tuple(v for pair in reversed(pw) for v in pair)
    return torch.nn.functional.pad(x, flat)

kernel_name = 'gated_mix__sliding_block__dense_activation_silu__prompt'

def setup_inputs():

    _w = (lambda a: (lambda t: t.to(torch.bfloat16) if t.is_floating_point() else t)(torch.as_tensor(a)))
    def _A_setup():
        B, S, D = 1, 2048, 640
        return {
            "x": _w((lambda *s: torch.randn(*s, dtype=torch.bfloat16) * 0.2)(B, S, D)),
            "wqkv": _w((lambda *s: torch.randn(*s, dtype=torch.bfloat16) * 0.2)(D, 3 * D)),
            "wo": _w((lambda *s: torch.randn(*s, dtype=torch.bfloat16) * 0.2)(D, D)),
        }
    _A_in = _A_setup()

    def _B_setup():
        B, S, D, F = 1, 2048, 640, 1536
        return {
            "x": _w((lambda *s: torch.randn(*s, dtype=torch.bfloat16) * 0.2)(B, S, D)),
            "w1": _w((lambda *s: torch.randn(*s, dtype=torch.bfloat16) * 3.2)(D, F) * (D ** -0.5)),
            "w2": _w((lambda *s: torch.randn(*s, dtype=torch.bfloat16) * 3.2)(F, D) * (F ** -0.5)),
        }
    _B_in = _B_setup()

    return {
        "A_x": _A_in["x"],
        "A_wqkv": _A_in["wqkv"],
        "A_wo": _A_in["wo"],
        "B_x": _B_in["x"],
        "B_w1": _B_in["w1"],
        "B_w2": _B_in["w2"],
        "gate_w": _w((lambda *s: torch.randn(*s, dtype=torch.bfloat16) * 0.2)(640) * 16.0),
    }

def reference(A_x, A_wqkv, A_wo, B_x, B_w1, B_w2, gate_w):
    def _A_ref(x, wqkv, wo):
        B, S, D = x.shape
        H = 32; Dh = D // H; W = 256
        qkv = (lambda x, *d: x.permute(*d))((x @ wqkv).reshape(B, S, 3, H, Dh), 2, 0, 3, 1, 4)
        q, k, v = qkv[0], qkv[1], qkv[2]
        scores = torch.einsum("bhqd,bhkd->bhqk", q, k) * (Dh ** -0.5)
        idx = torch.arange(S)
        mask = (idx[:, None] - idx[None, :] >= 0) & (idx[:, None] - idx[None, :] < W)
        scores = torch.where(mask[None, None], scores, -1e9)
        p = _softmax(scores, axis=-1)
        o = torch.einsum("bhqk,bhkd->bhqd", p, v)
        return (lambda x, *d: x.permute(*d))(o, 0, 2, 1, 3).reshape(B, S, D) @ wo

    def _B_ref(x, w1, w2):
        h = torch.einsum("bsd,df->bsf", x, w1)
        h = _silu(h)
        out = torch.einsum("bsf,fd->bsd", h, w2)
        return out

    x = A_x
    g = _sigmoid((x * gate_w).sum(-1, keepdims=True))
    a = _A_ref(x, A_wqkv, A_wo)
    b = _B_ref(x, B_w1, B_w2)
    return g * a + (1 - g) * b
```

```asm
; @launch grid=(256,1,1) block=(256,1,1) lds=163840
.amdgcn_target "amdgcn-amd-amdhsa--gfx950"
.text
.globl gated_mix__sliding_block__dense_activation_silu__prompt_kernel
.p2align 8
.type gated_mix__sliding_block__dense_activation_silu__prompt_kernel,@function
gated_mix__sliding_block__dense_activation_silu__prompt_kernel:
L_CODE_BEG:
  s_load_dwordx16 s[16:31], s[0:1], 0
  s_load_dwordx4 s[32:35], s[0:1], 64
  s_cmpk_ge_u32 s2, 256
  s_cbranch_scc1 L_END
  v_lshrrev_b32 v2, 6, v0
  v_and_b32 v1, 63, v0
  v_readfirstlane_b32 s3, v2
  s_getpc_b64 s[68:69]
L_PCe:
  s_sub_u32 s70, s68, L_PCe-L_CODE_BEG
  s_subb_u32 s71, s69, 0
  s_lshr_b32 s68, s2, 3
  s_lshl_b32 s68, s68, 11
  v_lshrrev_b32 v63, 4, v0
  v_lshl_add_u32 v63, v63, 7, s68
  v_min_u32 v63, L_CODE_END-L_CODE_BEG-4, v63
  global_load_dword v253, v63, s[70:71]
  s_lshr_b32 s7, s2, 3
  s_and_b32 s74, s7, 7
  s_lshr_b32 s11, s2, 6
  s_and_b32 s15, s2, 1
  s_lshr_b32 s9, s2, 1
  s_lshl3_add_u32 s4, s15, s74
  s_add_u32 s7, s7, s11
  s_and_b32 s7, s7, 3
  s_xor_b32 s6, s2, s9
  s_and_b32 s12, s6, 1
  s_mul_i32 s6, s12, 4
  s_add_u32 s64, s6, s7
  s_lshl_b32 s8, s3, 12
  s_lshl2_add_u32 s6, s4, s3
  s_lshl_b32 s6, s6, 5
  v_lshrrev_b32 v60, 3, v1
  v_lshrrev_b32 v62, 4, v1
  v_xor_b32 v61, v1, v62
  v_and_b32 v61, 7, v61
  v_add_u32 v60, s6, v60
  v_mul_u32_u24 v60, 1280, v60
  v_lshl_add_u32 v4, v61, 4, v60
  s_movk_i32 s6, 9216
  v_xor_b32 v5, 64, v4
  v_add_u32 v5, s6, v5
  s_movk_i32 s6, 18432
  v_add_u32 v6, s6, v4
  v_add_u32 v7, s6, v5
  s_mov_b32 s38, 2621440
  s_mov_b32 s39, 0x20000
  s_add_u32 m0, s8, 65536
  s_lshl_b32 s10, s64, 7
  s_waitcnt lgkmcnt(0)
  s_mov_b64 s[36:37], s[16:17]
  buffer_load_dwordx4 v4, s[36:39], s10 offen offset:0 lds
  buffer_load_dwordx4 v5, s[36:39], s10 offen offset:1024 lds
  buffer_load_dwordx4 v6, s[36:39], s10 offen offset:2048 lds
  buffer_load_dwordx4 v7, s[36:39], s10 offen offset:3072 lds
  s_and_b32 s9, s9, 3
  s_lshl2_add_u32 s5, s9, s11
  s_lshl3_add_u32 s14, s9, s74
  s_lshl2_add_u32 s15, s15, s11
  s_lshl_b32 s7, s7, 2
  s_lshl4_add_u32 s73, s12, s7
  s_mul_i32 s6, s3, 240
  s_add_u32 s6, s6, s5
  v_mad_u32_u24 v60, v62, 15, s6
  v_lshlrev_b32 v61, 1, v62
  v_xor_b32 v61, v1, v61
  v_and_b32 v61, 15, v61
  v_lshlrev_b32 v61, 4, v61
  v_lshl_add_u32 v8, v60, 8, v61
  s_movk_i32 s6, 14336
  v_add_u32 v9, s6, v8
  v_add_u32 v10, s6, v9
  v_xor_b32 v10, 128, v10
  v_add_u32 v11, s6, v10
  s_mov_b32 s42, 2457600
  s_mov_b32 s43, s39
  s_mov_b64 s[40:41], s[18:19]
  s_cmp_eq_u32 s5, 15
  s_cbranch_scc1 L_GATE
  s_add_u32 m0, s8, 0
  s_mul_i32 s10, s64, 245760
  buffer_load_dwordx4 v8, s[40:43], s10 offen offset:0 lds
  buffer_load_dwordx4 v9, s[40:43], s10 offen offset:1024 lds
  buffer_load_dwordx4 v10, s[40:43], s10 offen offset:2048 lds
  buffer_load_dwordx4 v11, s[40:43], s10 offen offset:3072 lds
  v_and_b32 v2, 31, v1
  v_lshrrev_b32 v3, 5, v1
  s_mul_i32 s9, s3, 3072
  s_bfe_u32 s12, s2, 0x40003
  s_lshr_b32 s7, s2, 7
  s_and_b32 s6, s2, 7
  s_lshl1_add_u32 s13, s6, s7
  s_lshr_b32 s6, s3, 1
  s_lshl_b32 s6, s6, 5
  s_add_u32 s75, s14, s6
  s_mov_b32 s7, 819200
  s_mov_b32 s59, 0x20000
  s_cmp_lt_u32 s75, 48
  s_cselect_b32 s58, 1966080, s7
  s_cselect_b32 s56, s26, s20
  s_cselect_b32 s57, s27, s21
  s_cmp_lt_u32 s75, 48
  s_cselect_b32 s6, 0, 48
  s_sub_u32 s6, s75, s6
  s_and_b32 s74, s3, 1
  s_lshl1_add_u32 s6, s6, s74
  s_mul_i32 s6, s6, 20480
  s_mul_i32 s7, s15, 160
  s_add_u32 s6, s6, s7
  v_add_u32 v60, 0, v1
  v_mul_u32_u24 v60, 6554, v60
  v_lshrrev_b32 v60, 16, v60
  v_mul_u32_u24 v60, 1120, v60
  v_lshl_add_u32 v60, v1, 4, v60
  v_add_u32 v240, s6, v60
  v_add_u32 v60, 64, v1
  v_mul_u32_u24 v60, 6554, v60
  v_lshrrev_b32 v60, 16, v60
  v_mul_u32_u24 v60, 1120, v60
  v_lshl_add_u32 v60, v1, 4, v60
  v_add_u32 v241, s6, v60
  v_add_u32 v60, 128, v1
  v_mul_u32_u24 v60, 6554, v60
  v_lshrrev_b32 v60, 16, v60
  v_mul_u32_u24 v60, 1120, v60
  v_lshl_add_u32 v60, v1, 4, v60
  v_add_u32 v242, s6, v60
  v_lshl_add_u32 v242, v3, 30, v242
  s_add_u32 s6, s9, 143360
  v_bfe_u32 v60, v1, 4, 1
  v_bfe_u32 v61, v1, 2, 2
  v_lshl_add_u32 v60, v60, 3, v61
  v_mul_u32_u24 v60, 160, v60
  v_add_u32 v60, s6, v60
  v_and_b32 v61, 3, v1
  v_lshl_add_u32 v244, v61, 3, v60
  v_lshl_add_u32 v60, v3, 3, v60
  v_lshl_add_u32 v243, v61, 4, v60
  s_and_b32 s6, s15, 1
  s_lshl_b32 s7, s6, 5
  v_add_u32 v243, s7, v243
  s_xor_b32 s6, s6, 1
  s_lshl_b32 s7, s6, 7
  v_add_u32 v244, s7, v244
  s_mul_i32 s6, s15, 348160
  s_mul_i32 s7, s75, 5120
  s_add_u32 s6, s6, s7
  s_lshl_b32 s7, s74, 9
  s_add_u32 s6, s6, s7
  s_add_u32 s6, s6, 17825792
  v_lshl_add_u32 v60, v2, 4, s6
  v_lshl_add_u32 v245, v3, 10, v60
  v_lshl_add_u32 v60, v3, 30, v60
  v_add_u32 v246, 4096, v60
  s_lshl1_add_u32 s7, s75, s74
  s_lshl_b32 s6, s15, 13
  s_lshl2_add_u32 s6, s7, s6
  s_add_u32 s6, s6, 22806528
  v_lshl_add_u32 v247, v1, 25, s6
  s_mov_b32 s48, s34
  s_mov_b32 s49, s35
  s_mov_b32 s50, 24117248
  s_mov_b32 s51, 0x20000
  s_mov_b32 s60, s32
  s_mov_b32 s61, s33
  s_mov_b32 s62, 256
  s_mov_b32 s63, 0x20000
  v_lshlrev_b32 v29, 25, v1
  v_mov_b32 v30, 1
  s_lshr_b32 s6, 1198064421, s73
  s_and_b32 s65, s6, 15
  s_lshr_b32 s6, 1409618017, s73
  s_and_b32 s66, s6, 15
  s_lshr_b32 s6, 1635133234, s73
  s_and_b32 s67, s6, 15
  s_lshr_b32 s6, 2235711752, s73
  s_and_b32 s68, s6, 15
  s_lshr_b32 s6, 2568443251, s73
  s_and_b32 s69, s6, 15
  s_lshr_b32 s6, 36726934, s73
  s_and_b32 s70, s6, 15
  s_lshr_b32 s6, 679576647, s73
  s_and_b32 s71, s6, 15
  s_lshr_b32 s6, 278427220, s73
  s_and_b32 s72, s6, 15
  s_lshr_b32 s6, 857971081, s73
  s_and_b32 s73, s6, 15
  s_mov_b32 s44, s24
  s_mov_b32 s45, s25
  s_mov_b32 s46, 1966080
  s_mov_b32 s47, 0x20000
  s_mov_b32 s52, s30
  s_mov_b32 s53, s31
  s_mov_b32 s54, 2621440
  s_mov_b32 s55, 0x20000
  v_lshlrev_b32 v59, 4, v1
  s_mul_i32 s6, s15, 348160
  s_add_u32 s6, s6, 17825792
  v_add_u32 v31, s6, v59
  v_add_u32 v32, 4096, v31
  v_and_b32 v61, 15, v1
  v_lshrrev_b32 v60, 1, v61
  v_lshrrev_b32 v62, 4, v1
  v_xor_b32 v60, v60, v62
  v_lshlrev_b32 v60, 4, v60
  v_lshl_add_u32 v60, v61, 7, v60
  s_add_u32 s6, s8, 65536
  v_add_u32 v24, s6, v60
  v_xor_b32 v25, 64, v24
  v_bfe_u32 v60, v1, 2, 2
  v_lshrrev_b32 v61, 4, v1
  v_lshl_add_u32 v61, v61, 3, v60
  v_and_b32 v62, 3, v1
  v_lshlrev_b32 v62, 3, v62
  v_bfe_u32 v60, v1, 2, 3
  v_lshl_add_u32 v63, v61, 8, v62
  v_lshl_add_u32 v16, v60, 5, v63
  s_and_b32 s6, s3, 1
  s_lshl_b32 s6, s6, 7
  v_xor_b32 v16, s6, v16
  v_xor_b32 v20, 0x1000, v24
  v_xor_b32 v21, 0x1000, v25
  v_xor_b32 v17, 32, v16
  v_xor_b32 v18, 64, v16
  v_xor_b32 v19, 96, v16
  v_mul_u32_u24 v63, 192, v61
  v_add_u32 v63, v63, v62
  v_bfe_u32 v60, v1, 4, 1
  v_lshl_add_u32 v40, v60, 5, v63
  v_xor_b32 v41, 32, v40
  v_add_u32 v42, 65536, v40
  v_add_u32 v43, 65536, v41
  v_add_u32 v44, 131072, v40
  v_add_u32 v45, 131072, v41
  s_mul_i32 s6, s3, 49152
  s_mul_i32 s7, s5, 192
  s_add_u32 s6, s6, s7
  s_sub_u32 s6, s6, 0
  v_add_u32 v60, 0, v1
  v_mul_u32_u24 v61, 43691, v60
  v_lshrrev_b32 v61, 19, v61
  v_lshrrev_b32 v62, 2, v61
  v_and_b32 v62, 2, v62
  v_xor_b32 v60, v60, v62
  v_mul_u32_u24 v61, 2880, v61
  v_lshl_add_u32 v60, v60, 4, v61
  v_add_u32 v12, s6, v60
  s_mul_i32 s6, s3, 49152
  s_mul_i32 s7, s5, 192
  s_add_u32 s6, s6, s7
  s_sub_u32 s6, s6, 1024
  v_add_u32 v60, 64, v1
  v_mul_u32_u24 v61, 43691, v60
  v_lshrrev_b32 v61, 19, v61
  v_lshrrev_b32 v62, 2, v61
  v_and_b32 v62, 2, v62
  v_xor_b32 v60, v60, v62
  v_mul_u32_u24 v61, 2880, v61
  v_lshl_add_u32 v60, v60, 4, v61
  v_add_u32 v13, s6, v60
  s_mul_i32 s6, s3, 49152
  s_mul_i32 s7, s5, 192
  s_add_u32 s6, s6, s7
  s_sub_u32 s6, s6, 2048
  v_add_u32 v60, 128, v1
  v_mul_u32_u24 v61, 43691, v60
  v_lshrrev_b32 v61, 19, v61
  v_lshrrev_b32 v62, 2, v61
  v_and_b32 v62, 2, v62
  v_xor_b32 v60, v60, v62
  v_mul_u32_u24 v61, 2880, v61
  v_lshl_add_u32 v60, v60, 4, v61
  v_add_u32 v14, s6, v60
  v_lshlrev_b32 v60, 4, v2
  v_lshl_add_u32 v38, v3, 10, v60
  v_lshl_add_u32 v39, v3, 30, v60
  s_lshr_b32 s7, s3, 1
  s_lshl1_add_u32 s6, s4, s7
  s_mul_i32 s6, s6, 245760
  s_lshl_b32 s7, s5, 14
  s_add_u32 s6, s6, s7
  s_and_b32 s7, s3, 1
  s_mul_i32 s7, s7, 8704
  s_add_u32 s6, s6, s7
  s_cmp_eq_u32 s5, 15
  s_cselect_b32 s6, 2146435072, s6
  v_bfe_u32 v60, v1, 4, 1
  v_lshl_add_u32 v60, v60, 1, v3
  v_and_b32 v61, 15, v1
  v_lshlrev_b32 v61, 4, v61
  v_lshl_add_u32 v62, v60, 10, v61
  v_add_u32 v27, s6, v62
  v_lshl_add_u32 v28, v60, 8, v61
  v_xor_b32 v26, 0x200, v27
  v_lshrrev_b32 v60, 4, v2
  v_mul_u32_u24 v60, 71680, v60
  v_and_b32 v61, 15, v2
  v_lshl_add_u32 v60, v61, 4, v60
  v_lshl_add_u32 v61, v3, 8, v60
  v_lshl_add_u32 v60, v3, 30, v60
  s_lshl_b32 s7, s3, 1
  s_lshl3_add_u32 s6, s4, s7
  s_mul_i32 s6, s6, 71680
  s_mul_i32 s74, s5, 3072
  s_add_u32 s6, s6, s74
  s_add_u32 s6, s6, 8388608
  v_add_u32 v28, s6, v28
  s_lshl3_add_u32 s6, s12, s7
  s_mul_i32 s6, s6, 71680
  s_mul_i32 s7, s13, 1280
  s_add_u32 s6, s6, s7
  s_add_u32 s6, s6, 8437760
  v_add_u32 v54, s6, v61
  v_add_u32 v55, s6, v60
  s_movk_i32 s30, 4096
  s_movk_i32 s31, 8192
  s_movk_i32 s32, 12288
  s_cmp_lt_u32 s5, 5
  s_cselect_b32 s28, 0x3ea52b5c, 1.0
  s_mov_b32 s29, 71680
  s_and_b32 s6, s14, 0
  s_mul_i32 s7, s3, 12
  s_cmp_eq_u32 s6, 0
  s_cselect_b32 s16, 0, 6
  s_cselect_b32 s17, 1, 7
  s_cselect_b32 s18, 2, 8
  s_cselect_b32 s19, 3, 9
  s_cselect_b32 s20, 4, 10
  s_cselect_b32 s21, 5, 11
  s_cselect_b32 s22, 6, 0
  s_cselect_b32 s23, 7, 1
  s_cselect_b32 s24, 8, 2
  s_cselect_b32 s25, 9, 3
  s_cselect_b32 s26, 10, 4
  s_cselect_b32 s27, 11, 5
  s_add_u32 s16, s16, s7
  s_add_u32 s17, s17, s7
  s_add_u32 s18, s18, s7
  s_add_u32 s19, s19, s7
  s_add_u32 s20, s20, s7
  s_add_u32 s21, s21, s7
  s_add_u32 s22, s22, s7
  s_add_u32 s23, s23, s7
  s_add_u32 s24, s24, s7
  s_add_u32 s25, s25, s7
  s_add_u32 s26, s26, s7
  s_add_u32 s27, s27, s7
  s_lshl4_add_u32 s6, s4, s5
  s_lshl_b32 s6, s6, 10
  s_add_u32 s35, s6, 22020096
  s_lshl4_add_u32 s6, s12, s13
  s_lshl_b32 s6, s6, 10
  s_add_u32 s75, s6, 22544384
  s_add_u32 m0, s8, 81920
  s_mul_i32 s10, s65, 128
  buffer_load_dwordx4 v4, s[36:39], s10 offen offset:0 lds
  s_and_b32 s6, s3, 1
  s_lshr_b32 s7, s3, 1
  s_mul_i32 s33, s7, 31232
  s_lshl_b32 s74, s6, 10
  s_add_u32 s33, s33, s74
  s_lshl1_add_u32 s6, s12, s6
  s_sub_u32 s6, s6, 4
  s_mul_i32 s7, s7, 80
  s_mul_i32 s74, s13, 5
  s_add_u32 s7, s7, s74
  s_add_u32 s7, s7, 80
  s_lshl_b32 s7, s7, 10
  s_mul_i32 s74, s6, 245760
  s_add_u32 s74, s74, s7
  s_cmp_lt_i32 s6, 0
  s_cselect_b32 s74, 2146435072, s74
  v_add_u32 v35, s74, v59
  s_add_u32 s6, s6, 2
  s_mul_i32 s74, s6, 245760
  s_add_u32 s74, s74, s7
  s_cmp_lt_i32 s6, 0
  s_cselect_b32 s74, 2146435072, s74
  v_add_u32 v36, s74, v59
  s_add_u32 s6, s6, 2
  s_mul_i32 s74, s6, 245760
  s_add_u32 s74, s74, s7
  s_cmp_lt_i32 s6, 0
  s_cselect_b32 s74, 2146435072, s74
  v_add_u32 v37, s74, v59
  s_add_u32 s6, s6, 2
  s_lshr_b32 s7, s3, 1
  s_lshl1_add_u32 s6, s12, s7
  s_mul_i32 s6, s6, 245760
  s_mul_i32 s7, s13, 5120
  s_add_u32 s6, s6, s7
  s_and_b32 s7, s3, 1
  s_lshl_b32 s7, s7, 9
  s_add_u32 s34, s6, s7
  buffer_load_dwordx4 v5, s[36:39], s10 offen offset:1024 lds
  v_lshlrev_b32 v60, 4, v2
  v_mul_u32_u24 v61, 6208, v3
  v_add_u32 v61, v60, v61
  v_add_u32 v62, 18688, v61
  v_add_u32 v60, 12416, v60
  v_accvgpr_write_b32 a240, v61
  v_accvgpr_write_b32 a241, v62
  v_accvgpr_write_b32 a242, v60
  buffer_load_dwordx4 v6, s[36:39], s10 offen offset:2048 lds
  v_bfe_u32 v60, v1, 2, 2
  v_lshl_add_u32 v60, v3, 2, v60
  v_lshlrev_b32 v60, 4, v60
  v_add_u32 v60, 31232, v60
  v_and_b32 v61, 1, v1
  v_mul_u32_u24 v61, 6208, v61
  v_bfe_u32 v62, v1, 1, 1
  v_lshl_add_u32 v61, v62, 3, v61
  v_and_b32 v62, 3, v1
  v_cmp_eq_u32 vcc, 0, v62
  v_mov_b32 v63, 31168
  v_mov_b32 v254, 12416
  v_mov_b32 v255, 12424
  v_cndmask_b32 v254, v63, v254, vcc
  v_cndmask_b32 v255, v63, v255, vcc
  v_and_b32 v62, 16, v1
  v_cmp_eq_u32 vcc, 0, v62
  v_add_u32 v63, 18688, v61
  s_nop 0
  v_cndmask_b32 v254, v254, v61, vcc
  v_cndmask_b32 v255, v255, v63, vcc
  v_add_u32 v254, v60, v254
  v_add_u32 v255, v60, v255
  v_accvgpr_write_b32 a243, v254
  v_accvgpr_write_b32 a244, v255
  s_add_u32 s6, s3, 0
  s_and_b32 s6, s6, 3
  s_lshl2_add_u32 s7, s14, s6
  s_mul_i32 s7, s7, 71680
  s_add_u32 s7, s7, 8388608
  v_add_u32 v60, s7, v59
  s_mul_i32 s6, s6, 15360
  s_add_u32 s6, s6, 20480
  v_lshl_add_u32 v61, v1, 4, s6
  v_accvgpr_write_b32 a248, v60
  v_accvgpr_write_b32 a247, v61
  buffer_load_dwordx4 v7, s[36:39], s10 offen offset:3072 lds
  s_add_u32 s6, s3, 1
  s_and_b32 s6, s6, 3
  s_lshl2_add_u32 s7, s14, s6
  s_mul_i32 s7, s7, 71680
  s_add_u32 s7, s7, 8388608
  v_add_u32 v60, s7, v59
  s_mul_i32 s6, s6, 15360
  s_add_u32 s6, s6, 20480
  v_lshl_add_u32 v61, v1, 4, s6
  v_accvgpr_write_b32 a249, v60
  v_accvgpr_write_b32 a252, v61
  s_add_u32 m0, s8, 16384
  s_mul_i32 s10, s65, 245760
  buffer_load_dwordx4 v8, s[40:43], s10 offen offset:0 lds
  s_add_u32 s6, s3, 2
  s_and_b32 s6, s6, 3
  s_lshl2_add_u32 s7, s14, s6
  s_mul_i32 s7, s7, 71680
  s_add_u32 s7, s7, 8388608
  v_add_u32 v60, s7, v59
  s_mul_i32 s6, s6, 15360
  s_add_u32 s6, s6, 25600
  v_lshl_add_u32 v61, v1, 4, s6
  v_accvgpr_write_b32 a250, v60
  v_accvgpr_write_b32 a253, v61
  s_add_u32 s6, s3, 3
  s_and_b32 s6, s6, 3
  s_lshl2_add_u32 s7, s14, s6
  s_mul_i32 s7, s7, 71680
  s_add_u32 s7, s7, 8388608
  v_add_u32 v60, s7, v59
  s_mul_i32 s6, s6, 15360
  s_add_u32 s6, s6, 30720
  v_lshl_add_u32 v61, v1, 4, s6
  v_accvgpr_write_b32 a251, v60
  v_accvgpr_write_b32 a254, v61
  buffer_load_dwordx4 v9, s[40:43], s10 offen offset:1024 lds
  s_lshl2_add_u32 s6, s14, s3
  s_mul_i32 s6, s6, 20480
  s_mul_i32 s7, s15, 160
  s_add_u32 s6, s6, s7
  v_and_b32 v60, 15, v1
  v_mul_u32_u24 v60, 1280, v60
  v_add_u32 v60, s6, v60
  v_lshrrev_b32 v61, 4, v1
  v_lshl_add_u32 v62, v61, 4, v60
  v_lshl_add_u32 v61, v61, 3, v60
  s_and_b32 s6, s15, 1
  s_lshl_b32 s7, s6, 5
  v_add_u32 v62, s7, v62
  s_xor_b32 s6, s6, 1
  s_lshl_b32 s7, s6, 7
  v_add_u32 v61, s7, v61
  v_accvgpr_write_b32 a245, v62
  v_accvgpr_write_b32 a246, v61
  buffer_load_dwordx4 v10, s[40:43], s10 offen offset:2048 lds
  s_mul_i32 s6, s3, 24
  v_add_u32 v61, s6, v1
  v_add_u32 v60, 72, v1
  v_cmp_gt_u32 vcc, 24, v1
  s_lshl_b32 s6, s15, 13
  s_add_u32 s6, s6, 22806528
  v_cndmask_b32 v60, v60, v61, vcc
  v_lshl_add_u32 v33, v60, 2, s6
  s_mul_i32 s6, s13, 40
  s_lshr_b32 s7, s3, 1
  s_mul_i32 s7, s7, 5
  s_add_u32 s7, s7, 5
  v_and_b32 v60, 1, v1
  v_mul_u32_u24 v60, 39, v60
  v_add_u32 v60, s6, v60
  v_lshrrev_b32 v60, 7, v60
  v_add_u32 v61, s7, v60
  v_cmp_gt_u32 vcc, 6, v1
  v_lshrrev_b32 v62, 1, v1
  v_min_u32 v62, 2, v62
  v_cndmask_b32 v60, v60, v61, vcc
  s_sub_u32 s6, s12, 2
  v_add_u32 v62, s6, v62
  v_max_i32 v62, 0, v62
  v_lshl_add_u32 v60, v62, 4, v60
  v_lshlrev_b32 v60, 10, v60
  v_add_u32 v34, 22020096, v60
  buffer_load_dwordx4 v11, s[40:43], s10 offen offset:3072 lds
  s_lshr_b32 s6, s14, 1
  s_lshl_b32 s6, s6, 14
  s_lshl_b32 s7, s3, 12
  s_add_u32 s7, s7, s6
  s_add_u32 s7, s7, 22282240
  v_lshl_add_u32 v61, v1, 10, s7
  s_add_u32 s7, s6, 22035456
  v_mov_b32 v60, s7
  v_cmp_gt_u32 vcc, 4, v1
  s_add_u32 s6, s6, 22544384
  v_and_b32 v62, 15, v1
  v_cndmask_b32 v57, v60, v61, vcc
  v_lshl_add_u32 v58, v62, 10, s6
  s_lshl_b32 s6, s12, 14
  s_add_u32 s6, s6, 22035456
  v_cmp_gt_u32 vcc, 5, v1
  v_mov_b32 v60, s6
  s_nop 0
  v_cndmask_b32 v57, v60, v57, vcc
  s_waitcnt vmcnt(8)
  s_barrier
  ds_read_b128 a[0:3], v24 offset:0
  ds_read_b64_tr_b16 v[176:177], v16 offset:0
  ds_read_b64_tr_b16 v[178:179], v16 offset:1024
  ds_read_b128 a[4:7], v24 offset:2048
  ds_read_b128 v[128:131], v20 offset:0
  ds_read_b128 v[132:135], v20 offset:2048
  ds_read_b64_tr_b16 v[180:181], v17 offset:0
  ds_read_b64_tr_b16 v[182:183], v17 offset:1024
  s_waitcnt lgkmcnt(5)
  v_mfma_f32_16x16x32_bf16 v[64:67], v[176:179], a[0:3], 0
  s_waitcnt lgkmcnt(4)
  s_add_u32 m0, s8, 98304
  s_mul_i32 s10, s66, 128
  buffer_load_dwordx4 v4, s[36:39], s10 offen offset:0 lds
  ds_read_b64_tr_b16 v[184:185], v18 offset:0
  v_mfma_f32_16x16x32_bf16 v[68:71], v[176:179], a[4:7], 0
  s_waitcnt lgkmcnt(4)
  ds_read_b64_tr_b16 v[186:187], v18 offset:1024
  v_mfma_f32_16x16x32_bf16 v[72:75], v[176:179], v[128:131], 0
  s_waitcnt lgkmcnt(4)
  buffer_load_dwordx4 v5, s[36:39], s10 offen offset:1024 lds
  v_mfma_f32_16x16x32_bf16 v[76:79], v[176:179], v[132:135], 0
  s_waitcnt lgkmcnt(2)
  v_mfma_f32_16x16x32_bf16 v[92:95], v[180:183], v[132:135], 0
  buffer_load_dwordx4 v6, s[36:39], s10 offen offset:2048 lds
  ds_read_b64_tr_b16 v[188:189], v19 offset:0
  v_mfma_f32_16x16x32_bf16 v[88:91], v[180:183], v[128:131], 0
  ds_read_b64_tr_b16 v[190:191], v19 offset:1024
  v_mfma_f32_16x16x32_bf16 v[84:87], v[180:183], a[4:7], 0
  buffer_load_dwordx4 v7, s[36:39], s10 offen offset:3072 lds
  v_mfma_f32_16x16x32_bf16 v[80:83], v[180:183], a[0:3], 0
  s_waitcnt lgkmcnt(2)
  v_mfma_f32_16x16x32_bf16 v[96:99], v[184:187], a[0:3], 0
  s_add_u32 m0, s8, 32768
  s_mul_i32 s10, s66, 245760
  buffer_load_dwordx4 v8, s[40:43], s10 offen offset:0 lds
  ds_read_b64_tr_b16 v[192:193], v16 offset:8192
  v_mfma_f32_16x16x32_bf16 v[100:103], v[184:187], a[4:7], 0
  ds_read_b64_tr_b16 v[194:195], v16 offset:9216
  v_mfma_f32_16x16x32_bf16 v[104:107], v[184:187], v[128:131], 0
  buffer_load_dwordx4 v9, s[40:43], s10 offen offset:1024 lds
  ds_read_b128 a[8:11], v25 offset:0
  v_mfma_f32_16x16x32_bf16 v[108:111], v[184:187], v[132:135], 0
  s_waitcnt lgkmcnt(3)
  ds_read_b128 a[12:15], v25 offset:2048
  v_mfma_f32_16x16x32_bf16 v[124:127], v[188:191], v[132:135], 0
  buffer_load_dwordx4 v10, s[40:43], s10 offen offset:2048 lds
  ds_read_b64_tr_b16 v[196:197], v17 offset:8192
  v_mfma_f32_16x16x32_bf16 v[120:123], v[188:191], v[128:131], 0
  ds_read_b64_tr_b16 v[198:199], v17 offset:9216
  v_mfma_f32_16x16x32_bf16 v[116:119], v[188:191], a[4:7], 0
  buffer_load_dwordx4 v11, s[40:43], s10 offen offset:3072 lds
  ds_read_b128 v[136:139], v21 offset:0
  v_mfma_f32_16x16x32_bf16 v[112:115], v[188:191], a[0:3], 0
  s_waitcnt lgkmcnt(4)
  ds_read_b128 v[140:143], v21 offset:2048
  v_mfma_f32_16x16x32_bf16 v[64:67], v[192:195], a[8:11], v[64:67]
  s_waitcnt lgkmcnt(4)
  s_add_u32 m0, s8, 114688
  s_mul_i32 s10, s67, 128
  buffer_load_dwordx4 v4, s[36:39], s10 offen offset:0 lds
  ds_read_b64_tr_b16 v[200:201], v18 offset:8192
  v_mfma_f32_16x16x32_bf16 v[68:71], v[192:195], a[12:15], v[68:71]
  s_waitcnt lgkmcnt(2)
  ds_read_b64_tr_b16 v[202:203], v18 offset:9216
  v_mfma_f32_16x16x32_bf16 v[72:75], v[192:195], v[136:139], v[72:75]
  s_waitcnt lgkmcnt(2)
  buffer_load_dwordx4 v5, s[36:39], s10 offen offset:1024 lds
  v_mfma_f32_16x16x32_bf16 v[76:79], v[192:195], v[140:143], v[76:79]
  v_mfma_f32_16x16x32_bf16 v[92:95], v[196:199], v[140:143], v[92:95]
  buffer_load_dwordx4 v6, s[36:39], s10 offen offset:2048 lds
  ds_read_b64_tr_b16 v[204:205], v19 offset:8192
  v_mfma_f32_16x16x32_bf16 v[88:91], v[196:199], v[136:139], v[88:91]
  ds_read_b64_tr_b16 v[206:207], v19 offset:9216
  v_mfma_f32_16x16x32_bf16 v[84:87], v[196:199], a[12:15], v[84:87]
  buffer_load_dwordx4 v7, s[36:39], s10 offen offset:3072 lds
  v_mfma_f32_16x16x32_bf16 v[80:83], v[196:199], a[8:11], v[80:83]
  s_waitcnt lgkmcnt(2)
  v_mfma_f32_16x16x32_bf16 v[96:99], v[200:203], a[8:11], v[96:99]
  s_waitcnt lgkmcnt(0) vmcnt(12)
  s_barrier
  s_add_u32 m0, s8, 49152
  s_mul_i32 s10, s67, 245760
  buffer_load_dwordx4 v8, s[40:43], s10 offen offset:0 lds
  ds_read_b64_tr_b16 v[176:177], v16 offset:16384
  v_mfma_f32_16x16x32_bf16 v[100:103], v[200:203], a[12:15], v[100:103]
  ds_read_b64_tr_b16 v[178:179], v16 offset:17408
  v_mfma_f32_16x16x32_bf16 v[104:107], v[200:203], v[136:139], v[104:107]
  buffer_load_dwordx4 v9, s[40:43], s10 offen offset:1024 lds
  ds_read_b128 a[16:19], v24 offset:16384
  v_mfma_f32_16x16x32_bf16 v[108:111], v[200:203], v[140:143], v[108:111]
  ds_read_b128 a[20:23], v24 offset:18432
  v_mfma_f32_16x16x32_bf16 v[124:127], v[204:207], v[140:143], v[124:127]
  buffer_load_dwordx4 v10, s[40:43], s10 offen offset:2048 lds
  ds_read_b64_tr_b16 v[180:181], v17 offset:16384
  v_mfma_f32_16x16x32_bf16 v[120:123], v[204:207], v[136:139], v[120:123]
  ds_read_b64_tr_b16 v[182:183], v17 offset:17408
  v_mfma_f32_16x16x32_bf16 v[116:119], v[204:207], a[12:15], v[116:119]
  buffer_load_dwordx4 v11, s[40:43], s10 offen offset:3072 lds
  ds_read_b128 v[128:131], v20 offset:16384
  v_mfma_f32_16x16x32_bf16 v[112:115], v[204:207], a[8:11], v[112:115]
  s_waitcnt lgkmcnt(4)
  ds_read_b128 v[132:135], v20 offset:18432
  v_mfma_f32_16x16x32_bf16 v[64:67], v[176:179], a[16:19], v[64:67]
  s_waitcnt lgkmcnt(4)
  s_add_u32 m0, s9, 143360
  s_nop 0
  buffer_load_dwordx4 v240, s[56:59], 0 offen offset:0 lds
  ds_read_b64_tr_b16 v[184:185], v18 offset:16384
  v_mfma_f32_16x16x32_bf16 v[68:71], v[176:179], a[20:23], v[68:71]
  s_waitcnt lgkmcnt(2)
  ds_read_b64_tr_b16 v[186:187], v18 offset:17408
  v_mfma_f32_16x16x32_bf16 v[72:75], v[176:179], v[128:131], v[72:75]
  s_waitcnt lgkmcnt(2)
  buffer_load_dwordx4 v241, s[56:59], 0 offen offset:1024 lds
  v_mfma_f32_16x16x32_bf16 v[76:79], v[176:179], v[132:135], v[76:79]
  v_mfma_f32_16x16x32_bf16 v[92:95], v[180:183], v[132:135], v[92:95]
  buffer_load_dwordx4 v242, s[56:59], 0 offen offset:2048 lds
  ds_read_b64_tr_b16 v[188:189], v19 offset:16384
  v_mfma_f32_16x16x32_bf16 v[88:91], v[180:183], v[128:131], v[88:91]
  ds_read_b64_tr_b16 v[190:191], v19 offset:17408
  v_mfma_f32_16x16x32_bf16 v[84:87], v[180:183], a[20:23], v[84:87]
  v_mfma_f32_16x16x32_bf16 v[80:83], v[180:183], a[16:19], v[80:83]
  s_waitcnt lgkmcnt(2)
  v_mfma_f32_16x16x32_bf16 v[96:99], v[184:187], a[16:19], v[96:99]
  s_add_u32 m0, s8, 65536
  s_mul_i32 s10, s68, 128
  buffer_load_dwordx4 v4, s[36:39], s10 offen offset:0 lds
  ds_read_b64_tr_b16 v[192:193], v16 offset:24576
  v_mfma_f32_16x16x32_bf16 v[100:103], v[184:187], a[20:23], v[100:103]
  ds_read_b64_tr_b16 v[194:195], v16 offset:25600
  v_mfma_f32_16x16x32_bf16 v[104:107], v[184:187], v[128:131], v[104:107]
  buffer_load_dwordx4 v5, s[36:39], s10 offen offset:1024 lds
  ds_read_b128 a[24:27], v25 offset:16384
  v_mfma_f32_16x16x32_bf16 v[108:111], v[184:187], v[132:135], v[108:111]
  s_waitcnt lgkmcnt(3)
  ds_read_b128 a[28:31], v25 offset:18432
  v_mfma_f32_16x16x32_bf16 v[124:127], v[188:191], v[132:135], v[124:127]
  ds_read_b64_tr_b16 v[196:197], v17 offset:24576
  v_mfma_f32_16x16x32_bf16 v[120:123], v[188:191], v[128:131], v[120:123]
  ds_read_b64_tr_b16 v[198:199], v17 offset:25600
  v_mfma_f32_16x16x32_bf16 v[116:119], v[188:191], a[20:23], v[116:119]
  buffer_load_dwordx4 v6, s[36:39], s10 offen offset:2048 lds
  ds_read_b128 v[136:139], v21 offset:16384
  v_mfma_f32_16x16x32_bf16 v[112:115], v[188:191], a[16:19], v[112:115]
  s_waitcnt lgkmcnt(4)
  ds_read_b128 v[140:143], v21 offset:18432
  v_mfma_f32_16x16x32_bf16 v[64:67], v[192:195], a[24:27], v[64:67]
  s_waitcnt lgkmcnt(4)
  buffer_load_dwordx4 v7, s[36:39], s10 offen offset:3072 lds
  ds_read_b64_tr_b16 v[200:201], v18 offset:24576
  v_mfma_f32_16x16x32_bf16 v[68:71], v[192:195], a[28:31], v[68:71]
  s_waitcnt lgkmcnt(2)
  ds_read_b64_tr_b16 v[202:203], v18 offset:25600
  v_mfma_f32_16x16x32_bf16 v[72:75], v[192:195], v[136:139], v[72:75]
  s_waitcnt lgkmcnt(2)
  v_mfma_f32_16x16x32_bf16 v[76:79], v[192:195], v[140:143], v[76:79]
  v_mfma_f32_16x16x32_bf16 v[92:95], v[196:199], v[140:143], v[92:95]
  s_add_u32 m0, s8, 0
  s_mul_i32 s10, s68, 245760
  buffer_load_dwordx4 v8, s[40:43], s10 offen offset:0 lds
  ds_read_b64_tr_b16 v[204:205], v19 offset:24576
  v_mfma_f32_16x16x32_bf16 v[88:91], v[196:199], v[136:139], v[88:91]
  ds_read_b64_tr_b16 v[206:207], v19 offset:25600
  v_mfma_f32_16x16x32_bf16 v[84:87], v[196:199], a[28:31], v[84:87]
  buffer_load_dwordx4 v9, s[40:43], s10 offen offset:1024 lds
  v_mfma_f32_16x16x32_bf16 v[80:83], v[196:199], a[24:27], v[80:83]
  s_waitcnt lgkmcnt(2)
  v_mfma_f32_16x16x32_bf16 v[96:99], v[200:203], a[24:27], v[96:99]
  s_waitcnt lgkmcnt(0) vmcnt(17)
  s_barrier
  ds_read_b64_tr_b16 v[176:177], v16 offset:32768
  v_mfma_f32_16x16x32_bf16 v[100:103], v[200:203], a[28:31], v[100:103]
  ds_read_b64_tr_b16 v[178:179], v16 offset:33792
  v_mfma_f32_16x16x32_bf16 v[104:107], v[200:203], v[136:139], v[104:107]
  buffer_load_dwordx4 v10, s[40:43], s10 offen offset:2048 lds
  ds_read_b128 a[32:35], v24 offset:32768
  v_mfma_f32_16x16x32_bf16 v[108:111], v[200:203], v[140:143], v[108:111]
  ds_read_b128 a[36:39], v24 offset:34816
  v_mfma_f32_16x16x32_bf16 v[124:127], v[204:207], v[140:143], v[124:127]
  buffer_load_dwordx4 v11, s[40:43], s10 offen offset:3072 lds
  ds_read_b64_tr_b16 v[180:181], v17 offset:32768
  v_mfma_f32_16x16x32_bf16 v[120:123], v[204:207], v[136:139], v[120:123]
  ds_read_b64_tr_b16 v[182:183], v17 offset:33792
  v_mfma_f32_16x16x32_bf16 v[116:119], v[204:207], a[28:31], v[116:119]
  ds_read_b128 v[128:131], v20 offset:32768
  v_mfma_f32_16x16x32_bf16 v[112:115], v[204:207], a[24:27], v[112:115]
  s_waitcnt lgkmcnt(4)
  ds_read_b128 v[132:135], v20 offset:34816
  v_mfma_f32_16x16x32_bf16 v[64:67], v[176:179], a[32:35], v[64:67]
  s_waitcnt lgkmcnt(4)
  s_add_u32 m0, s8, 81920
  s_mul_i32 s10, s69, 128
  buffer_load_dwordx4 v4, s[36:39], s10 offen offset:0 lds
  ds_read_b64_tr_b16 v[184:185], v18 offset:32768
  v_mfma_f32_16x16x32_bf16 v[68:71], v[176:179], a[36:39], v[68:71]
  s_waitcnt lgkmcnt(2)
  ds_read_b64_tr_b16 v[186:187], v18 offset:33792
  v_mfma_f32_16x16x32_bf16 v[72:75], v[176:179], v[128:131], v[72:75]
  s_waitcnt lgkmcnt(2)
  v_mfma_f32_16x16x32_bf16 v[76:79], v[176:179], v[132:135], v[76:79]
  v_mfma_f32_16x16x32_bf16 v[92:95], v[180:183], v[132:135], v[92:95]
  buffer_load_dwordx4 v5, s[36:39], s10 offen offset:1024 lds
  ds_read_b64_tr_b16 v[188:189], v19 offset:32768
  v_mfma_f32_16x16x32_bf16 v[88:91], v[180:183], v[128:131], v[88:91]
  ds_read_b64_tr_b16 v[190:191], v19 offset:33792
  v_mfma_f32_16x16x32_bf16 v[84:87], v[180:183], a[36:39], v[84:87]
  v_mfma_f32_16x16x32_bf16 v[80:83], v[180:183], a[32:35], v[80:83]
  s_waitcnt lgkmcnt(2)
  v_mfma_f32_16x16x32_bf16 v[96:99], v[184:187], a[32:35], v[96:99]
  buffer_load_dwordx4 v6, s[36:39], s10 offen offset:2048 lds
  ds_read_b64_tr_b16 v[192:193], v16 offset:40960
  v_mfma_f32_16x16x32_bf16 v[100:103], v[184:187], a[36:39], v[100:103]
  ds_read_b64_tr_b16 v[194:195], v16 offset:41984
  v_mfma_f32_16x16x32_bf16 v[104:107], v[184:187], v[128:131], v[104:107]
  ds_read_b128 a[40:43], v25 offset:32768
  v_mfma_f32_16x16x32_bf16 v[108:111], v[184:187], v[132:135], v[108:111]
  s_waitcnt lgkmcnt(3)
  ds_read_b128 a[44:47], v25 offset:34816
  v_mfma_f32_16x16x32_bf16 v[124:127], v[188:191], v[132:135], v[124:127]
  buffer_load_dwordx4 v7, s[36:39], s10 offen offset:3072 lds
  ds_read_b64_tr_b16 v[196:197], v17 offset:40960
  v_mfma_f32_16x16x32_bf16 v[120:123], v[188:191], v[128:131], v[120:123]
  ds_read_b64_tr_b16 v[198:199], v17 offset:41984
  v_mfma_f32_16x16x32_bf16 v[116:119], v[188:191], a[36:39], v[116:119]
  ds_read_b128 v[136:139], v21 offset:32768
  v_mfma_f32_16x16x32_bf16 v[112:115], v[188:191], a[32:35], v[112:115]
  s_waitcnt lgkmcnt(4)
  ds_read_b128 v[140:143], v21 offset:34816
  v_mfma_f32_16x16x32_bf16 v[64:67], v[192:195], a[40:43], v[64:67]
  s_waitcnt lgkmcnt(4)
  s_add_u32 m0, s8, 16384
  s_mul_i32 s10, s69, 245760
  buffer_load_dwordx4 v8, s[40:43], s10 offen offset:0 lds
  ds_read_b64_tr_b16 v[200:201], v18 offset:40960
  v_mfma_f32_16x16x32_bf16 v[68:71], v[192:195], a[44:47], v[68:71]
  s_waitcnt lgkmcnt(2)
  ds_read_b64_tr_b16 v[202:203], v18 offset:41984
  v_mfma_f32_16x16x32_bf16 v[72:75], v[192:195], v[136:139], v[72:75]
  s_waitcnt lgkmcnt(2)
  v_mfma_f32_16x16x32_bf16 v[76:79], v[192:195], v[140:143], v[76:79]
  v_mfma_f32_16x16x32_bf16 v[92:95], v[196:199], v[140:143], v[92:95]
  buffer_load_dwordx4 v9, s[40:43], s10 offen offset:1024 lds
  ds_read_b64_tr_b16 v[204:205], v19 offset:40960
  v_mfma_f32_16x16x32_bf16 v[88:91], v[196:199], v[136:139], v[88:91]
  ds_read_b64_tr_b16 v[206:207], v19 offset:41984
  v_mfma_f32_16x16x32_bf16 v[84:87], v[196:199], a[44:47], v[84:87]
  v_mfma_f32_16x16x32_bf16 v[80:83], v[196:199], a[40:43], v[80:83]
  s_waitcnt lgkmcnt(2)
  v_mfma_f32_16x16x32_bf16 v[96:99], v[200:203], a[40:43], v[96:99]
  s_waitcnt lgkmcnt(0) vmcnt(17)
  s_barrier
  buffer_load_dwordx4 v10, s[40:43], s10 offen offset:2048 lds
  ds_read_b64_tr_b16 v[176:177], v16 offset:49152
  v_mfma_f32_16x16x32_bf16 v[100:103], v[200:203], a[44:47], v[100:103]
  ds_read_b64_tr_b16 v[178:179], v16 offset:50176
  v_mfma_f32_16x16x32_bf16 v[104:107], v[200:203], v[136:139], v[104:107]
  ds_read_b128 a[48:51], v24 offset:49152
  v_mfma_f32_16x16x32_bf16 v[108:111], v[200:203], v[140:143], v[108:111]
  ds_read_b128 a[52:55], v24 offset:51200
  v_mfma_f32_16x16x32_bf16 v[124:127], v[204:207], v[140:143], v[124:127]
  buffer_load_dwordx4 v11, s[40:43], s10 offen offset:3072 lds
  ds_read_b64_tr_b16 v[180:181], v17 offset:49152
  v_mfma_f32_16x16x32_bf16 v[120:123], v[204:207], v[136:139], v[120:123]
  ds_read_b64_tr_b16 v[182:183], v17 offset:50176
  v_mfma_f32_16x16x32_bf16 v[116:119], v[204:207], a[44:47], v[116:119]
  ds_read_b128 v[128:131], v20 offset:49152
  v_mfma_f32_16x16x32_bf16 v[112:115], v[204:207], a[40:43], v[112:115]
  s_waitcnt lgkmcnt(4)
  ds_read_b128 v[132:135], v20 offset:51200
  v_mfma_f32_16x16x32_bf16 v[64:67], v[176:179], a[48:51], v[64:67]
  s_waitcnt lgkmcnt(4)
  s_add_u32 m0, s8, 98304
  s_mul_i32 s10, s70, 128
  buffer_load_dwordx4 v4, s[36:39], s10 offen offset:0 lds
  ds_read_b64_tr_b16 v[184:185], v18 offset:49152
  v_mfma_f32_16x16x32_bf16 v[68:71], v[176:179], a[52:55], v[68:71]
  s_waitcnt lgkmcnt(2)
  ds_read_b64_tr_b16 v[186:187], v18 offset:50176
  v_mfma_f32_16x16x32_bf16 v[72:75], v[176:179], v[128:131], v[72:75]
  s_waitcnt lgkmcnt(2)
  v_mfma_f32_16x16x32_bf16 v[76:79], v[176:179], v[132:135], v[76:79]
  v_mfma_f32_16x16x32_bf16 v[92:95], v[180:183], v[132:135], v[92:95]
  buffer_load_dwordx4 v5, s[36:39], s10 offen offset:1024 lds
  ds_read_b64_tr_b16 v[188:189], v19 offset:49152
  v_mfma_f32_16x16x32_bf16 v[88:91], v[180:183], v[128:131], v[88:91]
  ds_read_b64_tr_b16 v[190:191], v19 offset:50176
  v_mfma_f32_16x16x32_bf16 v[84:87], v[180:183], a[52:55], v[84:87]
  v_mfma_f32_16x16x32_bf16 v[80:83], v[180:183], a[48:51], v[80:83]
  s_waitcnt lgkmcnt(2)
  v_mfma_f32_16x16x32_bf16 v[96:99], v[184:187], a[48:51], v[96:99]
  buffer_load_dwordx4 v6, s[36:39], s10 offen offset:2048 lds
  ds_read_b64_tr_b16 v[192:193], v16 offset:57344
  v_mfma_f32_16x16x32_bf16 v[100:103], v[184:187], a[52:55], v[100:103]
  ds_read_b64_tr_b16 v[194:195], v16 offset:58368
  v_mfma_f32_16x16x32_bf16 v[104:107], v[184:187], v[128:131], v[104:107]
  ds_read_b128 a[56:59], v25 offset:49152
  v_mfma_f32_16x16x32_bf16 v[108:111], v[184:187], v[132:135], v[108:111]
  s_waitcnt lgkmcnt(3)
  ds_read_b128 a[60:63], v25 offset:51200
  v_mfma_f32_16x16x32_bf16 v[124:127], v[188:191], v[132:135], v[124:127]
  buffer_load_dwordx4 v7, s[36:39], s10 offen offset:3072 lds
  ds_read_b64_tr_b16 v[196:197], v17 offset:57344
  v_mfma_f32_16x16x32_bf16 v[120:123], v[188:191], v[128:131], v[120:123]
  ds_read_b64_tr_b16 v[198:199], v17 offset:58368
  v_mfma_f32_16x16x32_bf16 v[116:119], v[188:191], a[52:55], v[116:119]
  ds_read_b128 v[136:139], v21 offset:49152
  v_mfma_f32_16x16x32_bf16 v[112:115], v[188:191], a[48:51], v[112:115]
  s_waitcnt lgkmcnt(4)
  ds_read_b128 v[140:143], v21 offset:51200
  v_mfma_f32_16x16x32_bf16 v[64:67], v[192:195], a[56:59], v[64:67]
  s_waitcnt lgkmcnt(4)
  s_add_u32 m0, s8, 32768
  s_mul_i32 s10, s70, 245760
  buffer_load_dwordx4 v8, s[40:43], s10 offen offset:0 lds
  ds_read_b64_tr_b16 v[200:201], v18 offset:57344
  v_mfma_f32_16x16x32_bf16 v[68:71], v[192:195], a[60:63], v[68:71]
  s_waitcnt lgkmcnt(2)
  ds_read_b64_tr_b16 v[202:203], v18 offset:58368
  v_mfma_f32_16x16x32_bf16 v[72:75], v[192:195], v[136:139], v[72:75]
  s_waitcnt lgkmcnt(2)
  v_mfma_f32_16x16x32_bf16 v[76:79], v[192:195], v[140:143], v[76:79]
  v_mfma_f32_16x16x32_bf16 v[92:95], v[196:199], v[140:143], v[92:95]
  buffer_load_dwordx4 v9, s[40:43], s10 offen offset:1024 lds
  ds_read_b64_tr_b16 v[204:205], v19 offset:57344
  v_mfma_f32_16x16x32_bf16 v[88:91], v[196:199], v[136:139], v[88:91]
  ds_read_b64_tr_b16 v[206:207], v19 offset:58368
  v_mfma_f32_16x16x32_bf16 v[84:87], v[196:199], a[60:63], v[84:87]
  v_mfma_f32_16x16x32_bf16 v[80:83], v[196:199], a[56:59], v[80:83]
  s_waitcnt lgkmcnt(2)
  v_mfma_f32_16x16x32_bf16 v[96:99], v[200:203], a[56:59], v[96:99]
  s_waitcnt vmcnt(22)
  ds_read_b64_tr_b16 v[208:209], v243 offset:0
  ds_read_b64_tr_b16 v[210:211], v243 offset:640
  ds_read_b64_tr_b16 v[212:213], v243 offset:64
  ds_read_b64_tr_b16 v[214:215], v243 offset:704
  ds_read_b64_tr_b16 v[216:217], v244 offset:0
  ds_read_b64_tr_b16 v[218:219], v244 offset:640
  s_waitcnt lgkmcnt(4)
  buffer_store_dwordx4 v[208:211], v245, s[48:51], 0 offen offset:0 sc1
  s_waitcnt lgkmcnt(2)
  buffer_store_dwordx4 v[212:215], v245, s[48:51], 0 offen offset:2048 sc1
  s_waitcnt lgkmcnt(0)
  buffer_store_dwordx4 v[216:219], v246, s[48:51], 0 offen offset:0 sc1
  s_waitcnt vmcnt(17)
  s_barrier
  buffer_load_dwordx4 v10, s[40:43], s10 offen offset:2048 lds
  ds_read_b64_tr_b16 v[176:177], v16 offset:0
  v_mfma_f32_16x16x32_bf16 v[100:103], v[200:203], a[60:63], v[100:103]
  ds_read_b64_tr_b16 v[178:179], v16 offset:1024
  v_mfma_f32_16x16x32_bf16 v[104:107], v[200:203], v[136:139], v[104:107]
  ds_read_b128 a[64:67], v24 offset:0
  v_mfma_f32_16x16x32_bf16 v[108:111], v[200:203], v[140:143], v[108:111]
  ds_read_b128 a[68:71], v24 offset:2048
  v_mfma_f32_16x16x32_bf16 v[124:127], v[204:207], v[140:143], v[124:127]
  buffer_load_dwordx4 v11, s[40:43], s10 offen offset:3072 lds
  ds_read_b64_tr_b16 v[180:181], v17 offset:0
  v_mfma_f32_16x16x32_bf16 v[120:123], v[204:207], v[136:139], v[120:123]
  ds_read_b64_tr_b16 v[182:183], v17 offset:1024
  v_mfma_f32_16x16x32_bf16 v[116:119], v[204:207], a[60:63], v[116:119]
  ds_read_b128 v[128:131], v20 offset:0
  v_mfma_f32_16x16x32_bf16 v[112:115], v[204:207], a[56:59], v[112:115]
  s_waitcnt lgkmcnt(4)
  ds_read_b128 v[132:135], v20 offset:2048
  v_mfma_f32_16x16x32_bf16 v[64:67], v[176:179], a[64:67], v[64:67]
  s_waitcnt lgkmcnt(4)
  s_add_u32 m0, s8, 114688
  s_mul_i32 s10, s71, 128
  buffer_load_dwordx4 v4, s[36:39], s10 offen offset:0 lds
  ds_read_b64_tr_b16 v[184:185], v18 offset:0
  v_mfma_f32_16x16x32_bf16 v[68:71], v[176:179], a[68:71], v[68:71]
  s_waitcnt lgkmcnt(2)
  ds_read_b64_tr_b16 v[186:187], v18 offset:1024
  v_mfma_f32_16x16x32_bf16 v[72:75], v[176:179], v[128:131], v[72:75]
  s_waitcnt lgkmcnt(2)
  v_mfma_f32_16x16x32_bf16 v[76:79], v[176:179], v[132:135], v[76:79]
  v_mfma_f32_16x16x32_bf16 v[92:95], v[180:183], v[132:135], v[92:95]
  buffer_load_dwordx4 v5, s[36:39], s10 offen offset:1024 lds
  ds_read_b64_tr_b16 v[188:189], v19 offset:0
  v_mfma_f32_16x16x32_bf16 v[88:91], v[180:183], v[128:131], v[88:91]
  ds_read_b64_tr_b16 v[190:191], v19 offset:1024
  v_mfma_f32_16x16x32_bf16 v[84:87], v[180:183], a[68:71], v[84:87]
  v_mfma_f32_16x16x32_bf16 v[80:83], v[180:183], a[64:67], v[80:83]
  s_waitcnt lgkmcnt(2)
  v_mfma_f32_16x16x32_bf16 v[96:99], v[184:187], a[64:67], v[96:99]
  buffer_load_dwordx4 v6, s[36:39], s10 offen offset:2048 lds
  ds_read_b64_tr_b16 v[192:193], v16 offset:8192
  v_mfma_f32_16x16x32_bf16 v[100:103], v[184:187], a[68:71], v[100:103]
  ds_read_b64_tr_b16 v[194:195], v16 offset:9216
  v_mfma_f32_16x16x32_bf16 v[104:107], v[184:187], v[128:131], v[104:107]
  ds_read_b128 a[72:75], v25 offset:0
  v_mfma_f32_16x16x32_bf16 v[108:111], v[184:187], v[132:135], v[108:111]
  s_waitcnt lgkmcnt(3)
  ds_read_b128 a[76:79], v25 offset:2048
  v_mfma_f32_16x16x32_bf16 v[124:127], v[188:191], v[132:135], v[124:127]
  buffer_load_dwordx4 v7, s[36:39], s10 offen offset:3072 lds
  ds_read_b64_tr_b16 v[196:197], v17 offset:8192
  v_mfma_f32_16x16x32_bf16 v[120:123], v[188:191], v[128:131], v[120:123]
  ds_read_b64_tr_b16 v[198:199], v17 offset:9216
  v_mfma_f32_16x16x32_bf16 v[116:119], v[188:191], a[68:71], v[116:119]
  ds_read_b128 v[136:139], v21 offset:0
  v_mfma_f32_16x16x32_bf16 v[112:115], v[188:191], a[64:67], v[112:115]
  s_waitcnt lgkmcnt(4)
  ds_read_b128 v[140:143], v21 offset:2048
  v_mfma_f32_16x16x32_bf16 v[64:67], v[192:195], a[72:75], v[64:67]
  s_waitcnt lgkmcnt(4)
  s_add_u32 m0, s8, 49152
  s_mul_i32 s10, s71, 245760
  buffer_load_dwordx4 v8, s[40:43], s10 offen offset:0 lds
  ds_read_b64_tr_b16 v[200:201], v18 offset:8192
  v_mfma_f32_16x16x32_bf16 v[68:71], v[192:195], a[76:79], v[68:71]
  s_waitcnt lgkmcnt(2)
  ds_read_b64_tr_b16 v[202:203], v18 offset:9216
  v_mfma_f32_16x16x32_bf16 v[72:75], v[192:195], v[136:139], v[72:75]
  s_waitcnt lgkmcnt(2)
  v_mfma_f32_16x16x32_bf16 v[76:79], v[192:195], v[140:143], v[76:79]
  v_mfma_f32_16x16x32_bf16 v[92:95], v[196:199], v[140:143], v[92:95]
  buffer_load_dwordx4 v9, s[40:43], s10 offen offset:1024 lds
  ds_read_b64_tr_b16 v[204:205], v19 offset:8192
  v_mfma_f32_16x16x32_bf16 v[88:91], v[196:199], v[136:139], v[88:91]
  ds_read_b64_tr_b16 v[206:207], v19 offset:9216
  v_mfma_f32_16x16x32_bf16 v[84:87], v[196:199], a[76:79], v[84:87]
  v_mfma_f32_16x16x32_bf16 v[80:83], v[196:199], a[72:75], v[80:83]
  s_waitcnt lgkmcnt(2)
  v_mfma_f32_16x16x32_bf16 v[96:99], v[200:203], a[72:75], v[96:99]
  s_waitcnt lgkmcnt(0) vmcnt(17)
  s_barrier
  buffer_load_dwordx4 v10, s[40:43], s10 offen offset:2048 lds
  ds_read_b64_tr_b16 v[176:177], v16 offset:16384
  v_mfma_f32_16x16x32_bf16 v[100:103], v[200:203], a[76:79], v[100:103]
  ds_read_b64_tr_b16 v[178:179], v16 offset:17408
  v_mfma_f32_16x16x32_bf16 v[104:107], v[200:203], v[136:139], v[104:107]
  ds_read_b128 a[80:83], v24 offset:16384
  v_mfma_f32_16x16x32_bf16 v[108:111], v[200:203], v[140:143], v[108:111]
  ds_read_b128 a[84:87], v24 offset:18432
  v_mfma_f32_16x16x32_bf16 v[124:127], v[204:207], v[140:143], v[124:127]
  buffer_load_dwordx4 v11, s[40:43], s10 offen offset:3072 lds
  ds_read_b64_tr_b16 v[180:181], v17 offset:16384
  v_mfma_f32_16x16x32_bf16 v[120:123], v[204:207], v[136:139], v[120:123]
  ds_read_b64_tr_b16 v[182:183], v17 offset:17408
  v_mfma_f32_16x16x32_bf16 v[116:119], v[204:207], a[76:79], v[116:119]
  ds_read_b128 v[128:131], v20 offset:16384
  v_mfma_f32_16x16x32_bf16 v[112:115], v[204:207], a[72:75], v[112:115]
  s_waitcnt lgkmcnt(4)
  ds_read_b128 v[132:135], v20 offset:18432
  v_mfma_f32_16x16x32_bf16 v[64:67], v[176:179], a[80:83], v[64:67]
  s_waitcnt lgkmcnt(4)
  s_add_u32 m0, s8, 65536
  s_mul_i32 s10, s72, 128
  buffer_load_dwordx4 v4, s[36:39], s10 offen offset:0 lds
  ds_read_b64_tr_b16 v[184:185], v18 offset:16384
  v_mfma_f32_16x16x32_bf16 v[68:71], v[176:179], a[84:87], v[68:71]
  s_waitcnt lgkmcnt(2)
  ds_read_b64_tr_b16 v[186:187], v18 offset:17408
  v_mfma_f32_16x16x32_bf16 v[72:75], v[176:179], v[128:131], v[72:75]
  s_waitcnt lgkmcnt(2)
  v_mfma_f32_16x16x32_bf16 v[76:79], v[176:179], v[132:135], v[76:79]
  v_mfma_f32_16x16x32_bf16 v[92:95], v[180:183], v[132:135], v[92:95]
  buffer_load_dwordx4 v5, s[36:39], s10 offen offset:1024 lds
  ds_read_b64_tr_b16 v[188:189], v19 offset:16384
  v_mfma_f32_16x16x32_bf16 v[88:91], v[180:183], v[128:131], v[88:91]
  ds_read_b64_tr_b16 v[190:191], v19 offset:17408
  v_mfma_f32_16x16x32_bf16 v[84:87], v[180:183], a[84:87], v[84:87]
  v_mfma_f32_16x16x32_bf16 v[80:83], v[180:183], a[80:83], v[80:83]
  s_waitcnt lgkmcnt(2)
  v_mfma_f32_16x16x32_bf16 v[96:99], v[184:187], a[80:83], v[96:99]
  buffer_load_dwordx4 v6, s[36:39], s10 offen offset:2048 lds
  ds_read_b64_tr_b16 v[192:193], v16 offset:24576
  v_mfma_f32_16x16x32_bf16 v[100:103], v[184:187], a[84:87], v[100:103]
  ds_read_b64_tr_b16 v[194:195], v16 offset:25600
  v_mfma_f32_16x16x32_bf16 v[104:107], v[184:187], v[128:131], v[104:107]
  ds_read_b128 a[88:91], v25 offset:16384
  v_mfma_f32_16x16x32_bf16 v[108:111], v[184:187], v[132:135], v[108:111]
  s_waitcnt lgkmcnt(3)
  ds_read_b128 a[92:95], v25 offset:18432
  v_mfma_f32_16x16x32_bf16 v[124:127], v[188:191], v[132:135], v[124:127]
  buffer_load_dwordx4 v7, s[36:39], s10 offen offset:3072 lds
  ds_read_b64_tr_b16 v[196:197], v17 offset:24576
  v_mfma_f32_16x16x32_bf16 v[120:123], v[188:191], v[128:131], v[120:123]
  ds_read_b64_tr_b16 v[198:199], v17 offset:25600
  v_mfma_f32_16x16x32_bf16 v[116:119], v[188:191], a[84:87], v[116:119]
  ds_read_b128 v[136:139], v21 offset:16384
  v_mfma_f32_16x16x32_bf16 v[112:115], v[188:191], a[80:83], v[112:115]
  s_waitcnt lgkmcnt(4)
  ds_read_b128 v[140:143], v21 offset:18432
  v_mfma_f32_16x16x32_bf16 v[64:67], v[192:195], a[88:91], v[64:67]
  s_waitcnt lgkmcnt(4)
  s_add_u32 m0, s8, 0
  s_mul_i32 s10, s72, 245760
  buffer_load_dwordx4 v8, s[40:43], s10 offen offset:0 lds
  ds_read_b64_tr_b16 v[200:201], v18 offset:24576
  v_mfma_f32_16x16x32_bf16 v[68:71], v[192:195], a[92:95], v[68:71]
  s_waitcnt lgkmcnt(2)
  ds_read_b64_tr_b16 v[202:203], v18 offset:25600
  v_mfma_f32_16x16x32_bf16 v[72:75], v[192:195], v[136:139], v[72:75]
  s_waitcnt lgkmcnt(2)
  v_mfma_f32_16x16x32_bf16 v[76:79], v[192:195], v[140:143], v[76:79]
  v_mfma_f32_16x16x32_bf16 v[92:95], v[196:199], v[140:143], v[92:95]
  buffer_load_dwordx4 v9, s[40:43], s10 offen offset:1024 lds
  ds_read_b64_tr_b16 v[204:205], v19 offset:24576
  buffer_load_dword v15, off, s[60:63], 0 sc1
  v_mfma_f32_16x16x32_bf16 v[88:91], v[196:199], v[136:139], v[88:91]
  ds_read_b64_tr_b16 v[206:207], v19 offset:25600
  v_mfma_f32_16x16x32_bf16 v[84:87], v[196:199], a[92:95], v[84:87]
  v_mfma_f32_16x16x32_bf16 v[80:83], v[196:199], a[88:91], v[80:83]
  s_waitcnt lgkmcnt(2)
  v_mfma_f32_16x16x32_bf16 v[96:99], v[200:203], a[88:91], v[96:99]
  s_waitcnt lgkmcnt(0) vmcnt(15)
  s_barrier
  buffer_load_dwordx4 v10, s[40:43], s10 offen offset:2048 lds
  ds_read_b64_tr_b16 v[176:177], v16 offset:32768
  v_mfma_f32_16x16x32_bf16 v[100:103], v[200:203], a[92:95], v[100:103]
  ds_read_b64_tr_b16 v[178:179], v16 offset:33792
  v_mfma_f32_16x16x32_bf16 v[104:107], v[200:203], v[136:139], v[104:107]
  ds_read_b128 a[96:99], v24 offset:32768
  v_mfma_f32_16x16x32_bf16 v[108:111], v[200:203], v[140:143], v[108:111]
  ds_read_b128 a[100:103], v24 offset:34816
  v_mfma_f32_16x16x32_bf16 v[124:127], v[204:207], v[140:143], v[124:127]
  buffer_load_dwordx4 v11, s[40:43], s10 offen offset:3072 lds
  ds_read_b64_tr_b16 v[180:181], v17 offset:32768
  v_mfma_f32_16x16x32_bf16 v[120:123], v[204:207], v[136:139], v[120:123]
  ds_read_b64_tr_b16 v[182:183], v17 offset:33792
  v_mfma_f32_16x16x32_bf16 v[116:119], v[204:207], a[92:95], v[116:119]
  ds_read_b128 v[128:131], v20 offset:32768
  v_mfma_f32_16x16x32_bf16 v[112:115], v[204:207], a[88:91], v[112:115]
  s_waitcnt lgkmcnt(4)
  ds_read_b128 v[132:135], v20 offset:34816
  v_mfma_f32_16x16x32_bf16 v[64:67], v[176:179], a[96:99], v[64:67]
  s_waitcnt lgkmcnt(4)
  s_add_u32 m0, s8, 81920
  s_mul_i32 s10, s73, 128
  buffer_load_dwordx4 v4, s[36:39], s10 offen offset:0 lds
  ds_read_b64_tr_b16 v[184:185], v18 offset:32768
  v_mfma_f32_16x16x32_bf16 v[68:71], v[176:179], a[100:103], v[68:71]
  s_waitcnt lgkmcnt(2)
  ds_read_b64_tr_b16 v[186:187], v18 offset:33792
  v_mfma_f32_16x16x32_bf16 v[72:75], v[176:179], v[128:131], v[72:75]
  s_waitcnt lgkmcnt(2)
  v_mfma_f32_16x16x32_bf16 v[76:79], v[176:179], v[132:135], v[76:79]
  v_mfma_f32_16x16x32_bf16 v[92:95], v[180:183], v[132:135], v[92:95]
  buffer_load_dwordx4 v5, s[36:39], s10 offen offset:1024 lds
  ds_read_b64_tr_b16 v[188:189], v19 offset:32768
  v_mfma_f32_16x16x32_bf16 v[88:91], v[180:183], v[128:131], v[88:91]
  ds_read_b64_tr_b16 v[190:191], v19 offset:33792
  v_mfma_f32_16x16x32_bf16 v[84:87], v[180:183], a[100:103], v[84:87]
  v_mfma_f32_16x16x32_bf16 v[80:83], v[180:183], a[96:99], v[80:83]
  s_waitcnt lgkmcnt(2)
  v_mfma_f32_16x16x32_bf16 v[96:99], v[184:187], a[96:99], v[96:99]
  buffer_load_dwordx4 v6, s[36:39], s10 offen offset:2048 lds
  ds_read_b64_tr_b16 v[192:193], v16 offset:40960
  v_mfma_f32_16x16x32_bf16 v[100:103], v[184:187], a[100:103], v[100:103]
  ds_read_b64_tr_b16 v[194:195], v16 offset:41984
  v_mfma_f32_16x16x32_bf16 v[104:107], v[184:187], v[128:131], v[104:107]
  ds_read_b128 a[104:107], v25 offset:32768
  v_mfma_f32_16x16x32_bf16 v[108:111], v[184:187], v[132:135], v[108:111]
  s_waitcnt lgkmcnt(3)
  ds_read_b128 a[108:111], v25 offset:34816
  v_mfma_f32_16x16x32_bf16 v[124:127], v[188:191], v[132:135], v[124:127]
  buffer_load_dwordx4 v7, s[36:39], s10 offen offset:3072 lds
  ds_read_b64_tr_b16 v[196:197], v17 offset:40960
  v_mfma_f32_16x16x32_bf16 v[120:123], v[188:191], v[128:131], v[120:123]
  ds_read_b64_tr_b16 v[198:199], v17 offset:41984
  v_mfma_f32_16x16x32_bf16 v[116:119], v[188:191], a[100:103], v[116:119]
  ds_read_b128 v[136:139], v21 offset:32768
  v_mfma_f32_16x16x32_bf16 v[112:115], v[188:191], a[96:99], v[112:115]
  s_waitcnt lgkmcnt(4)
  ds_read_b128 v[140:143], v21 offset:34816
  v_mfma_f32_16x16x32_bf16 v[64:67], v[192:195], a[104:107], v[64:67]
  s_waitcnt lgkmcnt(4)
  s_add_u32 m0, s8, 16384
  s_mul_i32 s10, s73, 245760
  buffer_load_dwordx4 v8, s[40:43], s10 offen offset:0 lds
  ds_read_b64_tr_b16 v[200:201], v18 offset:40960
  v_mfma_f32_16x16x32_bf16 v[68:71], v[192:195], a[108:111], v[68:71]
  s_waitcnt lgkmcnt(2)
  ds_read_b64_tr_b16 v[202:203], v18 offset:41984
  v_mfma_f32_16x16x32_bf16 v[72:75], v[192:195], v[136:139], v[72:75]
  s_waitcnt lgkmcnt(2)
  v_mfma_f32_16x16x32_bf16 v[76:79], v[192:195], v[140:143], v[76:79]
  v_mfma_f32_16x16x32_bf16 v[92:95], v[196:199], v[140:143], v[92:95]
  buffer_load_dwordx4 v9, s[40:43], s10 offen offset:1024 lds
  ds_read_b64_tr_b16 v[204:205], v19 offset:40960
  v_mfma_f32_16x16x32_bf16 v[88:91], v[196:199], v[136:139], v[88:91]
  ds_read_b64_tr_b16 v[206:207], v19 offset:41984
  v_mfma_f32_16x16x32_bf16 v[84:87], v[196:199], a[108:111], v[84:87]
  v_mfma_f32_16x16x32_bf16 v[80:83], v[196:199], a[104:107], v[80:83]
  s_waitcnt lgkmcnt(2)
  v_mfma_f32_16x16x32_bf16 v[96:99], v[200:203], a[104:107], v[96:99]
  s_waitcnt lgkmcnt(0) vmcnt(15)
  s_barrier
  buffer_load_dwordx4 v10, s[40:43], s10 offen offset:2048 lds
  ds_read_b64_tr_b16 v[176:177], v16 offset:49152
  v_mfma_f32_16x16x32_bf16 v[100:103], v[200:203], a[108:111], v[100:103]
  ds_read_b64_tr_b16 v[178:179], v16 offset:50176
  v_mfma_f32_16x16x32_bf16 v[104:107], v[200:203], v[136:139], v[104:107]
  ds_read_b128 a[112:115], v24 offset:49152
  v_mfma_f32_16x16x32_bf16 v[108:111], v[200:203], v[140:143], v[108:111]
  ds_read_b128 a[116:119], v24 offset:51200
  v_mfma_f32_16x16x32_bf16 v[124:127], v[204:207], v[140:143], v[124:127]
  buffer_load_dwordx4 v11, s[40:43], s10 offen offset:3072 lds
  ds_read_b64_tr_b16 v[180:181], v17 offset:49152
  v_mfma_f32_16x16x32_bf16 v[120:123], v[204:207], v[136:139], v[120:123]
  ds_read_b64_tr_b16 v[182:183], v17 offset:50176
  v_mfma_f32_16x16x32_bf16 v[116:119], v[204:207], a[108:111], v[116:119]
  ds_read_b128 v[128:131], v20 offset:49152
  v_mfma_f32_16x16x32_bf16 v[112:115], v[204:207], a[104:107], v[112:115]
  s_waitcnt lgkmcnt(4)
  ds_read_b128 v[132:135], v20 offset:51200
  v_mfma_f32_16x16x32_bf16 v[64:67], v[176:179], a[112:115], v[64:67]
  s_waitcnt lgkmcnt(4)
  s_add_u32 m0, s9, 131072
  s_mul_i32 s10, s64, 196608
  buffer_load_dwordx4 v12, s[44:47], s10 offen offset:0 lds
  ds_read_b64_tr_b16 v[184:185], v18 offset:49152
  v_mfma_f32_16x16x32_bf16 v[68:71], v[176:179], a[116:119], v[68:71]
  s_waitcnt lgkmcnt(2)
  ds_read_b64_tr_b16 v[186:187], v18 offset:50176
  v_mfma_f32_16x16x32_bf16 v[72:75], v[176:179], v[128:131], v[72:75]
  s_waitcnt lgkmcnt(2)
  v_mfma_f32_16x16x32_bf16 v[76:79], v[176:179], v[132:135], v[76:79]
  v_mfma_f32_16x16x32_bf16 v[92:95], v[180:183], v[132:135], v[92:95]
  buffer_load_dwordx4 v13, s[44:47], s10 offen offset:1024 lds
  ds_read_b64_tr_b16 v[188:189], v19 offset:49152
  v_mfma_f32_16x16x32_bf16 v[88:91], v[180:183], v[128:131], v[88:91]
  ds_read_b64_tr_b16 v[190:191], v19 offset:50176
  v_mfma_f32_16x16x32_bf16 v[84:87], v[180:183], a[116:119], v[84:87]
  v_mfma_f32_16x16x32_bf16 v[80:83], v[180:183], a[112:115], v[80:83]
  s_waitcnt lgkmcnt(2)
  v_mfma_f32_16x16x32_bf16 v[96:99], v[184:187], a[112:115], v[96:99]
  buffer_load_dwordx4 v14, s[44:47], s10 offen offset:2048 lds
  ds_read_b64_tr_b16 v[192:193], v16 offset:57344
  v_mfma_f32_16x16x32_bf16 v[100:103], v[184:187], a[116:119], v[100:103]
  ds_read_b64_tr_b16 v[194:195], v16 offset:58368
  v_mfma_f32_16x16x32_bf16 v[104:107], v[184:187], v[128:131], v[104:107]
  ds_read_b128 a[120:123], v25 offset:49152
  v_mfma_f32_16x16x32_bf16 v[108:111], v[184:187], v[132:135], v[108:111]
  s_waitcnt lgkmcnt(3)
  ds_read_b128 a[124:127], v25 offset:51200
  v_mfma_f32_16x16x32_bf16 v[124:127], v[188:191], v[132:135], v[124:127]
  s_add_u32 m0, s9, 143360
  s_mul_i32 s10, s72, 196608
  buffer_load_dwordx4 v12, s[44:47], s10 offen offset:0 lds
  ds_read_b64_tr_b16 v[196:197], v17 offset:57344
  v_mfma_f32_16x16x32_bf16 v[120:123], v[188:191], v[128:131], v[120:123]
  ds_read_b64_tr_b16 v[198:199], v17 offset:58368
  v_mfma_f32_16x16x32_bf16 v[116:119], v[188:191], a[116:119], v[116:119]
  ds_read_b128 v[136:139], v21 offset:49152
  v_mfma_f32_16x16x32_bf16 v[112:115], v[188:191], a[112:115], v[112:115]
  s_waitcnt lgkmcnt(4)
  ds_read_b128 v[140:143], v21 offset:51200
  v_mfma_f32_16x16x32_bf16 v[64:67], v[192:195], a[120:123], v[64:67]
  s_waitcnt lgkmcnt(4)
  buffer_load_dwordx4 v13, s[44:47], s10 offen offset:1024 lds
  ds_read_b64_tr_b16 v[200:201], v18 offset:57344
  v_mfma_f32_16x16x32_bf16 v[68:71], v[192:195], a[124:127], v[68:71]
  s_waitcnt lgkmcnt(2)
  ds_read_b64_tr_b16 v[202:203], v18 offset:58368
  v_mfma_f32_16x16x32_bf16 v[72:75], v[192:195], v[136:139], v[72:75]
  s_waitcnt lgkmcnt(2)
  v_mfma_f32_16x16x32_bf16 v[76:79], v[192:195], v[140:143], v[76:79]
  v_mfma_f32_16x16x32_bf16 v[92:95], v[196:199], v[140:143], v[92:95]
  buffer_load_dwordx4 v14, s[44:47], s10 offen offset:2048 lds
  ds_read_b64_tr_b16 v[204:205], v19 offset:57344
  s_waitcnt vmcnt(16)
  v_cmp_gt_u32 vcc, 32, v15
  s_cbranch_vccnz SL_rdy
OK_rdy:
  buffer_store_dword v30, v247, s[48:51], 0 offen sc1
  v_mfma_f32_16x16x32_bf16 v[88:91], v[196:199], v[136:139], v[88:91]
  ds_read_b64_tr_b16 v[206:207], v19 offset:58368
  v_mfma_f32_16x16x32_bf16 v[84:87], v[196:199], a[124:127], v[84:87]
  v_mfma_f32_16x16x32_bf16 v[80:83], v[196:199], a[120:123], v[80:83]
  s_waitcnt lgkmcnt(2)
  v_mfma_f32_16x16x32_bf16 v[96:99], v[200:203], a[120:123], v[96:99]
  s_waitcnt lgkmcnt(0) vmcnt(15)
  s_barrier
  ds_read_b64_tr_b16 v[176:177], v16 offset:0
  v_mfma_f32_16x16x32_bf16 v[100:103], v[200:203], a[124:127], v[100:103]
  ds_read_b64_tr_b16 v[178:179], v16 offset:1024
  v_mfma_f32_16x16x32_bf16 v[104:107], v[200:203], v[136:139], v[104:107]
  ds_read_b128 a[128:131], v24 offset:0
  v_mfma_f32_16x16x32_bf16 v[108:111], v[200:203], v[140:143], v[108:111]
  ds_read_b128 a[132:135], v24 offset:2048
  v_mfma_f32_16x16x32_bf16 v[124:127], v[204:207], v[140:143], v[124:127]
  ds_read_b64_tr_b16 v[180:181], v17 offset:0
  v_mfma_f32_16x16x32_bf16 v[120:123], v[204:207], v[136:139], v[120:123]
  ds_read_b64_tr_b16 v[182:183], v17 offset:1024
  v_mfma_f32_16x16x32_bf16 v[116:119], v[204:207], a[124:127], v[116:119]
  ds_read_b128 v[128:131], v20 offset:0
  v_mfma_f32_16x16x32_bf16 v[112:115], v[204:207], a[120:123], v[112:115]
  s_waitcnt lgkmcnt(4)
  ds_read_b128 v[132:135], v20 offset:2048
  v_mfma_f32_16x16x32_bf16 v[64:67], v[176:179], a[128:131], v[64:67]
  s_waitcnt lgkmcnt(4)
  s_add_u32 m0, s9, 32768
  s_mul_i32 s10, s73, 196608
  buffer_load_dwordx4 v12, s[44:47], s10 offen offset:0 lds
  ds_read_b64_tr_b16 v[184:185], v18 offset:0
  v_mfma_f32_16x16x32_bf16 v[68:71], v[176:179], a[132:135], v[68:71]
  s_waitcnt lgkmcnt(2)
  ds_read_b64_tr_b16 v[186:187], v18 offset:1024
  v_mfma_f32_16x16x32_bf16 v[72:75], v[176:179], v[128:131], v[72:75]
  s_waitcnt lgkmcnt(2)
  v_mfma_f32_16x16x32_bf16 v[76:79], v[176:179], v[132:135], v[76:79]
  v_mfma_f32_16x16x32_bf16 v[92:95], v[180:183], v[132:135], v[92:95]
  buffer_load_dwordx4 v13, s[44:47], s10 offen offset:1024 lds
  ds_read_b64_tr_b16 v[188:189], v19 offset:0
  v_mfma_f32_16x16x32_bf16 v[88:91], v[180:183], v[128:131], v[88:91]
  ds_read_b64_tr_b16 v[190:191], v19 offset:1024
  v_mfma_f32_16x16x32_bf16 v[84:87], v[180:183], a[132:135], v[84:87]
  v_mfma_f32_16x16x32_bf16 v[80:83], v[180:183], a[128:131], v[80:83]
  s_waitcnt lgkmcnt(2)
  v_mfma_f32_16x16x32_bf16 v[96:99], v[184:187], a[128:131], v[96:99]
  buffer_load_dwordx4 v14, s[44:47], s10 offen offset:2048 lds
  ds_read_b64_tr_b16 v[192:193], v16 offset:8192
  v_mfma_f32_16x16x32_bf16 v[100:103], v[184:187], a[132:135], v[100:103]
  ds_read_b64_tr_b16 v[194:195], v16 offset:9216
  v_mfma_f32_16x16x32_bf16 v[104:107], v[184:187], v[128:131], v[104:107]
  ds_read_b128 a[136:139], v25 offset:0
  v_mfma_f32_16x16x32_bf16 v[108:111], v[184:187], v[132:135], v[108:111]
  s_waitcnt lgkmcnt(3)
  ds_read_b128 a[140:143], v25 offset:2048
  v_mfma_f32_16x16x32_bf16 v[124:127], v[188:191], v[132:135], v[124:127]
  s_add_u32 m0, s9, 98304
  s_mul_i32 s10, s65, 196608
  buffer_load_dwordx4 v12, s[44:47], s10 offen offset:0 lds
  ds_read_b64_tr_b16 v[196:197], v17 offset:8192
  v_mfma_f32_16x16x32_bf16 v[120:123], v[188:191], v[128:131], v[120:123]
  ds_read_b64_tr_b16 v[198:199], v17 offset:9216
  v_mfma_f32_16x16x32_bf16 v[116:119], v[188:191], a[132:135], v[116:119]
  ds_read_b128 v[136:139], v21 offset:0
  v_mfma_f32_16x16x32_bf16 v[112:115], v[188:191], a[128:131], v[112:115]
  s_waitcnt lgkmcnt(4)
  ds_read_b128 v[140:143], v21 offset:2048
  v_mfma_f32_16x16x32_bf16 v[64:67], v[192:195], a[136:139], v[64:67]
  s_waitcnt lgkmcnt(4)
  buffer_load_dwordx4 v13, s[44:47], s10 offen offset:1024 lds
  ds_read_b64_tr_b16 v[200:201], v18 offset:8192
  v_mfma_f32_16x16x32_bf16 v[68:71], v[192:195], a[140:143], v[68:71]
  s_waitcnt lgkmcnt(2)
  ds_read_b64_tr_b16 v[202:203], v18 offset:9216
  v_mfma_f32_16x16x32_bf16 v[72:75], v[192:195], v[136:139], v[72:75]
  s_waitcnt lgkmcnt(2)
  v_mfma_f32_16x16x32_bf16 v[76:79], v[192:195], v[140:143], v[76:79]
  v_mfma_f32_16x16x32_bf16 v[92:95], v[196:199], v[140:143], v[92:95]
  buffer_load_dwordx4 v14, s[44:47], s10 offen offset:2048 lds
  ds_read_b64_tr_b16 v[204:205], v19 offset:8192
  v_mfma_f32_16x16x32_bf16 v[88:91], v[196:199], v[136:139], v[88:91]
  ds_read_b64_tr_b16 v[206:207], v19 offset:9216
  v_mfma_f32_16x16x32_bf16 v[84:87], v[196:199], a[140:143], v[84:87]
  v_mfma_f32_16x16x32_bf16 v[80:83], v[196:199], a[136:139], v[80:83]
  s_waitcnt lgkmcnt(2)
  v_mfma_f32_16x16x32_bf16 v[96:99], v[200:203], a[136:139], v[96:99]
  s_waitcnt lgkmcnt(0) vmcnt(13)
  s_barrier
  ds_read_b64_tr_b16 v[176:177], v16 offset:16384
  v_mfma_f32_16x16x32_bf16 v[100:103], v[200:203], a[140:143], v[100:103]
  ds_read_b64_tr_b16 v[178:179], v16 offset:17408
  v_mfma_f32_16x16x32_bf16 v[104:107], v[200:203], v[136:139], v[104:107]
  ds_read_b128 a[144:147], v24 offset:16384
  v_mfma_f32_16x16x32_bf16 v[108:111], v[200:203], v[140:143], v[108:111]
  ds_read_b128 a[148:151], v24 offset:18432
  v_mfma_f32_16x16x32_bf16 v[124:127], v[204:207], v[140:143], v[124:127]
  ds_read_b64_tr_b16 v[180:181], v17 offset:16384
  v_mfma_f32_16x16x32_bf16 v[120:123], v[204:207], v[136:139], v[120:123]
  ds_read_b64_tr_b16 v[182:183], v17 offset:17408
  v_mfma_f32_16x16x32_bf16 v[116:119], v[204:207], a[140:143], v[116:119]
  ds_read_b128 v[128:131], v20 offset:16384
  v_mfma_f32_16x16x32_bf16 v[112:115], v[204:207], a[136:139], v[112:115]
  s_waitcnt lgkmcnt(4)
  ds_read_b128 v[132:135], v20 offset:18432
  v_mfma_f32_16x16x32_bf16 v[64:67], v[176:179], a[144:147], v[64:67]
  s_waitcnt lgkmcnt(4)
  s_add_u32 m0, s9, 49152
  s_mul_i32 s10, s66, 196608
  buffer_load_dwordx4 v12, s[44:47], s10 offen offset:0 lds
  ds_read_b64_tr_b16 v[184:185], v18 offset:16384
  v_mfma_f32_16x16x32_bf16 v[68:71], v[176:179], a[148:151], v[68:71]
  s_waitcnt lgkmcnt(2)
  ds_read_b64_tr_b16 v[186:187], v18 offset:17408
  v_mfma_f32_16x16x32_bf16 v[72:75], v[176:179], v[128:131], v[72:75]
  s_waitcnt lgkmcnt(2)
  v_mfma_f32_16x16x32_bf16 v[76:79], v[176:179], v[132:135], v[76:79]
  v_mfma_f32_16x16x32_bf16 v[92:95], v[180:183], v[132:135], v[92:95]
  buffer_load_dwordx4 v13, s[44:47], s10 offen offset:1024 lds
  ds_read_b64_tr_b16 v[188:189], v19 offset:16384
  v_mfma_f32_16x16x32_bf16 v[88:91], v[180:183], v[128:131], v[88:91]
  ds_read_b64_tr_b16 v[190:191], v19 offset:17408
  v_mfma_f32_16x16x32_bf16 v[84:87], v[180:183], a[148:151], v[84:87]
  v_mfma_f32_16x16x32_bf16 v[80:83], v[180:183], a[144:147], v[80:83]
  s_waitcnt lgkmcnt(2)
  v_mfma_f32_16x16x32_bf16 v[96:99], v[184:187], a[144:147], v[96:99]
  buffer_load_dwordx4 v14, s[44:47], s10 offen offset:2048 lds
  ds_read_b64_tr_b16 v[192:193], v16 offset:24576
  v_mfma_f32_16x16x32_bf16 v[100:103], v[184:187], a[148:151], v[100:103]
  ds_read_b64_tr_b16 v[194:195], v16 offset:25600
  v_mfma_f32_16x16x32_bf16 v[104:107], v[184:187], v[128:131], v[104:107]
  ds_read_b128 a[152:155], v25 offset:16384
  v_mfma_f32_16x16x32_bf16 v[108:111], v[184:187], v[132:135], v[108:111]
  s_waitcnt lgkmcnt(3)
  ds_read_b128 a[156:159], v25 offset:18432
  v_mfma_f32_16x16x32_bf16 v[124:127], v[188:191], v[132:135], v[124:127]
  s_add_u32 m0, s9, 114688
  s_mul_i32 s10, s67, 196608
  buffer_load_dwordx4 v12, s[44:47], s10 offen offset:0 lds
  ds_read_b64_tr_b16 v[196:197], v17 offset:24576
  v_mfma_f32_16x16x32_bf16 v[120:123], v[188:191], v[128:131], v[120:123]
  ds_read_b64_tr_b16 v[198:199], v17 offset:25600
  v_mfma_f32_16x16x32_bf16 v[116:119], v[188:191], a[148:151], v[116:119]
  ds_read_b128 v[136:139], v21 offset:16384
  v_mfma_f32_16x16x32_bf16 v[112:115], v[188:191], a[144:147], v[112:115]
  s_waitcnt lgkmcnt(4)
  ds_read_b128 v[140:143], v21 offset:18432
  v_mfma_f32_16x16x32_bf16 v[64:67], v[192:195], a[152:155], v[64:67]
  s_waitcnt lgkmcnt(4)
  buffer_load_dwordx4 v13, s[44:47], s10 offen offset:1024 lds
  ds_read_b64_tr_b16 v[200:201], v18 offset:24576
  v_mfma_f32_16x16x32_bf16 v[68:71], v[192:195], a[156:159], v[68:71]
  s_waitcnt lgkmcnt(2)
  ds_read_b64_tr_b16 v[202:203], v18 offset:25600
  v_mfma_f32_16x16x32_bf16 v[72:75], v[192:195], v[136:139], v[72:75]
  s_waitcnt lgkmcnt(2)
  v_mfma_f32_16x16x32_bf16 v[76:79], v[192:195], v[140:143], v[76:79]
  v_mfma_f32_16x16x32_bf16 v[92:95], v[196:199], v[140:143], v[92:95]
  buffer_load_dwordx4 v14, s[44:47], s10 offen offset:2048 lds
  ds_read_b64_tr_b16 v[204:205], v19 offset:24576
  v_mfma_f32_16x16x32_bf16 v[88:91], v[196:199], v[136:139], v[88:91]
  ds_read_b64_tr_b16 v[206:207], v19 offset:25600
  v_mfma_f32_16x16x32_bf16 v[84:87], v[196:199], a[156:159], v[84:87]
  v_mfma_f32_16x16x32_bf16 v[80:83], v[196:199], a[152:155], v[80:83]
  s_waitcnt lgkmcnt(2)
  v_mfma_f32_16x16x32_bf16 v[96:99], v[200:203], a[152:155], v[96:99]
  s_waitcnt vmcnt(13)
  s_barrier
  ds_read_b64_tr_b16 v[176:177], v44 offset:0
  ds_read_b64_tr_b16 v[178:179], v44 offset:768
  v_mfma_f32_16x16x32_bf16 v[100:103], v[200:203], a[156:159], v[100:103]
  ds_read_b64_tr_b16 v[180:181], v45 offset:0
  ds_read_b64_tr_b16 v[182:183], v45 offset:768
  v_mfma_f32_16x16x32_bf16 v[104:107], v[200:203], v[136:139], v[104:107]
  ds_read_b64_tr_b16 v[184:185], v44 offset:64
  ds_read_b64_tr_b16 v[186:187], v44 offset:832
  v_mfma_f32_16x16x32_bf16 v[108:111], v[200:203], v[140:143], v[108:111]
  s_waitcnt lgkmcnt(6)
  ds_read_b64_tr_b16 v[188:189], v45 offset:64
  ds_read_b64_tr_b16 v[190:191], v45 offset:832
  v_mfma_f32_16x16x32_bf16 v[124:127], v[204:207], v[140:143], v[124:127]
  ds_read_b64_tr_b16 v[192:193], v44 offset:128
  ds_read_b64_tr_b16 v[194:195], v44 offset:896
  v_mfma_f32_16x16x32_bf16 v[120:123], v[204:207], v[136:139], v[120:123]
  v_mfma_f32_16x16x32_bf16 v[116:119], v[204:207], a[156:159], v[116:119]
  v_mfma_f32_16x16x32_bf16 v[112:115], v[204:207], a[152:155], v[112:115]
L_R2:
  s_waitcnt lgkmcnt(8)
  v_mfma_f32_16x16x32_bf16 v[128:131], v[176:179], a[0:3], 0
  ds_read_b64_tr_b16 v[196:197], v45 offset:128
  s_add_u32 m0, s9, 0
  s_mul_i32 s10, s68, 196608
  buffer_load_dwordx4 v12, s[44:47], s10 offen offset:0 lds
  v_mfma_f32_16x16x32_bf16 v[132:135], v[176:179], a[4:7], 0
  s_waitcnt lgkmcnt(7)
  ds_read_b64_tr_b16 v[198:199], v45 offset:896
  v_mfma_f32_16x16x32_bf16 v[136:139], v[180:183], a[0:3], 0
  ds_read_b64_tr_b16 v[200:201], v44 offset:6144
  v_mfma_f32_16x16x32_bf16 v[140:143], v[180:183], a[4:7], 0
  s_waitcnt lgkmcnt(7)
  ds_read_b64_tr_b16 v[202:203], v44 offset:6912
  v_mul_f32 v64, s28, v64
  v_mul_f32 v65, s28, v65
  v_mfma_f32_16x16x32_bf16 v[144:147], v[184:187], a[0:3], 0
  ds_read_b64_tr_b16 v[204:205], v45 offset:6144
  buffer_load_dwordx4 v13, s[44:47], s10 offen offset:1024 lds
  v_mul_f32 v66, s28, v66
  v_mfma_f32_16x16x32_bf16 v[148:151], v[184:187], a[4:7], 0
  s_waitcnt lgkmcnt(7)
  ds_read_b64_tr_b16 v[206:207], v45 offset:6912
  v_mul_f32 v67, s28, v67
  v_mfma_f32_16x16x32_bf16 v[152:155], v[188:191], a[0:3], 0
  ds_read_b64_tr_b16 v[176:177], v44 offset:6208
  v_mul_f32 v80, s28, v80
  v_mfma_f32_16x16x32_bf16 v[156:159], v[188:191], a[4:7], 0
  s_waitcnt lgkmcnt(7)
  ds_read_b64_tr_b16 v[178:179], v44 offset:6976
  v_mul_f32 v81, s28, v81
  v_mfma_f32_16x16x32_bf16 v[160:163], v[192:195], a[0:3], 0
  ds_read_b64_tr_b16 v[180:181], v45 offset:6208
  buffer_load_dwordx4 v14, s[44:47], s10 offen offset:2048 lds
  v_mul_f32 v82, s28, v82
  v_mfma_f32_16x16x32_bf16 v[164:167], v[192:195], a[4:7], 0
  s_waitcnt lgkmcnt(7)
  ds_read_b64_tr_b16 v[182:183], v45 offset:6976
  v_mul_f32 v83, s28, v83
  v_mfma_f32_16x16x32_bf16 v[168:171], v[196:199], a[0:3], 0
  ds_read_b64_tr_b16 v[184:185], v44 offset:6272
  v_mul_f32 v68, s28, v68
  v_mfma_f32_16x16x32_bf16 v[172:175], v[196:199], a[4:7], 0
  s_waitcnt lgkmcnt(7)
  ds_read_b64_tr_b16 v[186:187], v44 offset:7040
  v_mul_f32 v69, s28, v69
  v_mul_f32 v70, s28, v70
  v_mfma_f32_16x16x32_bf16 v[128:131], v[200:203], a[8:11], v[128:131]
  ds_read_b64_tr_b16 v[188:189], v45 offset:6272
  s_add_u32 m0, s9, 65536
  s_mul_i32 s10, s69, 196608
  buffer_load_dwordx4 v12, s[44:47], s10 offen offset:0 lds
  v_mul_f32 v71, s28, v71
  v_mfma_f32_16x16x32_bf16 v[132:135], v[200:203], a[12:15], v[132:135]
  s_waitcnt lgkmcnt(7)
  ds_read_b64_tr_b16 v[190:191], v45 offset:7040
  v_mul_f32 v84, s28, v84
  v_mfma_f32_16x16x32_bf16 v[136:139], v[204:207], a[8:11], v[136:139]
  ds_read_b64_tr_b16 v[192:193], v44 offset:12288
  v_mul_f32 v85, s28, v85
  v_mfma_f32_16x16x32_bf16 v[140:143], v[204:207], a[12:15], v[140:143]
  s_waitcnt lgkmcnt(7)
  ds_read_b64_tr_b16 v[194:195], v44 offset:13056
  v_mul_f32 v86, s28, v86
  v_mfma_f32_16x16x32_bf16 v[144:147], v[176:179], a[8:11], v[144:147]
  ds_read_b64_tr_b16 v[196:197], v45 offset:12288
  buffer_load_dwordx4 v13, s[44:47], s10 offen offset:1024 lds
  v_mul_f32 v87, s28, v87
  v_mfma_f32_16x16x32_bf16 v[148:151], v[176:179], a[12:15], v[148:151]
  s_waitcnt lgkmcnt(7)
  ds_read_b64_tr_b16 v[198:199], v45 offset:13056
  v_mul_f32 v72, s28, v72
  v_mfma_f32_16x16x32_bf16 v[152:155], v[180:183], a[8:11], v[152:155]
  ds_read_b64_tr_b16 v[200:201], v44 offset:12352
  v_mul_f32 v73, s28, v73
  v_mfma_f32_16x16x32_bf16 v[156:159], v[180:183], a[12:15], v[156:159]
  s_waitcnt lgkmcnt(7)
  ds_read_b64_tr_b16 v[202:203], v44 offset:13120
  v_mul_f32 v74, s28, v74
  v_mul_f32 v75, s28, v75
  v_mfma_f32_16x16x32_bf16 v[160:163], v[184:187], a[8:11], v[160:163]
  ds_read_b64_tr_b16 v[204:205], v45 offset:12352
  buffer_load_dwordx4 v14, s[44:47], s10 offen offset:2048 lds
  v_mul_f32 v88, s28, v88
  v_mfma_f32_16x16x32_bf16 v[164:167], v[184:187], a[12:15], v[164:167]
  s_waitcnt lgkmcnt(7)
  ds_read_b64_tr_b16 v[206:207], v45 offset:13120
  v_mul_f32 v89, s28, v89
  v_mfma_f32_16x16x32_bf16 v[168:171], v[188:191], a[8:11], v[168:171]
  ds_read_b64_tr_b16 v[176:177], v44 offset:12416
  v_mul_f32 v90, s28, v90
  v_mfma_f32_16x16x32_bf16 v[172:175], v[188:191], a[12:15], v[172:175]
  s_waitcnt lgkmcnt(7)
  ds_read_b64_tr_b16 v[178:179], v44 offset:13184
  v_mul_f32 v91, s28, v91
  v_mfma_f32_16x16x32_bf16 v[128:131], v[192:195], a[128:131], v[128:131]
  ds_read_b64_tr_b16 v[180:181], v45 offset:12416
  v_mul_f32 v76, s28, v76
  v_mfma_f32_16x16x32_bf16 v[132:135], v[192:195], a[132:135], v[132:135]
  s_waitcnt lgkmcnt(7)
  ds_read_b64_tr_b16 v[182:183], v45 offset:13184
  v_mul_f32 v77, s28, v77
  v_mfma_f32_16x16x32_bf16 v[136:139], v[196:199], a[128:131], v[136:139]
  ds_read_b64_tr_b16 v[184:185], v44 offset:18432
  v_mul_f32 v78, s28, v78
  v_mfma_f32_16x16x32_bf16 v[140:143], v[196:199], a[132:135], v[140:143]
  s_waitcnt lgkmcnt(7)
  ds_read_b64_tr_b16 v[186:187], v44 offset:19200
  v_mul_f32 v79, s28, v79
  v_mul_f32 v92, s28, v92
  v_mfma_f32_16x16x32_bf16 v[144:147], v[200:203], a[128:131], v[144:147]
  ds_read_b64_tr_b16 v[188:189], v45 offset:18432
  v_mul_f32 v93, s28, v93
  v_mfma_f32_16x16x32_bf16 v[148:151], v[200:203], a[132:135], v[148:151]
  s_waitcnt lgkmcnt(7)
  ds_read_b64_tr_b16 v[190:191], v45 offset:19200
  v_mul_f32 v94, s28, v94
  v_mfma_f32_16x16x32_bf16 v[152:155], v[204:207], a[128:131], v[152:155]
  ds_read_b64_tr_b16 v[192:193], v44 offset:18496
  v_mul_f32 v95, s28, v95
  v_mfma_f32_16x16x32_bf16 v[156:159], v[204:207], a[132:135], v[156:159]
  s_waitcnt lgkmcnt(7)
  ds_read_b64_tr_b16 v[194:195], v44 offset:19264
  v_mul_f32 v96, s28, v96
  v_mfma_f32_16x16x32_bf16 v[160:163], v[176:179], a[128:131], v[160:163]
  ds_read_b64_tr_b16 v[196:197], v45 offset:18496
  v_mul_f32 v97, s28, v97
  v_mfma_f32_16x16x32_bf16 v[164:167], v[176:179], a[132:135], v[164:167]
  s_waitcnt lgkmcnt(7)
  ds_read_b64_tr_b16 v[198:199], v45 offset:19264
  v_mul_f32 v98, s28, v98
  v_mfma_f32_16x16x32_bf16 v[168:171], v[180:183], a[128:131], v[168:171]
  ds_read_b64_tr_b16 v[200:201], v44 offset:18560
  v_mul_f32 v99, s28, v99
  v_mfma_f32_16x16x32_bf16 v[172:175], v[180:183], a[132:135], v[172:175]
  s_waitcnt lgkmcnt(7)
  ds_read_b64_tr_b16 v[202:203], v44 offset:19328
  v_mul_f32 v112, s28, v112
  v_mul_f32 v113, s28, v113
  v_mfma_f32_16x16x32_bf16 v[128:131], v[184:187], a[136:139], v[128:131]
  ds_read_b64_tr_b16 v[204:205], v45 offset:18560
  v_mul_f32 v114, s28, v114
  v_mfma_f32_16x16x32_bf16 v[132:135], v[184:187], a[140:143], v[132:135]
  s_waitcnt lgkmcnt(7)
  ds_read_b64_tr_b16 v[206:207], v45 offset:19328
  v_mul_f32 v115, s28, v115
  v_mfma_f32_16x16x32_bf16 v[136:139], v[188:191], a[136:139], v[136:139]
  s_waitcnt vmcnt(12)
  s_barrier
  ds_read_b64_tr_b16 v[176:177], v40 offset:32768
  v_mul_f32 v100, s28, v100
  v_mfma_f32_16x16x32_bf16 v[140:143], v[188:191], a[140:143], v[140:143]
  s_waitcnt lgkmcnt(7)
  ds_read_b64_tr_b16 v[178:179], v40 offset:33536
  v_mul_f32 v101, s28, v101
  v_mfma_f32_16x16x32_bf16 v[144:147], v[192:195], a[136:139], v[144:147]
  ds_read_b64_tr_b16 v[180:181], v41 offset:32768
  s_add_u32 m0, s9, 16384
  s_mul_i32 s10, s70, 196608
  buffer_load_dwordx4 v12, s[44:47], s10 offen offset:0 lds
  v_mul_f32 v102, s28, v102
  v_cvt_pk_bf16_f32 v224, v64, v65
  v_cvt_pk_bf16_f32 v225, v66, v67
  v_mfma_f32_16x16x32_bf16 v[148:151], v[192:195], a[140:143], v[148:151]
  s_waitcnt lgkmcnt(7)
  ds_read_b64_tr_b16 v[182:183], v41 offset:33536
  v_mul_f32 v103, s28, v103
  v_cvt_pk_bf16_f32 v226, v80, v81
  v_mfma_f32_16x16x32_bf16 v[152:155], v[196:199], a[136:139], v[152:155]
  ds_read_b64_tr_b16 v[184:185], v40 offset:32832
  v_mul_f32 v116, s28, v116
  v_cvt_pk_bf16_f32 v227, v82, v83
  v_mfma_f32_16x16x32_bf16 v[156:159], v[196:199], a[140:143], v[156:159]
  s_waitcnt lgkmcnt(7)
  ds_read_b64_tr_b16 v[186:187], v40 offset:33600
  buffer_load_dwordx4 v13, s[44:47], s10 offen offset:1024 lds
  v_mul_f32 v117, s28, v117
  v_mul_f32 v118, s28, v118
  v_cvt_pk_bf16_f32 v228, v68, v69
  v_mfma_f32_16x16x32_bf16 v[160:163], v[200:203], a[136:139], v[160:163]
  ds_read_b64_tr_b16 v[188:189], v41 offset:32832
  v_mul_f32 v119, s28, v119
  v_cvt_pk_bf16_f32 v229, v70, v71
  v_mfma_f32_16x16x32_bf16 v[164:167], v[200:203], a[140:143], v[164:167]
  s_waitcnt lgkmcnt(7)
  ds_read_b64_tr_b16 v[190:191], v41 offset:33600
  v_mul_f32 v104, s28, v104
  v_permlane16_swap_b32 v224, v226
  v_mfma_f32_16x16x32_bf16 v[168:171], v[204:207], a[136:139], v[168:171]
  ds_read_b64_tr_b16 v[192:193], v40 offset:32896
  buffer_load_dwordx4 v14, s[44:47], s10 offen offset:2048 lds
  v_mul_f32 v105, s28, v105
  v_permlane16_swap_b32 v225, v227
  v_mfma_f32_16x16x32_bf16 v[172:175], v[204:207], a[140:143], v[172:175]
  s_waitcnt lgkmcnt(7)
  ds_read_b64_tr_b16 v[194:195], v40 offset:33664
  buffer_store_dwordx4 v[224:227], v27, s[48:51], 0 offen offset:0 sc1
  v_mul_f32 v106, s28, v106
  v_mfma_f32_16x16x32_bf16 v[128:131], v[176:179], a[144:147], v[128:131]
  ds_read_b64_tr_b16 v[196:197], v41 offset:32896
  v_mul_f32 v107, s28, v107
  v_cvt_pk_bf16_f32 v230, v84, v85
  v_mfma_f32_16x16x32_bf16 v[132:135], v[176:179], a[148:151], v[132:135]
  s_waitcnt lgkmcnt(7)
  ds_read_b64_tr_b16 v[198:199], v41 offset:33664
  v_mul_f32 v120, s28, v120
  v_cvt_pk_bf16_f32 v231, v86, v87
  v_mfma_f32_16x16x32_bf16 v[136:139], v[180:183], a[144:147], v[136:139]
  ds_read_b64_tr_b16 v[200:201], v40 offset:38912
  s_add_u32 m0, s9, 81920
  s_mul_i32 s10, s71, 196608
  buffer_load_dwordx4 v12, s[44:47], s10 offen offset:0 lds
  v_mul_f32 v121, s28, v121
  v_cvt_pk_bf16_f32 v232, v72, v73
  v_mfma_f32_16x16x32_bf16 v[140:143], v[180:183], a[148:151], v[140:143]
  s_waitcnt lgkmcnt(7)
  ds_read_b64_tr_b16 v[202:203], v40 offset:39680
  v_mul_f32 v122, s28, v122
  v_mul_f32 v123, s28, v123
  v_cvt_pk_bf16_f32 v233, v74, v75
  v_mfma_f32_16x16x32_bf16 v[144:147], v[184:187], a[144:147], v[144:147]
  ds_read_b64_tr_b16 v[204:205], v41 offset:38912
  v_mul_f32 v108, s28, v108
  v_permlane16_swap_b32 v228, v230
  v_mfma_f32_16x16x32_bf16 v[148:151], v[184:187], a[148:151], v[148:151]
  s_waitcnt lgkmcnt(7)
  ds_read_b64_tr_b16 v[206:207], v41 offset:39680
  buffer_load_dwordx4 v13, s[44:47], s10 offen offset:1024 lds
  v_mul_f32 v109, s28, v109
  v_permlane16_swap_b32 v229, v231
  v_mfma_f32_16x16x32_bf16 v[152:155], v[188:191], a[144:147], v[152:155]
  ds_read_b64_tr_b16 v[176:177], v40 offset:38976
  buffer_store_dwordx4 v[228:231], v27, s[48:51], 0 offen offset:256 sc1
  v_mul_f32 v110, s28, v110
  v_mfma_f32_16x16x32_bf16 v[156:159], v[188:191], a[148:151], v[156:159]
  s_waitcnt lgkmcnt(7)
  ds_read_b64_tr_b16 v[178:179], v40 offset:39744
  v_mul_f32 v111, s28, v111
  v_cvt_pk_bf16_f32 v234, v88, v89
  v_mfma_f32_16x16x32_bf16 v[160:163], v[192:195], a[144:147], v[160:163]
  ds_read_b64_tr_b16 v[180:181], v41 offset:38976
  buffer_load_dwordx4 v14, s[44:47], s10 offen offset:2048 lds
  v_mul_f32 v124, s28, v124
  v_cvt_pk_bf16_f32 v235, v90, v91
  v_mfma_f32_16x16x32_bf16 v[164:167], v[192:195], a[148:151], v[164:167]
  s_waitcnt lgkmcnt(7)
  ds_read_b64_tr_b16 v[182:183], v41 offset:39744
  v_mul_f32 v125, s28, v125
  v_cvt_pk_bf16_f32 v236, v76, v77
  v_mfma_f32_16x16x32_bf16 v[168:171], v[196:199], a[144:147], v[168:171]
  ds_read_b64_tr_b16 v[184:185], v40 offset:39040
  v_mul_f32 v126, s28, v126
  v_cvt_pk_bf16_f32 v237, v78, v79
  v_mfma_f32_16x16x32_bf16 v[172:175], v[196:199], a[148:151], v[172:175]
  s_waitcnt lgkmcnt(7)
  ds_read_b64_tr_b16 v[186:187], v40 offset:39808
  v_mul_f32 v127, s28, v127
  v_permlane16_swap_b32 v232, v234
  v_mfma_f32_16x16x32_bf16 v[128:131], v[200:203], a[152:155], v[128:131]
  ds_read_b64_tr_b16 v[188:189], v41 offset:39040
  v_permlane16_swap_b32 v233, v235
  v_mfma_f32_16x16x32_bf16 v[132:135], v[200:203], a[156:159], v[132:135]
  s_waitcnt lgkmcnt(7)
  ds_read_b64_tr_b16 v[190:191], v41 offset:39808
  buffer_store_dwordx4 v[232:235], v26, s[48:51], 0 offen offset:0 sc1
  v_mfma_f32_16x16x32_bf16 v[136:139], v[204:207], a[152:155], v[136:139]
  ds_read_b64_tr_b16 v[192:193], v42 offset:32768
  v_cvt_pk_bf16_f32 v238, v92, v93
  v_mfma_f32_16x16x32_bf16 v[140:143], v[204:207], a[156:159], v[140:143]
  s_waitcnt lgkmcnt(7)
  ds_read_b64_tr_b16 v[194:195], v42 offset:33536
  v_cvt_pk_bf16_f32 v239, v94, v95
  v_mfma_f32_16x16x32_bf16 v[144:147], v[176:179], a[152:155], v[144:147]
  ds_read_b64_tr_b16 v[196:197], v43 offset:32768
  v_cvt_pk_bf16_f32 v224, v96, v97
  v_mfma_f32_16x16x32_bf16 v[148:151], v[176:179], a[156:159], v[148:151]
  s_waitcnt lgkmcnt(7)
  ds_read_b64_tr_b16 v[198:199], v43 offset:33536
  v_cvt_pk_bf16_f32 v225, v98, v99
  v_mfma_f32_16x16x32_bf16 v[152:155], v[180:183], a[152:155], v[152:155]
  ds_read_b64_tr_b16 v[200:201], v42 offset:32832
  v_permlane16_swap_b32 v236, v238
  v_mfma_f32_16x16x32_bf16 v[156:159], v[180:183], a[156:159], v[156:159]
  s_waitcnt lgkmcnt(7)
  ds_read_b64_tr_b16 v[202:203], v42 offset:33600
  v_permlane16_swap_b32 v237, v239
  v_mfma_f32_16x16x32_bf16 v[160:163], v[184:187], a[152:155], v[160:163]
  ds_read_b64_tr_b16 v[204:205], v43 offset:32832
  buffer_store_dwordx4 v[236:239], v26, s[48:51], 0 offen offset:256 sc1
  v_cvt_pk_bf16_f32 v226, v112, v113
  v_mfma_f32_16x16x32_bf16 v[164:167], v[184:187], a[156:159], v[164:167]
  s_waitcnt lgkmcnt(7)
  ds_read_b64_tr_b16 v[206:207], v43 offset:33600
  v_cvt_pk_bf16_f32 v227, v114, v115
  v_mfma_f32_16x16x32_bf16 v[168:171], v[188:191], a[152:155], v[168:171]
  ds_read_b64_tr_b16 v[176:177], v42 offset:32896
  v_cvt_pk_bf16_f32 v228, v100, v101
  v_mfma_f32_16x16x32_bf16 v[172:175], v[188:191], a[156:159], v[172:175]
  s_waitcnt lgkmcnt(7)
  ds_read_b64_tr_b16 v[178:179], v42 offset:33664
  v_cvt_pk_bf16_f32 v229, v102, v103
  v_mfma_f32_16x16x32_bf16 v[128:131], v[192:195], a[16:19], v[128:131]
  ds_read_b64_tr_b16 v[180:181], v43 offset:32896
  v_permlane16_swap_b32 v224, v226
  v_mfma_f32_16x16x32_bf16 v[132:135], v[192:195], a[20:23], v[132:135]
  s_waitcnt lgkmcnt(7)
  ds_read_b64_tr_b16 v[182:183], v43 offset:33664
  v_permlane16_swap_b32 v225, v227
  v_mfma_f32_16x16x32_bf16 v[136:139], v[196:199], a[16:19], v[136:139]
  ds_read_b64_tr_b16 v[184:185], v42 offset:38912
  buffer_store_dwordx4 v[224:227], v27, s[48:51], s30 offen offset:0 sc1
  v_mfma_f32_16x16x32_bf16 v[140:143], v[196:199], a[20:23], v[140:143]
  s_waitcnt lgkmcnt(7)
  ds_read_b64_tr_b16 v[186:187], v42 offset:39680
  v_cvt_pk_bf16_f32 v230, v116, v117
  v_mfma_f32_16x16x32_bf16 v[144:147], v[200:203], a[16:19], v[144:147]
  ds_read_b64_tr_b16 v[188:189], v43 offset:38912
  v_cvt_pk_bf16_f32 v231, v118, v119
  v_mfma_f32_16x16x32_bf16 v[148:151], v[200:203], a[20:23], v[148:151]
  s_waitcnt lgkmcnt(7)
  ds_read_b64_tr_b16 v[190:191], v43 offset:39680
  v_cvt_pk_bf16_f32 v232, v104, v105
  v_mfma_f32_16x16x32_bf16 v[152:155], v[204:207], a[16:19], v[152:155]
  ds_read_b64_tr_b16 v[192:193], v42 offset:38976
  v_cvt_pk_bf16_f32 v233, v106, v107
  v_mfma_f32_16x16x32_bf16 v[156:159], v[204:207], a[20:23], v[156:159]
  s_waitcnt lgkmcnt(7)
  ds_read_b64_tr_b16 v[194:195], v42 offset:39744
  v_permlane16_swap_b32 v228, v230
  v_mfma_f32_16x16x32_bf16 v[160:163], v[176:179], a[16:19], v[160:163]
  ds_read_b64_tr_b16 v[196:197], v43 offset:38976
  v_permlane16_swap_b32 v229, v231
  v_mfma_f32_16x16x32_bf16 v[164:167], v[176:179], a[20:23], v[164:167]
  s_waitcnt lgkmcnt(7)
  ds_read_b64_tr_b16 v[198:199], v43 offset:39744
  buffer_store_dwordx4 v[228:231], v27, s[48:51], s30 offen offset:256 sc1
  v_mfma_f32_16x16x32_bf16 v[168:171], v[180:183], a[16:19], v[168:171]
  ds_read_b64_tr_b16 v[200:201], v42 offset:39040
  v_cvt_pk_bf16_f32 v234, v120, v121
  v_mfma_f32_16x16x32_bf16 v[172:175], v[180:183], a[20:23], v[172:175]
  s_waitcnt lgkmcnt(7)
  ds_read_b64_tr_b16 v[202:203], v42 offset:39808
  v_cvt_pk_bf16_f32 v235, v122, v123
  v_mfma_f32_16x16x32_bf16 v[128:131], v[184:187], a[24:27], v[128:131]
  ds_read_b64_tr_b16 v[204:205], v43 offset:39040
  buffer_load_dword v15, v33, s[48:51], 0 offen sc1
  v_cvt_pk_bf16_f32 v236, v108, v109
  v_mfma_f32_16x16x32_bf16 v[132:135], v[184:187], a[28:31], v[132:135]
  s_waitcnt lgkmcnt(7)
  ds_read_b64_tr_b16 v[206:207], v43 offset:39808
  v_cvt_pk_bf16_f32 v237, v110, v111
  v_mfma_f32_16x16x32_bf16 v[136:139], v[188:191], a[24:27], v[136:139]
  s_waitcnt vmcnt(19)
  s_barrier
  ds_read_b64_tr_b16 v[176:177], v40 offset:49152
  v_permlane16_swap_b32 v232, v234
  v_mfma_f32_16x16x32_bf16 v[140:143], v[188:191], a[28:31], v[140:143]
  s_waitcnt lgkmcnt(7)
  ds_read_b64_tr_b16 v[178:179], v40 offset:49920
  v_permlane16_swap_b32 v233, v235
  v_mfma_f32_16x16x32_bf16 v[144:147], v[192:195], a[24:27], v[144:147]
  ds_read_b64_tr_b16 v[180:181], v41 offset:49152
  buffer_store_dwordx4 v[232:235], v26, s[48:51], s30 offen offset:0 sc1
  v_mfma_f32_16x16x32_bf16 v[148:151], v[192:195], a[28:31], v[148:151]
  s_waitcnt lgkmcnt(7)
  ds_read_b64_tr_b16 v[182:183], v41 offset:49920
  v_cvt_pk_bf16_f32 v238, v124, v125
  v_mfma_f32_16x16x32_bf16 v[152:155], v[196:199], a[24:27], v[152:155]
  ds_read_b64_tr_b16 v[184:185], v40 offset:49216
  v_cvt_pk_bf16_f32 v239, v126, v127
  v_mfma_f32_16x16x32_bf16 v[156:159], v[196:199], a[28:31], v[156:159]
  s_waitcnt lgkmcnt(7)
  ds_read_b64_tr_b16 v[186:187], v40 offset:49984
  v_permlane16_swap_b32 v236, v238
  v_mfma_f32_16x16x32_bf16 v[160:163], v[200:203], a[24:27], v[160:163]
  ds_read_b64_tr_b16 v[188:189], v41 offset:49216
  v_permlane16_swap_b32 v237, v239
  v_mfma_f32_16x16x32_bf16 v[164:167], v[200:203], a[28:31], v[164:167]
  s_waitcnt lgkmcnt(7)
  ds_read_b64_tr_b16 v[190:191], v41 offset:49984
  buffer_store_dwordx4 v[236:239], v26, s[48:51], s30 offen offset:256 sc1
  v_mfma_f32_16x16x32_bf16 v[168:171], v[204:207], a[24:27], v[168:171]
  ds_read_b64_tr_b16 v[192:193], v40 offset:49280
  v_mfma_f32_16x16x32_bf16 v[172:175], v[204:207], a[28:31], v[172:175]
  s_waitcnt lgkmcnt(7)
  ds_read_b64_tr_b16 v[194:195], v40 offset:50048
  v_mfma_f32_16x16x32_bf16 v[128:131], v[176:179], a[32:35], v[128:131]
  ds_read_b64_tr_b16 v[196:197], v41 offset:49280
  v_mfma_f32_16x16x32_bf16 v[132:135], v[176:179], a[36:39], v[132:135]
  s_waitcnt lgkmcnt(7)
  ds_read_b64_tr_b16 v[198:199], v41 offset:50048
  v_mfma_f32_16x16x32_bf16 v[136:139], v[180:183], a[32:35], v[136:139]
  ds_read_b64_tr_b16 v[200:201], v40 offset:55296
  v_lshlrev_b32 v60, 2, v3
  v_mfma_f32_16x16x32_bf16 v[140:143], v[180:183], a[36:39], v[140:143]
  s_waitcnt lgkmcnt(7)
  ds_read_b64_tr_b16 v[202:203], v40 offset:56064
  v_mfma_f32_16x16x32_bf16 v[144:147], v[184:187], a[32:35], v[144:147]
  ds_read_b64_tr_b16 v[204:205], v41 offset:55296
  v_sub_u32 v60, v2, v60
  v_mfma_f32_16x16x32_bf16 v[148:151], v[184:187], a[36:39], v[148:151]
  s_waitcnt lgkmcnt(7)
  ds_read_b64_tr_b16 v[206:207], v41 offset:56064
  v_mfma_f32_16x16x32_bf16 v[152:155], v[188:191], a[32:35], v[152:155]
  ds_read_b64_tr_b16 v[176:177], v40 offset:55360
  v_subrev_u32 v61, 0, v60
  v_mfma_f32_16x16x32_bf16 v[156:159], v[188:191], a[36:39], v[156:159]
  s_waitcnt lgkmcnt(7)
  ds_read_b64_tr_b16 v[178:179], v40 offset:56128
  v_mfma_f32_16x16x32_bf16 v[160:163], v[192:195], a[32:35], v[160:163]
  ds_read_b64_tr_b16 v[180:181], v41 offset:55360
  v_ashrrev_i32 v61, 31, v61
  v_mfma_f32_16x16x32_bf16 v[164:167], v[192:195], a[36:39], v[164:167]
  s_waitcnt lgkmcnt(7)
  ds_read_b64_tr_b16 v[182:183], v41 offset:56128
  v_mfma_f32_16x16x32_bf16 v[168:171], v[196:199], a[32:35], v[168:171]
  ds_read_b64_tr_b16 v[184:185], v40 offset:55424
  v_and_b32 v80, 0xff800000, v61
  v_mfma_f32_16x16x32_bf16 v[172:175], v[196:199], a[36:39], v[172:175]
  s_waitcnt lgkmcnt(7)
  ds_read_b64_tr_b16 v[186:187], v40 offset:56192
  v_mfma_f32_16x16x32_bf16 v[128:131], v[200:203], a[40:43], v[128:131]
  ds_read_b64_tr_b16 v[188:189], v41 offset:55424
  v_xor_b32 v64, 0xff800000, v80
  v_mfma_f32_16x16x32_bf16 v[132:135], v[200:203], a[44:47], v[132:135]
  s_waitcnt lgkmcnt(7)
  ds_read_b64_tr_b16 v[190:191], v41 offset:56192
  v_mfma_f32_16x16x32_bf16 v[136:139], v[204:207], a[40:43], v[136:139]
  ds_read_b64_tr_b16 v[192:193], v42 offset:49152
  v_subrev_u32 v61, 1, v60
  v_mfma_f32_16x16x32_bf16 v[140:143], v[204:207], a[44:47], v[140:143]
  s_waitcnt lgkmcnt(7)
  ds_read_b64_tr_b16 v[194:195], v42 offset:49920
  v_mfma_f32_16x16x32_bf16 v[144:147], v[176:179], a[40:43], v[144:147]
  ds_read_b64_tr_b16 v[196:197], v43 offset:49152
  v_ashrrev_i32 v61, 31, v61
  v_mfma_f32_16x16x32_bf16 v[148:151], v[176:179], a[44:47], v[148:151]
  s_waitcnt lgkmcnt(7)
  ds_read_b64_tr_b16 v[198:199], v43 offset:49920
  v_mfma_f32_16x16x32_bf16 v[152:155], v[180:183], a[40:43], v[152:155]
  ds_read_b64_tr_b16 v[200:201], v42 offset:49216
  v_and_b32 v81, 0xff800000, v61
  v_mfma_f32_16x16x32_bf16 v[156:159], v[180:183], a[44:47], v[156:159]
  s_waitcnt lgkmcnt(7)
  ds_read_b64_tr_b16 v[202:203], v42 offset:49984
  v_mfma_f32_16x16x32_bf16 v[160:163], v[184:187], a[40:43], v[160:163]
  ds_read_b64_tr_b16 v[204:205], v43 offset:49216
  v_xor_b32 v65, 0xff800000, v81
  v_mfma_f32_16x16x32_bf16 v[164:167], v[184:187], a[44:47], v[164:167]
  s_waitcnt lgkmcnt(7)
  ds_read_b64_tr_b16 v[206:207], v43 offset:49984
  v_mfma_f32_16x16x32_bf16 v[168:171], v[188:191], a[40:43], v[168:171]
  ds_read_b64_tr_b16 v[176:177], v42 offset:49280
  v_subrev_u32 v61, 2, v60
  v_mfma_f32_16x16x32_bf16 v[172:175], v[188:191], a[44:47], v[172:175]
  s_waitcnt lgkmcnt(7)
  ds_read_b64_tr_b16 v[178:179], v42 offset:50048
  v_mfma_f32_16x16x32_bf16 v[128:131], v[192:195], a[48:51], v[128:131]
  ds_read_b64_tr_b16 v[180:181], v43 offset:49280
  v_mfma_f32_16x16x32_bf16 v[132:135], v[192:195], a[52:55], v[132:135]
  s_waitcnt lgkmcnt(7)
  ds_read_b64_tr_b16 v[182:183], v43 offset:50048
  v_ashrrev_i32 v61, 31, v61
  v_mfma_f32_16x16x32_bf16 v[136:139], v[196:199], a[48:51], v[136:139]
  ds_read_b64_tr_b16 v[184:185], v42 offset:55296
  v_mfma_f32_16x16x32_bf16 v[140:143], v[196:199], a[52:55], v[140:143]
  s_waitcnt lgkmcnt(7)
  ds_read_b64_tr_b16 v[186:187], v42 offset:56064
  v_and_b32 v82, 0xff800000, v61
  v_mfma_f32_16x16x32_bf16 v[144:147], v[200:203], a[48:51], v[144:147]
  ds_read_b64_tr_b16 v[188:189], v43 offset:55296
  v_accvgpr_read_b32 v4, a240
  v_mfma_f32_16x16x32_bf16 v[148:151], v[200:203], a[52:55], v[148:151]
  s_waitcnt lgkmcnt(7)
  ds_read_b64_tr_b16 v[190:191], v43 offset:56064
  v_xor_b32 v66, 0xff800000, v82
  v_mfma_f32_16x16x32_bf16 v[152:155], v[204:207], a[48:51], v[152:155]
  ds_read_b64_tr_b16 v[192:193], v42 offset:55360
  v_mfma_f32_16x16x32_bf16 v[156:159], v[204:207], a[52:55], v[156:159]
  s_waitcnt lgkmcnt(7)
  ds_read_b64_tr_b16 v[194:195], v42 offset:56128
  v_subrev_u32 v61, 3, v60
  v_mfma_f32_16x16x32_bf16 v[160:163], v[176:179], a[48:51], v[160:163]
  ds_read_b64_tr_b16 v[196:197], v43 offset:55360
  v_mfma_f32_16x16x32_bf16 v[164:167], v[176:179], a[52:55], v[164:167]
  s_waitcnt lgkmcnt(7)
  ds_read_b64_tr_b16 v[198:199], v43 offset:56128
  v_ashrrev_i32 v61, 31, v61
  v_mfma_f32_16x16x32_bf16 v[168:171], v[180:183], a[48:51], v[168:171]
  ds_read_b64_tr_b16 v[200:201], v42 offset:55424
  v_accvgpr_read_b32 v5, a241
  v_mfma_f32_16x16x32_bf16 v[172:175], v[180:183], a[52:55], v[172:175]
  ds_read_b64_tr_b16 v[202:203], v42 offset:56192
  v_and_b32 v83, 0xff800000, v61
  s_waitcnt vmcnt(2)
  v_cmp_gt_u32 vcc, 1, v15
  s_cbranch_vccnz SL_fw
OK_fw:
  s_waitcnt lgkmcnt(8)
  v_mfma_f32_16x16x32_bf16 v[128:131], v[184:187], a[56:59], v[128:131]
  ds_read_b64_tr_b16 v[204:205], v43 offset:55424
  s_mul_i32 s11, s16, 5120
  buffer_load_dwordx4 a[160:163], v31, s[48:51], s11 offen offset:0 sc1
  v_mfma_f32_16x16x32_bf16 v[132:135], v[184:187], a[60:63], v[132:135]
  s_waitcnt lgkmcnt(7)
  ds_read_b64_tr_b16 v[206:207], v43 offset:56192
  v_xor_b32 v67, 0xff800000, v83
  v_mfma_f32_16x16x32_bf16 v[136:139], v[188:191], a[56:59], v[136:139]
  s_barrier
  ds_read_b64_tr_b16 v[176:177], v40 offset:0
  v_mfma_f32_16x16x32_bf16 v[140:143], v[188:191], a[60:63], v[140:143]
  s_waitcnt lgkmcnt(7)
  ds_read_b64_tr_b16 v[178:179], v40 offset:768
  v_subrev_u32 v61, 8, v60
  v_mfma_f32_16x16x32_bf16 v[144:147], v[192:195], a[56:59], v[144:147]
  ds_read_b64_tr_b16 v[180:181], v41 offset:0
  buffer_load_dwordx4 a[164:167], v31, s[48:51], s11 offen offset:1024 sc1
  v_accvgpr_read_b32 v6, a242
  v_mfma_f32_16x16x32_bf16 v[148:151], v[192:195], a[60:63], v[148:151]
  s_waitcnt lgkmcnt(7)
  ds_read_b64_tr_b16 v[182:183], v41 offset:768
  v_ashrrev_i32 v61, 31, v61
  v_mfma_f32_16x16x32_bf16 v[152:155], v[196:199], a[56:59], v[152:155]
  ds_read_b64_tr_b16 v[184:185], v40 offset:64
  v_mfma_f32_16x16x32_bf16 v[156:159], v[196:199], a[60:63], v[156:159]
  s_waitcnt lgkmcnt(7)
  ds_read_b64_tr_b16 v[186:187], v40 offset:832
  v_and_b32 v84, 0xff800000, v61
  v_mfma_f32_16x16x32_bf16 v[160:163], v[200:203], a[56:59], v[160:163]
  ds_read_b64_tr_b16 v[188:189], v41 offset:64
  v_mfma_f32_16x16x32_bf16 v[164:167], v[200:203], a[60:63], v[164:167]
  s_waitcnt lgkmcnt(7)
  ds_read_b64_tr_b16 v[190:191], v41 offset:832
  buffer_load_dwordx4 a[168:171], v31, s[48:51], s11 offen offset:2048 sc1
  v_xor_b32 v68, 0xff800000, v84
  v_mfma_f32_16x16x32_bf16 v[168:171], v[204:207], a[56:59], v[168:171]
  ds_read_b64_tr_b16 v[192:193], v40 offset:128
  v_mfma_f32_16x16x32_bf16 v[172:175], v[204:207], a[60:63], v[172:175]
  s_waitcnt lgkmcnt(7)
  ds_read_b64_tr_b16 v[194:195], v40 offset:896
  v_accvgpr_read_b32 v7, a243
  v_mfma_f32_16x16x32_bf16 v[128:131], v[176:179], a[64:67], v[128:131]
  ds_read_b64_tr_b16 v[196:197], v41 offset:128
  v_subrev_u32 v61, 9, v60
  v_mfma_f32_16x16x32_bf16 v[132:135], v[176:179], a[68:71], v[132:135]
  s_waitcnt lgkmcnt(7)
  ds_read_b64_tr_b16 v[198:199], v41 offset:896
  v_mfma_f32_16x16x32_bf16 v[136:139], v[180:183], a[64:67], v[136:139]
  ds_read_b64_tr_b16 v[200:201], v40 offset:6144
  buffer_load_dwordx4 a[172:175], v31, s[48:51], s11 offen offset:3072 sc1
  v_ashrrev_i32 v61, 31, v61
  v_mfma_f32_16x16x32_bf16 v[140:143], v[180:183], a[68:71], v[140:143]
  s_waitcnt lgkmcnt(7)
  ds_read_b64_tr_b16 v[202:203], v40 offset:6912
  v_mfma_f32_16x16x32_bf16 v[144:147], v[184:187], a[64:67], v[144:147]
  ds_read_b64_tr_b16 v[204:205], v41 offset:6144
  v_and_b32 v85, 0xff800000, v61
  v_mfma_f32_16x16x32_bf16 v[148:151], v[184:187], a[68:71], v[148:151]
  s_waitcnt lgkmcnt(7)
  ds_read_b64_tr_b16 v[206:207], v41 offset:6912
  v_accvgpr_read_b32 v8, a244
  v_mfma_f32_16x16x32_bf16 v[152:155], v[188:191], a[64:67], v[152:155]
  ds_read_b64_tr_b16 v[176:177], v40 offset:6208
  v_xor_b32 v69, 0xff800000, v85
  v_mfma_f32_16x16x32_bf16 v[156:159], v[188:191], a[68:71], v[156:159]
  s_waitcnt lgkmcnt(7)
  ds_read_b64_tr_b16 v[178:179], v40 offset:6976
  buffer_load_dwordx4 a[176:179], v32, s[48:51], s11 offen offset:0 sc1
  v_mfma_f32_16x16x32_bf16 v[160:163], v[192:195], a[64:67], v[160:163]
  ds_read_b64_tr_b16 v[180:181], v41 offset:6208
  v_subrev_u32 v61, 10, v60
  v_mfma_f32_16x16x32_bf16 v[164:167], v[192:195], a[68:71], v[164:167]
  s_waitcnt lgkmcnt(7)
  ds_read_b64_tr_b16 v[182:183], v41 offset:6976
  v_mfma_f32_16x16x32_bf16 v[168:171], v[196:199], a[64:67], v[168:171]
  ds_read_b64_tr_b16 v[184:185], v40 offset:6272
  s_waitcnt vmcnt(5)
  buffer_atomic_add v30, v29, s[48:51], s35 offen sc1
  v_ashrrev_i32 v61, 31, v61
  v_mfma_f32_16x16x32_bf16 v[172:175], v[196:199], a[68:71], v[172:175]
  s_waitcnt lgkmcnt(7)
  ds_read_b64_tr_b16 v[186:187], v40 offset:7040
  v_mfma_f32_16x16x32_bf16 v[128:131], v[200:203], a[72:75], v[128:131]
  ds_read_b64_tr_b16 v[188:189], v41 offset:6272
  s_mul_i32 s11, s17, 5120
  buffer_load_dwordx4 a[180:183], v31, s[48:51], s11 offen offset:0 sc1
  v_and_b32 v86, 0xff800000, v61
  v_accvgpr_read_b32 v9, a245
  v_mfma_f32_16x16x32_bf16 v[132:135], v[200:203], a[76:79], v[132:135]
  s_waitcnt lgkmcnt(7)
  ds_read_b64_tr_b16 v[190:191], v41 offset:7040
  v_mfma_f32_16x16x32_bf16 v[136:139], v[204:207], a[72:75], v[136:139]
  ds_read_b64_tr_b16 v[192:193], v42 offset:0
  v_xor_b32 v70, 0xff800000, v86
  v_mfma_f32_16x16x32_bf16 v[140:143], v[204:207], a[76:79], v[140:143]
  s_waitcnt lgkmcnt(7)
  ds_read_b64_tr_b16 v[194:195], v42 offset:768
  v_mfma_f32_16x16x32_bf16 v[144:147], v[176:179], a[72:75], v[144:147]
  ds_read_b64_tr_b16 v[196:197], v43 offset:0
  v_subrev_u32 v61, 11, v60
  v_mfma_f32_16x16x32_bf16 v[148:151], v[176:179], a[76:79], v[148:151]
  s_waitcnt lgkmcnt(7)
  ds_read_b64_tr_b16 v[198:199], v43 offset:768
  buffer_load_dwordx4 a[184:187], v31, s[48:51], s11 offen offset:1024 sc1
  v_mfma_f32_16x16x32_bf16 v[152:155], v[180:183], a[72:75], v[152:155]
  ds_read_b64_tr_b16 v[200:201], v42 offset:64
  v_ashrrev_i32 v61, 31, v61
  v_accvgpr_read_b32 v10, a246
  v_mfma_f32_16x16x32_bf16 v[156:159], v[180:183], a[76:79], v[156:159]
  s_waitcnt lgkmcnt(7)
  ds_read_b64_tr_b16 v[202:203], v42 offset:832
  v_mfma_f32_16x16x32_bf16 v[160:163], v[184:187], a[72:75], v[160:163]
  ds_read_b64_tr_b16 v[204:205], v43 offset:64
  v_and_b32 v87, 0xff800000, v61
  v_mfma_f32_16x16x32_bf16 v[164:167], v[184:187], a[76:79], v[164:167]
  s_waitcnt lgkmcnt(7)
  ds_read_b64_tr_b16 v[206:207], v43 offset:832
  v_mfma_f32_16x16x32_bf16 v[168:171], v[188:191], a[72:75], v[168:171]
  ds_read_b64_tr_b16 v[176:177], v42 offset:128
  buffer_load_dwordx4 a[188:191], v31, s[48:51], s11 offen offset:2048 sc1
  v_mfma_f32_16x16x32_bf16 v[172:175], v[188:191], a[76:79], v[172:175]
  s_waitcnt lgkmcnt(7)
  ds_read_b64_tr_b16 v[178:179], v42 offset:896
  v_xor_b32 v71, 0xff800000, v87
  v_mfma_f32_16x16x32_bf16 v[128:131], v[192:195], a[80:83], v[128:131]
  ds_read_b64_tr_b16 v[180:181], v43 offset:128
  v_accvgpr_read_b32 v11, a247
  v_mfma_f32_16x16x32_bf16 v[132:135], v[192:195], a[84:87], v[132:135]
  s_waitcnt lgkmcnt(7)
  ds_read_b64_tr_b16 v[182:183], v43 offset:896
  v_subrev_u32 v61, 16, v60
  v_mfma_f32_16x16x32_bf16 v[136:139], v[196:199], a[80:83], v[136:139]
  ds_read_b64_tr_b16 v[184:185], v42 offset:6144
  v_mfma_f32_16x16x32_bf16 v[140:143], v[196:199], a[84:87], v[140:143]
  s_waitcnt lgkmcnt(7)
  ds_read_b64_tr_b16 v[186:187], v42 offset:6912
  buffer_load_dwordx4 a[192:195], v31, s[48:51], s11 offen offset:3072 sc1
  v_ashrrev_i32 v61, 31, v61
  v_mfma_f32_16x16x32_bf16 v[144:147], v[200:203], a[80:83], v[144:147]
  ds_read_b64_tr_b16 v[188:189], v43 offset:6144
  v_mfma_f32_16x16x32_bf16 v[148:151], v[200:203], a[84:87], v[148:151]
  s_waitcnt lgkmcnt(7)
  ds_read_b64_tr_b16 v[190:191], v43 offset:6912
  v_and_b32 v88, 0xff800000, v61
  v_mfma_f32_16x16x32_bf16 v[152:155], v[204:207], a[80:83], v[152:155]
  ds_read_b64_tr_b16 v[192:193], v42 offset:6208
  v_mfma_f32_16x16x32_bf16 v[156:159], v[204:207], a[84:87], v[156:159]
  s_waitcnt lgkmcnt(7)
  ds_read_b64_tr_b16 v[194:195], v42 offset:6976
  v_xor_b32 v72, 0xff800000, v88
  v_accvgpr_read_b32 v16, a248
  v_mfma_f32_16x16x32_bf16 v[160:163], v[176:179], a[80:83], v[160:163]
  ds_read_b64_tr_b16 v[196:197], v43 offset:6208
  buffer_load_dwordx4 a[196:199], v32, s[48:51], s11 offen offset:0 sc1
  v_mfma_f32_16x16x32_bf16 v[164:167], v[176:179], a[84:87], v[164:167]
  s_waitcnt lgkmcnt(7)
  ds_read_b64_tr_b16 v[198:199], v43 offset:6976
  v_subrev_u32 v61, 17, v60
  v_mfma_f32_16x16x32_bf16 v[168:171], v[180:183], a[80:83], v[168:171]
  ds_read_b64_tr_b16 v[200:201], v42 offset:6272
  v_mfma_f32_16x16x32_bf16 v[172:175], v[180:183], a[84:87], v[172:175]
  s_waitcnt lgkmcnt(7)
  ds_read_b64_tr_b16 v[202:203], v42 offset:7040
  v_ashrrev_i32 v61, 31, v61
  v_mfma_f32_16x16x32_bf16 v[128:131], v[184:187], a[88:91], v[128:131]
  ds_read_b64_tr_b16 v[204:205], v43 offset:6272
  v_mfma_f32_16x16x32_bf16 v[132:135], v[184:187], a[92:95], v[132:135]
  s_waitcnt lgkmcnt(7)
  ds_read_b64_tr_b16 v[206:207], v43 offset:7040
  s_mul_i32 s11, s18, 5120
  buffer_load_dwordx4 a[200:203], v31, s[48:51], s11 offen offset:0 sc1
  v_and_b32 v89, 0xff800000, v61
  v_accvgpr_read_b32 v17, a249
  v_mfma_f32_16x16x32_bf16 v[136:139], v[188:191], a[88:91], v[136:139]
  s_barrier
  ds_read_b64_tr_b16 v[176:177], v40 offset:16384
  v_mfma_f32_16x16x32_bf16 v[140:143], v[188:191], a[92:95], v[140:143]
  s_waitcnt lgkmcnt(7)
  ds_read_b64_tr_b16 v[178:179], v40 offset:17152
  v_xor_b32 v73, 0xff800000, v89
  v_mfma_f32_16x16x32_bf16 v[144:147], v[192:195], a[88:91], v[144:147]
  ds_read_b64_tr_b16 v[180:181], v41 offset:16384
  v_mfma_f32_16x16x32_bf16 v[148:151], v[192:195], a[92:95], v[148:151]
  s_waitcnt lgkmcnt(7)
  ds_read_b64_tr_b16 v[182:183], v41 offset:17152
  v_subrev_u32 v61, 18, v60
  v_mfma_f32_16x16x32_bf16 v[152:155], v[196:199], a[88:91], v[152:155]
  ds_read_b64_tr_b16 v[184:185], v40 offset:16448
  buffer_load_dwordx4 a[204:207], v31, s[48:51], s11 offen offset:1024 sc1
  v_mfma_f32_16x16x32_bf16 v[156:159], v[196:199], a[92:95], v[156:159]
  s_waitcnt lgkmcnt(7)
  ds_read_b64_tr_b16 v[186:187], v40 offset:17216
  v_ashrrev_i32 v61, 31, v61
  v_mfma_f32_16x16x32_bf16 v[160:163], v[200:203], a[88:91], v[160:163]
  ds_read_b64_tr_b16 v[188:189], v41 offset:16448
  v_accvgpr_read_b32 v18, a250
  v_mfma_f32_16x16x32_bf16 v[164:167], v[200:203], a[92:95], v[164:167]
  s_waitcnt lgkmcnt(7)
  ds_read_b64_tr_b16 v[190:191], v41 offset:17216
  v_mfma_f32_16x16x32_bf16 v[168:171], v[204:207], a[88:91], v[168:171]
  ds_read_b64_tr_b16 v[192:193], v40 offset:16512
  buffer_load_dwordx4 a[208:211], v31, s[48:51], s11 offen offset:2048 sc1
  v_and_b32 v90, 0xff800000, v61
  v_mfma_f32_16x16x32_bf16 v[172:175], v[204:207], a[92:95], v[172:175]
  s_waitcnt lgkmcnt(7)
  ds_read_b64_tr_b16 v[194:195], v40 offset:17280
  v_mfma_f32_16x16x32_bf16 v[128:131], v[176:179], a[96:99], v[128:131]
  ds_read_b64_tr_b16 v[196:197], v41 offset:16512
  v_xor_b32 v74, 0xff800000, v90
  v_mfma_f32_16x16x32_bf16 v[132:135], v[176:179], a[100:103], v[132:135]
  s_waitcnt lgkmcnt(7)
  ds_read_b64_tr_b16 v[198:199], v41 offset:17280
  v_mfma_f32_16x16x32_bf16 v[136:139], v[180:183], a[96:99], v[136:139]
  ds_read_b64_tr_b16 v[200:201], v40 offset:22528
  v_subrev_u32 v61, 19, v60
  v_accvgpr_read_b32 v19, a251
  v_mfma_f32_16x16x32_bf16 v[140:143], v[180:183], a[100:103], v[140:143]
  s_waitcnt lgkmcnt(7)
  ds_read_b64_tr_b16 v[202:203], v40 offset:23296
  buffer_load_dwordx4 a[212:215], v31, s[48:51], s11 offen offset:3072 sc1
  v_mfma_f32_16x16x32_bf16 v[144:147], v[184:187], a[96:99], v[144:147]
  ds_read_b64_tr_b16 v[204:205], v41 offset:22528
  v_ashrrev_i32 v61, 31, v61
  v_mfma_f32_16x16x32_bf16 v[148:151], v[184:187], a[100:103], v[148:151]
  s_waitcnt lgkmcnt(7)
  ds_read_b64_tr_b16 v[206:207], v41 offset:23296
  v_mfma_f32_16x16x32_bf16 v[152:155], v[188:191], a[96:99], v[152:155]
  ds_read_b64_tr_b16 v[176:177], v40 offset:22592
  v_and_b32 v91, 0xff800000, v61
  v_mfma_f32_16x16x32_bf16 v[156:159], v[188:191], a[100:103], v[156:159]
  s_waitcnt lgkmcnt(7)
  ds_read_b64_tr_b16 v[178:179], v40 offset:23360
  v_mfma_f32_16x16x32_bf16 v[160:163], v[192:195], a[96:99], v[160:163]
  ds_read_b64_tr_b16 v[180:181], v41 offset:22592
  buffer_load_dwordx4 a[216:219], v32, s[48:51], s11 offen offset:0 sc1
  v_xor_b32 v75, 0xff800000, v91
  v_accvgpr_read_b32 v20, a252
  v_mfma_f32_16x16x32_bf16 v[164:167], v[192:195], a[100:103], v[164:167]
  s_waitcnt lgkmcnt(7)
  ds_read_b64_tr_b16 v[182:183], v41 offset:23360
  v_mfma_f32_16x16x32_bf16 v[168:171], v[196:199], a[96:99], v[168:171]
  ds_read_b64_tr_b16 v[184:185], v40 offset:22656
  v_subrev_u32 v61, 24, v60
  v_mfma_f32_16x16x32_bf16 v[172:175], v[196:199], a[100:103], v[172:175]
  s_waitcnt lgkmcnt(7)
  ds_read_b64_tr_b16 v[186:187], v40 offset:23424
  v_mfma_f32_16x16x32_bf16 v[128:131], v[200:203], a[104:107], v[128:131]
  ds_read_b64_tr_b16 v[188:189], v41 offset:22656
  v_ashrrev_i32 v61, 31, v61
  v_mfma_f32_16x16x32_bf16 v[132:135], v[200:203], a[108:111], v[132:135]
  s_waitcnt lgkmcnt(7)
  ds_read_b64_tr_b16 v[190:191], v41 offset:23424
  s_mul_i32 s11, s19, 5120
  buffer_load_dwordx4 a[220:223], v31, s[48:51], s11 offen offset:0 sc1
  v_mfma_f32_16x16x32_bf16 v[136:139], v[204:207], a[104:107], v[136:139]
  ds_read_b64_tr_b16 v[192:193], v42 offset:16384
  v_and_b32 v92, 0xff800000, v61
  v_mfma_f32_16x16x32_bf16 v[140:143], v[204:207], a[108:111], v[140:143]
  s_waitcnt lgkmcnt(7)
  ds_read_b64_tr_b16 v[194:195], v42 offset:17152
  v_accvgpr_read_b32 v21, a253
  v_mfma_f32_16x16x32_bf16 v[144:147], v[176:179], a[104:107], v[144:147]
  ds_read_b64_tr_b16 v[196:197], v43 offset:16384
  v_xor_b32 v76, 0xff800000, v92
  v_mfma_f32_16x16x32_bf16 v[148:151], v[176:179], a[108:111], v[148:151]
  s_waitcnt lgkmcnt(7)
  ds_read_b64_tr_b16 v[198:199], v43 offset:17152
  v_mfma_f32_16x16x32_bf16 v[152:155], v[180:183], a[104:107], v[152:155]
  ds_read_b64_tr_b16 v[200:201], v42 offset:16448
  buffer_load_dwordx4 a[224:227], v31, s[48:51], s11 offen offset:1024 sc1
  v_subrev_u32 v61, 25, v60
  v_mfma_f32_16x16x32_bf16 v[156:159], v[180:183], a[108:111], v[156:159]
  s_waitcnt lgkmcnt(7)
  ds_read_b64_tr_b16 v[202:203], v42 offset:17216
  v_mfma_f32_16x16x32_bf16 v[160:163], v[184:187], a[104:107], v[160:163]
  ds_read_b64_tr_b16 v[204:205], v43 offset:16448
  v_mfma_f32_16x16x32_bf16 v[164:167], v[184:187], a[108:111], v[164:167]
  s_waitcnt lgkmcnt(7)
  ds_read_b64_tr_b16 v[206:207], v43 offset:17216
  v_ashrrev_i32 v61, 31, v61
  v_accvgpr_read_b32 v22, a254
  v_mfma_f32_16x16x32_bf16 v[168:171], v[188:191], a[104:107], v[168:171]
  ds_read_b64_tr_b16 v[176:177], v42 offset:16512
  v_mfma_f32_16x16x32_bf16 v[172:175], v[188:191], a[108:111], v[172:175]
  s_waitcnt lgkmcnt(7)
  ds_read_b64_tr_b16 v[178:179], v42 offset:17280
  buffer_load_dwordx4 a[228:231], v31, s[48:51], s11 offen offset:2048 sc1
  v_and_b32 v93, 0xff800000, v61
  v_mfma_f32_16x16x32_bf16 v[128:131], v[192:195], a[112:115], v[128:131]
  ds_read_b64_tr_b16 v[180:181], v43 offset:16512
  v_mfma_f32_16x16x32_bf16 v[132:135], v[192:195], a[116:119], v[132:135]
  s_waitcnt lgkmcnt(7)
  ds_read_b64_tr_b16 v[182:183], v43 offset:17280
  v_xor_b32 v77, 0xff800000, v93
  v_mfma_f32_16x16x32_bf16 v[136:139], v[196:199], a[112:115], v[136:139]
  ds_read_b64_tr_b16 v[184:185], v42 offset:22528
  v_mfma_f32_16x16x32_bf16 v[140:143], v[196:199], a[116:119], v[140:143]
  s_waitcnt lgkmcnt(7)
  ds_read_b64_tr_b16 v[186:187], v42 offset:23296
  v_subrev_u32 v61, 26, v60
  v_mfma_f32_16x16x32_bf16 v[144:147], v[200:203], a[112:115], v[144:147]
  ds_read_b64_tr_b16 v[188:189], v43 offset:22528
  buffer_load_dwordx4 a[232:235], v31, s[48:51], s11 offen offset:3072 sc1
  v_mfma_f32_16x16x32_bf16 v[148:151], v[200:203], a[116:119], v[148:151]
  s_waitcnt lgkmcnt(7)
  ds_read_b64_tr_b16 v[190:191], v43 offset:23296
  v_ashrrev_i32 v61, 31, v61
  v_mfma_f32_16x16x32_bf16 v[152:155], v[204:207], a[112:115], v[152:155]
  ds_read_b64_tr_b16 v[192:193], v42 offset:22592
  v_mfma_f32_16x16x32_bf16 v[156:159], v[204:207], a[116:119], v[156:159]
  s_waitcnt lgkmcnt(7)
  ds_read_b64_tr_b16 v[194:195], v42 offset:23360
  v_and_b32 v94, 0xff800000, v61
  v_mfma_f32_16x16x32_bf16 v[160:163], v[176:179], a[112:115], v[160:163]
  ds_read_b64_tr_b16 v[196:197], v43 offset:22592
  v_mfma_f32_16x16x32_bf16 v[164:167], v[176:179], a[116:119], v[164:167]
  s_waitcnt lgkmcnt(7)
  ds_read_b64_tr_b16 v[198:199], v43 offset:23360
  buffer_load_dwordx4 a[236:239], v32, s[48:51], s11 offen offset:0 sc1
  v_xor_b32 v78, 0xff800000, v94
  v_mfma_f32_16x16x32_bf16 v[168:171], v[180:183], a[112:115], v[168:171]
  ds_read_b64_tr_b16 v[200:201], v42 offset:22656
  v_mfma_f32_16x16x32_bf16 v[172:175], v[180:183], a[116:119], v[172:175]
  s_waitcnt lgkmcnt(7)
  ds_read_b64_tr_b16 v[202:203], v42 offset:23424
  v_subrev_u32 v61, 27, v60
  v_mfma_f32_16x16x32_bf16 v[128:131], v[184:187], a[120:123], v[128:131]
  ds_read_b64_tr_b16 v[204:205], v43 offset:22656
  v_mfma_f32_16x16x32_bf16 v[132:135], v[184:187], a[124:127], v[132:135]
  s_waitcnt lgkmcnt(7)
  ds_read_b64_tr_b16 v[206:207], v43 offset:23424
  v_ashrrev_i32 v61, 31, v61
  v_mfma_f32_16x16x32_bf16 v[136:139], v[188:191], a[120:123], v[136:139]
  s_mul_i32 s11, s20, 5120
  buffer_load_dwordx4 a[0:3], v31, s[48:51], s11 offen offset:0 sc1
  v_mfma_f32_16x16x32_bf16 v[140:143], v[188:191], a[124:127], v[140:143]
  s_waitcnt lgkmcnt(6)
  v_and_b32 v95, 0xff800000, v61
  v_mfma_f32_16x16x32_bf16 v[144:147], v[192:195], a[120:123], v[144:147]
  v_mfma_f32_16x16x32_bf16 v[148:151], v[192:195], a[124:127], v[148:151]
  s_waitcnt lgkmcnt(4)
  v_xor_b32 v79, 0xff800000, v95
  v_mfma_f32_16x16x32_bf16 v[152:155], v[196:199], a[120:123], v[152:155]
  v_mfma_f32_16x16x32_bf16 v[156:159], v[196:199], a[124:127], v[156:159]
  s_waitcnt lgkmcnt(2)
  buffer_load_dwordx4 a[4:7], v31, s[48:51], s11 offen offset:1024 sc1
  v_mfma_f32_16x16x32_bf16 v[160:163], v[200:203], a[120:123], v[160:163]
  v_mfma_f32_16x16x32_bf16 v[164:167], v[200:203], a[124:127], v[164:167]
  s_waitcnt lgkmcnt(0)
  v_mfma_f32_16x16x32_bf16 v[168:171], v[204:207], a[120:123], v[168:171]
  v_mfma_f32_16x16x32_bf16 v[172:175], v[204:207], a[124:127], v[172:175]
  v_mul_f32 v208, 0xbfb8aa3b, v128
  buffer_load_dwordx4 a[8:11], v31, s[48:51], s11 offen offset:2048 sc1
  v_mul_f32 v209, 0xbfb8aa3b, v129
  v_mul_f32 v210, 0xbfb8aa3b, v130
  v_mul_f32 v211, 0xbfb8aa3b, v131
  v_exp_f32 v208, v208
  v_exp_f32 v209, v209
  v_exp_f32 v210, v210
  v_exp_f32 v211, v211
  v_add_f32 v208, 1.0, v208
  buffer_load_dwordx4 a[12:15], v31, s[48:51], s11 offen offset:3072 sc1
  v_add_f32 v209, 1.0, v209
  v_add_f32 v210, 1.0, v210
  v_add_f32 v211, 1.0, v211
  v_rcp_f32 v208, v208
  v_rcp_f32 v209, v209
  v_rcp_f32 v210, v210
  v_rcp_f32 v211, v211
  v_mul_f32 v208, v128, v208
  v_mul_f32 v209, v129, v209
  buffer_load_dwordx4 a[128:131], v32, s[48:51], s11 offen offset:0 sc1
  v_mul_f32 v210, v130, v210
  v_mul_f32 v211, v131, v211
  v_cvt_pk_bf16_f32 v224, v208, v209
  v_cvt_pk_bf16_f32 v225, v210, v211
  v_mul_f32 v212, 0xbfb8aa3b, v136
  v_mul_f32 v213, 0xbfb8aa3b, v137
  v_mul_f32 v214, 0xbfb8aa3b, v138
  v_mul_f32 v215, 0xbfb8aa3b, v139
  s_mul_i32 s11, s21, 5120
  buffer_load_dwordx4 a[132:135], v31, s[48:51], s11 offen offset:0 sc1
  v_exp_f32 v212, v212
  v_exp_f32 v213, v213
  v_exp_f32 v214, v214
  v_exp_f32 v215, v215
  v_add_f32 v212, 1.0, v212
  v_add_f32 v213, 1.0, v213
  v_add_f32 v214, 1.0, v214
  v_add_f32 v215, 1.0, v215
  v_rcp_f32 v212, v212
  buffer_load_dwordx4 a[136:139], v31, s[48:51], s11 offen offset:1024 sc1
  v_rcp_f32 v213, v213
  v_rcp_f32 v214, v214
  v_rcp_f32 v215, v215
  v_mul_f32 v212, v136, v212
  v_mul_f32 v213, v137, v213
  v_mul_f32 v214, v138, v214
  v_mul_f32 v215, v139, v215
  v_cvt_pk_bf16_f32 v226, v212, v213
  v_cvt_pk_bf16_f32 v227, v214, v215
  buffer_load_dwordx4 a[140:143], v31, s[48:51], s11 offen offset:2048 sc1
  v_mul_f32 v208, 0xbfb8aa3b, v132
  v_mul_f32 v209, 0xbfb8aa3b, v133
  v_mul_f32 v210, 0xbfb8aa3b, v134
  v_mul_f32 v211, 0xbfb8aa3b, v135
  v_permlane16_swap_b32 v224, v226
  v_permlane16_swap_b32 v225, v227
  v_exp_f32 v208, v208
  v_exp_f32 v209, v209
  buffer_load_dwordx4 a[144:147], v31, s[48:51], s11 offen offset:3072 sc1
  v_exp_f32 v210, v210
  v_exp_f32 v211, v211
  v_add_f32 v208, 1.0, v208
  v_add_f32 v209, 1.0, v209
  v_add_f32 v210, 1.0, v210
  v_add_f32 v211, 1.0, v211
  v_rcp_f32 v208, v208
  v_rcp_f32 v209, v209
  v_rcp_f32 v210, v210
  buffer_load_dword v15, v34, s[48:51], 0 offen sc1
  v_rcp_f32 v211, v211
  v_mul_f32 v208, v132, v208
  v_mul_f32 v209, v133, v209
  v_mul_f32 v210, v134, v210
  v_mul_f32 v211, v135, v211
  v_cvt_pk_bf16_f32 v228, v208, v209
  v_cvt_pk_bf16_f32 v229, v210, v211
  v_mul_f32 v212, 0xbfb8aa3b, v140
  v_mul_f32 v213, 0xbfb8aa3b, v141
  buffer_load_dwordx4 a[148:151], v32, s[48:51], s11 offen offset:0 sc1
  v_mul_f32 v214, 0xbfb8aa3b, v142
  v_mul_f32 v215, 0xbfb8aa3b, v143
  v_exp_f32 v212, v212
  v_exp_f32 v213, v213
  v_exp_f32 v214, v214
  v_exp_f32 v215, v215
  v_add_f32 v212, 1.0, v212
  v_add_f32 v213, 1.0, v213
  s_mul_i32 s11, s22, 5120
  buffer_load_dwordx4 a[152:155], v31, s[48:51], s11 offen offset:0 sc1
  v_add_f32 v214, 1.0, v214
  v_add_f32 v215, 1.0, v215
  v_rcp_f32 v212, v212
  v_rcp_f32 v213, v213
  v_rcp_f32 v214, v214
  v_rcp_f32 v215, v215
  v_mul_f32 v212, v140, v212
  v_mul_f32 v213, v141, v213
  v_mul_f32 v214, v142, v214
  buffer_load_dwordx4 a[156:159], v31, s[48:51], s11 offen offset:1024 sc1
  v_mul_f32 v215, v143, v215
  v_cvt_pk_bf16_f32 v230, v212, v213
  v_cvt_pk_bf16_f32 v231, v214, v215
  v_mul_f32 v208, 0xbfb8aa3b, v144
  v_mul_f32 v209, 0xbfb8aa3b, v145
  v_mul_f32 v210, 0xbfb8aa3b, v146
  v_mul_f32 v211, 0xbfb8aa3b, v147
  v_permlane16_swap_b32 v228, v230
  buffer_load_dwordx4 a[16:19], v31, s[48:51], s11 offen offset:2048 sc1
  v_permlane16_swap_b32 v229, v231
  v_exp_f32 v208, v208
  v_exp_f32 v209, v209
  v_exp_f32 v210, v210
  v_exp_f32 v211, v211
  v_add_f32 v208, 1.0, v208
  v_add_f32 v209, 1.0, v209
  v_add_f32 v210, 1.0, v210
  v_add_f32 v211, 1.0, v211
  buffer_load_dwordx4 a[20:23], v31, s[48:51], s11 offen offset:3072 sc1
  v_rcp_f32 v208, v208
  v_rcp_f32 v209, v209
  v_rcp_f32 v210, v210
  v_rcp_f32 v211, v211
  v_mul_f32 v208, v144, v208
  v_mul_f32 v209, v145, v209
  v_mul_f32 v210, v146, v210
  v_mul_f32 v211, v147, v211
  v_cvt_pk_bf16_f32 v232, v208, v209
  buffer_load_dwordx4 a[24:27], v32, s[48:51], s11 offen offset:0 sc1
  v_cvt_pk_bf16_f32 v233, v210, v211
  v_mul_f32 v212, 0xbfb8aa3b, v152
  v_mul_f32 v213, 0xbfb8aa3b, v153
  v_mul_f32 v214, 0xbfb8aa3b, v154
  v_mul_f32 v215, 0xbfb8aa3b, v155
  v_exp_f32 v212, v212
  v_exp_f32 v213, v213
  v_exp_f32 v214, v214
  s_mul_i32 s11, s23, 5120
  buffer_load_dwordx4 a[28:31], v31, s[48:51], s11 offen offset:0 sc1
  v_exp_f32 v215, v215
  v_add_f32 v212, 1.0, v212
  v_add_f32 v213, 1.0, v213
  v_add_f32 v214, 1.0, v214
  v_add_f32 v215, 1.0, v215
  v_rcp_f32 v212, v212
  v_rcp_f32 v213, v213
  v_rcp_f32 v214, v214
  v_rcp_f32 v215, v215
  buffer_load_dwordx4 a[32:35], v31, s[48:51], s11 offen offset:1024 sc1
  v_mul_f32 v212, v152, v212
  v_mul_f32 v213, v153, v213
  v_mul_f32 v214, v154, v214
  v_mul_f32 v215, v155, v215
  v_cvt_pk_bf16_f32 v234, v212, v213
  v_cvt_pk_bf16_f32 v235, v214, v215
  v_mul_f32 v208, 0xbfb8aa3b, v148
  v_mul_f32 v209, 0xbfb8aa3b, v149
  s_barrier
  s_waitcnt vmcnt(8)
  v_cmp_gt_u32 vcc, 4, v15
  s_cbranch_vccnz SL_fq
OK_fq:
  buffer_load_dwordx4 v[48:51], v39, s[48:51], s34 offen offset:2048 sc1
  buffer_load_dwordx4 v[40:43], v38, s[48:51], s34 offen sc1
  buffer_load_dwordx4 v[44:47], v38, s[48:51], s34 offen offset:3072 sc1
  s_add_u32 m0, s33, 4096
  s_movk_i32 s6, 0
  buffer_load_dwordx4 v36, s[48:51], s6 offen sc1 lds
  s_add_u32 m0, s33, 10304
  s_movk_i32 s6, 1024
  buffer_load_dwordx4 v36, s[48:51], s6 offen sc1 lds
  s_add_u32 m0, s33, 16512
  s_movk_i32 s6, 2048
  buffer_load_dwordx4 v36, s[48:51], s6 offen sc1 lds
  s_add_u32 m0, s33, 22784
  s_movk_i32 s6, 3072
  buffer_load_dwordx4 v36, s[48:51], s6 offen sc1 lds
  s_add_u32 m0, s33, 28992
  s_movk_i32 s6, 4096
  buffer_load_dwordx4 v36, s[48:51], s6 offen sc1 lds
  s_cmp_ge_u32 s12, 2
  s_cselect_b32 s6, 0x3f803f80, 0
  s_cmp_ge_u32 s3, 2
  s_cselect_b32 s6, 0x3f803f80, s6
  s_cmp_ge_u32 s12, 1
  s_cselect_b32 s7, 0x3f803f80, 0
  v_mov_b32 v96, s6
  v_mov_b32 v97, s6
  v_mov_b32 v98, s6
  v_mov_b32 v99, s6
  v_lshlrev_b32 v60, 4, v0
  ds_write_b128 v60, v[96:99] offset:62400
  v_mov_b32 v100, s7
  v_mov_b32 v101, s7
  v_lshlrev_b32 v61, 3, v0
  v_add_u32 v61, 4096, v61
  ds_write_b64 v61, v[100:101] offset:62400
  v_mul_f32 v210, 0xbfb8aa3b, v150
  s_add_u32 m0, s33, 0
  s_movk_i32 s6, 0
  buffer_load_dwordx4 v35, s[48:51], s6 offen sc1 lds
  v_mul_f32 v211, 0xbfb8aa3b, v151
  v_permlane16_swap_b32 v232, v234
  v_permlane16_swap_b32 v233, v235
  v_exp_f32 v208, v208
  v_exp_f32 v209, v209
  v_exp_f32 v210, v210
  v_exp_f32 v211, v211
  v_add_f32 v208, 1.0, v208
  v_add_f32 v209, 1.0, v209
  v_add_f32 v210, 1.0, v210
  v_add_f32 v211, 1.0, v211
  v_rcp_f32 v208, v208
  v_rcp_f32 v209, v209
  s_add_u32 m0, s33, 6208
  s_movk_i32 s6, 1024
  buffer_load_dwordx4 v35, s[48:51], s6 offen sc1 lds
  v_rcp_f32 v210, v210
  v_rcp_f32 v211, v211
  v_mul_f32 v208, v148, v208
  v_mul_f32 v209, v149, v209
  v_mul_f32 v210, v150, v210
  v_mul_f32 v211, v151, v211
  v_cvt_pk_bf16_f32 v236, v208, v209
  v_cvt_pk_bf16_f32 v237, v210, v211
  v_mul_f32 v212, 0xbfb8aa3b, v156
  v_mul_f32 v213, 0xbfb8aa3b, v157
  v_mul_f32 v214, 0xbfb8aa3b, v158
  v_mul_f32 v215, 0xbfb8aa3b, v159
  v_exp_f32 v212, v212
  v_exp_f32 v213, v213
  s_add_u32 m0, s33, 12416
  s_movk_i32 s6, 2048
  buffer_load_dwordx4 v35, s[48:51], s6 offen sc1 lds
  v_exp_f32 v214, v214
  v_exp_f32 v215, v215
  v_add_f32 v212, 1.0, v212
  v_add_f32 v213, 1.0, v213
  v_add_f32 v214, 1.0, v214
  v_add_f32 v215, 1.0, v215
  v_rcp_f32 v212, v212
  v_rcp_f32 v213, v213
  v_rcp_f32 v214, v214
  v_rcp_f32 v215, v215
  v_mul_f32 v212, v156, v212
  v_mul_f32 v213, v157, v213
  v_mul_f32 v214, v158, v214
  v_mul_f32 v215, v159, v215
  s_add_u32 m0, s33, 18688
  s_movk_i32 s6, 3072
  buffer_load_dwordx4 v35, s[48:51], s6 offen sc1 lds
  v_cvt_pk_bf16_f32 v238, v212, v213
  v_cvt_pk_bf16_f32 v239, v214, v215
  v_mul_f32 v208, 0xbfb8aa3b, v160
  v_mul_f32 v209, 0xbfb8aa3b, v161
  v_mul_f32 v210, 0xbfb8aa3b, v162
  v_mul_f32 v211, 0xbfb8aa3b, v163
  v_permlane16_swap_b32 v236, v238
  v_permlane16_swap_b32 v237, v239
  v_exp_f32 v208, v208
  v_exp_f32 v209, v209
  v_exp_f32 v210, v210
  v_exp_f32 v211, v211
  v_add_f32 v208, 1.0, v208
  v_add_f32 v209, 1.0, v209
  s_add_u32 m0, s33, 24896
  s_movk_i32 s6, 4096
  buffer_load_dwordx4 v35, s[48:51], s6 offen sc1 lds
  v_add_f32 v210, 1.0, v210
  v_add_f32 v211, 1.0, v211
  v_rcp_f32 v208, v208
  v_rcp_f32 v209, v209
  v_rcp_f32 v210, v210
  v_rcp_f32 v211, v211
  v_mul_f32 v208, v160, v208
  v_mul_f32 v209, v161, v209
  v_mul_f32 v210, v162, v210
  v_mul_f32 v211, v163, v211
  v_cvt_pk_bf16_f32 v240, v208, v209
  v_cvt_pk_bf16_f32 v241, v210, v211
  v_mul_f32 v212, 0xbfb8aa3b, v168
  v_mul_f32 v213, 0xbfb8aa3b, v169
  s_add_u32 m0, s33, 2048
  s_movk_i32 s6, 0
  buffer_load_dwordx4 v37, s[48:51], s6 offen sc1 lds
  v_mul_f32 v214, 0xbfb8aa3b, v170
  v_mul_f32 v215, 0xbfb8aa3b, v171
  v_exp_f32 v212, v212
  v_exp_f32 v213, v213
  v_exp_f32 v214, v214
  v_exp_f32 v215, v215
  v_add_f32 v212, 1.0, v212
  v_add_f32 v213, 1.0, v213
  v_add_f32 v214, 1.0, v214
  v_add_f32 v215, 1.0, v215
  v_rcp_f32 v212, v212
  v_rcp_f32 v213, v213
  v_rcp_f32 v214, v214
  s_add_u32 m0, s33, 8256
  s_movk_i32 s6, 1024
  buffer_load_dwordx4 v37, s[48:51], s6 offen sc1 lds
  v_rcp_f32 v215, v215
  v_mul_f32 v212, v168, v212
  v_mul_f32 v213, v169, v213
  v_mul_f32 v214, v170, v214
  v_mul_f32 v215, v171, v215
  v_cvt_pk_bf16_f32 v242, v212, v213
  v_cvt_pk_bf16_f32 v243, v214, v215
  v_mul_f32 v208, 0xbfb8aa3b, v164
  v_mul_f32 v209, 0xbfb8aa3b, v165
  v_mul_f32 v210, 0xbfb8aa3b, v166
  v_mul_f32 v211, 0xbfb8aa3b, v167
  v_permlane16_swap_b32 v240, v242
  v_permlane16_swap_b32 v241, v243
  v_exp_f32 v208, v208
  s_add_u32 m0, s33, 14464
  s_movk_i32 s6, 2048
  buffer_load_dwordx4 v37, s[48:51], s6 offen sc1 lds
  v_exp_f32 v209, v209
  v_exp_f32 v210, v210
  v_exp_f32 v211, v211
  v_add_f32 v208, 1.0, v208
  v_add_f32 v209, 1.0, v209
  v_add_f32 v210, 1.0, v210
  v_add_f32 v211, 1.0, v211
  v_rcp_f32 v208, v208
  v_rcp_f32 v209, v209
  v_rcp_f32 v210, v210
  v_rcp_f32 v211, v211
  v_mul_f32 v208, v164, v208
  v_mul_f32 v209, v165, v209
  v_mul_f32 v210, v166, v210
  s_add_u32 m0, s33, 20736
  s_movk_i32 s6, 3072
  buffer_load_dwordx4 v37, s[48:51], s6 offen sc1 lds
  v_mul_f32 v211, v167, v211
  v_cvt_pk_bf16_f32 v244, v208, v209
  v_cvt_pk_bf16_f32 v245, v210, v211
  v_mul_f32 v212, 0xbfb8aa3b, v172
  v_mul_f32 v213, 0xbfb8aa3b, v173
  v_mul_f32 v214, 0xbfb8aa3b, v174
  v_mul_f32 v215, 0xbfb8aa3b, v175
  v_exp_f32 v212, v212
  v_exp_f32 v213, v213
  v_exp_f32 v214, v214
  v_exp_f32 v215, v215
  v_add_f32 v212, 1.0, v212
  v_add_f32 v213, 1.0, v213
  v_add_f32 v214, 1.0, v214
  s_add_u32 m0, s33, 26944
  s_movk_i32 s6, 4096
  buffer_load_dwordx4 v37, s[48:51], s6 offen sc1 lds
  v_add_f32 v215, 1.0, v215
  v_rcp_f32 v212, v212
  v_rcp_f32 v213, v213
  v_rcp_f32 v214, v214
  v_rcp_f32 v215, v215
  v_mul_f32 v212, v172, v212
  v_mul_f32 v213, v173, v213
  v_mul_f32 v214, v174, v214
  v_mul_f32 v215, v175, v215
  v_cvt_pk_bf16_f32 v246, v212, v213
  v_cvt_pk_bf16_f32 v247, v214, v215
  s_nop 0
  v_permlane16_swap_b32 v244, v246
  v_permlane16_swap_b32 v245, v247
  s_waitcnt vmcnt(17)
  v_mov_b32 v52, v50
  v_mov_b32 v53, v51
  v_mov_b32 v50, 0
  v_mov_b32 v51, 0
  s_waitcnt vmcnt(10) lgkmcnt(0)
  s_barrier
  ds_read_b128 v[176:179], v4 offset:4096
  ds_read_b128 v[184:187], v6 offset:4096
  ds_read_b128 v[180:183], v5 offset:4096
  s_waitcnt lgkmcnt(2)
  v_mfma_f32_32x32x16_bf16 v[96:111], v[176:179], v[40:43], 0
  s_waitcnt lgkmcnt(1)
  v_mfma_f32_32x32x16_bf16 v[96:111], v[184:187], v[48:51], v[96:111]
  s_waitcnt lgkmcnt(0)
  ds_read_b64_tr_b16 v[192:193], v7 offset:4096
  ds_read_b64_tr_b16 v[194:195], v7 offset:4224
  buffer_store_dwordx4 v[224:227], v28, s[48:51], 0 offen offset:0 sc1
  s_nop 7
  v_exp_f32 v96, v96
  v_exp_f32 v97, v97
  v_exp_f32 v98, v98
  v_exp_f32 v99, v99
  v_mfma_f32_32x32x16_bf16 v[112:127], v[180:183], v[44:47], 0
  ds_read_b64_tr_b16 v[196:197], v7 offset:4352
  ds_read_b64_tr_b16 v[198:199], v7 offset:4480
  s_nop 0
  v_exp_f32 v100, v100
  v_exp_f32 v101, v101
  v_exp_f32 v102, v102
  v_exp_f32 v103, v103
  v_cvt_pk_bf16_f32 v128, v96, v97
  v_cvt_pk_bf16_f32 v129, v98, v99
  v_mfma_f32_32x32x16_bf16 v[112:127], v[184:187], v[50:53], v[112:127]
  s_waitcnt lgkmcnt(2)
  ds_read_b128 v[176:179], v4 offset:4608
  ds_read_b128 v[188:191], v6 offset:4608
  buffer_store_dwordx4 v[228:231], v28, s[48:51], s29 offen offset:0 sc1
  v_exp_f32 v104, v104
  v_exp_f32 v105, v105
  v_exp_f32 v106, v106
  v_exp_f32 v107, v107
  v_cvt_pk_bf16_f32 v130, v100, v101
  v_cvt_pk_bf16_f32 v131, v102, v103
  v_exp_f32 v108, v108
  v_exp_f32 v109, v109
  v_exp_f32 v110, v110
  v_exp_f32 v111, v111
  v_cvt_pk_bf16_f32 v132, v104, v105
  v_cvt_pk_bf16_f32 v133, v106, v107
  v_mfma_f32_32x32x16_bf16 v[144:159], v[192:195], v[128:131], 0
  s_waitcnt lgkmcnt(1)
  ds_read_b64_tr_b16 v[200:201], v8 offset:4096
  ds_read_b64_tr_b16 v[202:203], v8 offset:4224
  v_cvt_pk_bf16_f32 v134, v108, v109
  v_cvt_pk_bf16_f32 v135, v110, v111
  v_exp_f32 v112, v112
  v_exp_f32 v113, v113
  v_exp_f32 v114, v114
  v_exp_f32 v115, v115
  v_mfma_f32_32x32x16_bf16 v[96:111], v[176:179], v[40:43], 0
  s_waitcnt lgkmcnt(2)
  ds_read_b64_tr_b16 v[204:205], v8 offset:4352
  ds_read_b64_tr_b16 v[206:207], v8 offset:4480
  buffer_store_dwordx4 v[232:235], v28, s[48:51], 0 offen offset:1024 sc1
  v_exp_f32 v116, v116
  v_exp_f32 v117, v117
  v_exp_f32 v118, v118
  v_exp_f32 v119, v119
  v_cvt_pk_bf16_f32 v136, v112, v113
  v_cvt_pk_bf16_f32 v137, v114, v115
  v_mfma_f32_32x32x16_bf16 v[96:111], v[188:191], v[48:51], v[96:111]
  ds_read_b128 v[180:183], v5 offset:4608
  v_exp_f32 v120, v120
  v_exp_f32 v121, v121
  v_exp_f32 v122, v122
  v_exp_f32 v123, v123
  v_cvt_pk_bf16_f32 v138, v116, v117
  v_cvt_pk_bf16_f32 v139, v118, v119
  v_mfma_f32_32x32x16_bf16 v[144:159], v[196:199], v[132:135], v[144:159]
  s_waitcnt lgkmcnt(3)
  v_exp_f32 v124, v124
  v_exp_f32 v125, v125
  v_exp_f32 v126, v126
  v_exp_f32 v127, v127
  v_cvt_pk_bf16_f32 v140, v120, v121
  v_cvt_pk_bf16_f32 v141, v122, v123
  v_mfma_f32_32x32x16_bf16 v[160:175], v[200:203], v[136:139], 0
  s_waitcnt lgkmcnt(0)
  ds_read_b64_tr_b16 v[192:193], v7 offset:4608
  ds_read_b64_tr_b16 v[194:195], v7 offset:4736
  buffer_store_dwordx4 v[236:239], v28, s[48:51], s29 offen offset:1024 sc1
  v_cvt_pk_bf16_f32 v142, v124, v125
  v_cvt_pk_bf16_f32 v143, v126, v127
  v_exp_f32 v96, v96
  v_exp_f32 v97, v97
  v_exp_f32 v98, v98
  v_exp_f32 v99, v99
  v_mfma_f32_32x32x16_bf16 v[112:127], v[180:183], v[44:47], 0
  ds_read_b64_tr_b16 v[196:197], v7 offset:4864
  ds_read_b64_tr_b16 v[198:199], v7 offset:4992
  v_exp_f32 v100, v100
  v_exp_f32 v101, v101
  v_exp_f32 v102, v102
  v_exp_f32 v103, v103
  v_cvt_pk_bf16_f32 v128, v96, v97
  v_cvt_pk_bf16_f32 v129, v98, v99
  v_mfma_f32_32x32x16_bf16 v[112:127], v[188:191], v[50:53], v[112:127]
  ds_read_b128 v[176:179], v4 offset:5120
  ds_read_b128 v[184:187], v6 offset:5120
  buffer_store_dwordx4 v[240:243], v28, s[48:51], 0 offen offset:2048 sc1
  v_exp_f32 v104, v104
  v_exp_f32 v105, v105
  v_exp_f32 v106, v106
  v_exp_f32 v107, v107
  v_cvt_pk_bf16_f32 v130, v100, v101
  v_cvt_pk_bf16_f32 v131, v102, v103
  v_mfma_f32_32x32x16_bf16 v[160:175], v[204:207], v[140:143], v[160:175]
  s_waitcnt lgkmcnt(4)
  v_exp_f32 v108, v108
  v_exp_f32 v109, v109
  v_exp_f32 v110, v110
  v_exp_f32 v111, v111
  v_cvt_pk_bf16_f32 v132, v104, v105
  v_cvt_pk_bf16_f32 v133, v106, v107
  v_mfma_f32_32x32x16_bf16 v[144:159], v[192:195], v[128:131], v[144:159]
  s_waitcnt lgkmcnt(1)
  ds_read_b64_tr_b16 v[200:201], v8 offset:4608
  ds_read_b64_tr_b16 v[202:203], v8 offset:4736
  v_cvt_pk_bf16_f32 v134, v108, v109
  v_cvt_pk_bf16_f32 v135, v110, v111
  v_exp_f32 v112, v112
  v_exp_f32 v113, v113
  v_exp_f32 v114, v114
  v_exp_f32 v115, v115
  v_mfma_f32_32x32x16_bf16 v[96:111], v[176:179], v[40:43], 0
  s_waitcnt lgkmcnt(2)
  ds_read_b64_tr_b16 v[204:205], v8 offset:4864
  ds_read_b64_tr_b16 v[206:207], v8 offset:4992
  buffer_store_dwordx4 v[244:247], v28, s[48:51], s29 offen offset:2048 sc1
  v_exp_f32 v116, v116
  v_exp_f32 v117, v117
  v_exp_f32 v118, v118
  v_exp_f32 v119, v119
  v_cvt_pk_bf16_f32 v136, v112, v113
  v_cvt_pk_bf16_f32 v137, v114, v115
  v_mfma_f32_32x32x16_bf16 v[96:111], v[184:187], v[48:51], v[96:111]
  ds_read_b128 v[180:183], v5 offset:5120
  v_exp_f32 v120, v120
  v_exp_f32 v121, v121
  v_exp_f32 v122, v122
  v_exp_f32 v123, v123
  v_cvt_pk_bf16_f32 v138, v116, v117
  v_cvt_pk_bf16_f32 v139, v118, v119
  v_mfma_f32_32x32x16_bf16 v[144:159], v[196:199], v[132:135], v[144:159]
  s_waitcnt lgkmcnt(3)
  v_exp_f32 v124, v124
  v_exp_f32 v125, v125
  v_exp_f32 v126, v126
  v_exp_f32 v127, v127
  v_cvt_pk_bf16_f32 v140, v120, v121
  v_cvt_pk_bf16_f32 v141, v122, v123
  v_mfma_f32_32x32x16_bf16 v[160:175], v[200:203], v[136:139], v[160:175]
  s_waitcnt lgkmcnt(0)
  ds_read_b64_tr_b16 v[192:193], v7 offset:5120
  ds_read_b64_tr_b16 v[194:195], v7 offset:5248
  buffer_load_dwordx4 a[36:39], v31, s[48:51], s11 offen offset:2048 sc1
  v_cvt_pk_bf16_f32 v142, v124, v125
  v_cvt_pk_bf16_f32 v143, v126, v127
  v_exp_f32 v96, v96
  v_exp_f32 v97, v97
  v_exp_f32 v98, v98
  v_exp_f32 v99, v99
  v_mfma_f32_32x32x16_bf16 v[112:127], v[180:183], v[44:47], 0
  ds_read_b64_tr_b16 v[196:197], v7 offset:5376
  ds_read_b64_tr_b16 v[198:199], v7 offset:5504
  buffer_load_dwordx4 a[40:43], v31, s[48:51], s11 offen offset:3072 sc1
  v_exp_f32 v100, v100
  v_exp_f32 v101, v101
  v_exp_f32 v102, v102
  v_exp_f32 v103, v103
  v_cvt_pk_bf16_f32 v128, v96, v97
  v_cvt_pk_bf16_f32 v129, v98, v99
  v_mfma_f32_32x32x16_bf16 v[112:127], v[184:187], v[50:53], v[112:127]
  ds_read_b128 v[176:179], v4 offset:5632
  ds_read_b128 v[188:191], v6 offset:5632
  buffer_load_dwordx4 a[44:47], v32, s[48:51], s11 offen offset:0 sc1
  v_exp_f32 v104, v104
  v_exp_f32 v105, v105
  v_exp_f32 v106, v106
  v_exp_f32 v107, v107
  v_cvt_pk_bf16_f32 v130, v100, v101
  v_cvt_pk_bf16_f32 v131, v102, v103
  v_mfma_f32_32x32x16_bf16 v[160:175], v[204:207], v[140:143], v[160:175]
  s_waitcnt lgkmcnt(4)
  s_mul_i32 s11, s24, 5120
  buffer_load_dwordx4 a[48:51], v31, s[48:51], s11 offen offset:0 sc1
  v_exp_f32 v108, v108
  v_exp_f32 v109, v109
  v_exp_f32 v110, v110
  v_exp_f32 v111, v111
  v_cvt_pk_bf16_f32 v132, v104, v105
  v_cvt_pk_bf16_f32 v133, v106, v107
  v_mfma_f32_32x32x16_bf16 v[144:159], v[192:195], v[128:131], v[144:159]
  s_waitcnt lgkmcnt(1)
  ds_read_b64_tr_b16 v[200:201], v8 offset:5120
  ds_read_b64_tr_b16 v[202:203], v8 offset:5248
  buffer_load_dwordx4 a[52:55], v31, s[48:51], s11 offen offset:1024 sc1
  v_cvt_pk_bf16_f32 v134, v108, v109
  v_cvt_pk_bf16_f32 v135, v110, v111
  v_exp_f32 v112, v112
  v_exp_f32 v113, v113
  v_exp_f32 v114, v114
  v_exp_f32 v115, v115
  v_mfma_f32_32x32x16_bf16 v[96:111], v[176:179], v[40:43], 0
  s_waitcnt lgkmcnt(2)
  ds_read_b64_tr_b16 v[204:205], v8 offset:5376
  ds_read_b64_tr_b16 v[206:207], v8 offset:5504
  buffer_load_dwordx4 a[56:59], v31, s[48:51], s11 offen offset:2048 sc1
  v_exp_f32 v116, v116
  v_exp_f32 v117, v117
  v_exp_f32 v118, v118
  v_exp_f32 v119, v119
  v_cvt_pk_bf16_f32 v136, v112, v113
  v_cvt_pk_bf16_f32 v137, v114, v115
  v_mfma_f32_32x32x16_bf16 v[96:111], v[188:191], v[48:51], v[96:111]
  ds_read_b128 v[180:183], v5 offset:5632
  v_exp_f32 v120, v120
  v_exp_f32 v121, v121
  v_exp_f32 v122, v122
  v_exp_f32 v123, v123
  v_cvt_pk_bf16_f32 v138, v116, v117
  v_cvt_pk_bf16_f32 v139, v118, v119
  v_mfma_f32_32x32x16_bf16 v[144:159], v[196:199], v[132:135], v[144:159]
  s_waitcnt lgkmcnt(3)
  buffer_load_dwordx4 a[60:63], v31, s[48:51], s11 offen offset:3072 sc1
  v_exp_f32 v124, v124
  v_exp_f32 v125, v125
  v_exp_f32 v126, v126
  v_exp_f32 v127, v127
  v_cvt_pk_bf16_f32 v140, v120, v121
  v_cvt_pk_bf16_f32 v141, v122, v123
  v_mfma_f32_32x32x16_bf16 v[160:175], v[200:203], v[136:139], v[160:175]
  s_waitcnt lgkmcnt(0)
  ds_read_b64_tr_b16 v[192:193], v7 offset:5632
  ds_read_b64_tr_b16 v[194:195], v7 offset:5760
  buffer_load_dwordx4 a[64:67], v32, s[48:51], s11 offen offset:0 sc1
  v_cvt_pk_bf16_f32 v142, v124, v125
  v_cvt_pk_bf16_f32 v143, v126, v127
  v_exp_f32 v96, v96
  v_exp_f32 v97, v97
  v_exp_f32 v98, v98
  v_exp_f32 v99, v99
  v_mfma_f32_32x32x16_bf16 v[112:127], v[180:183], v[44:47], 0
  ds_read_b64_tr_b16 v[196:197], v7 offset:5888
  ds_read_b64_tr_b16 v[198:199], v7 offset:6016
  s_mul_i32 s11, s25, 5120
  buffer_load_dwordx4 a[68:71], v31, s[48:51], s11 offen offset:0 sc1
  v_exp_f32 v100, v100
  v_exp_f32 v101, v101
  v_exp_f32 v102, v102
  v_exp_f32 v103, v103
  v_cvt_pk_bf16_f32 v128, v96, v97
  v_cvt_pk_bf16_f32 v129, v98, v99
  v_mfma_f32_32x32x16_bf16 v[112:127], v[188:191], v[50:53], v[112:127]
  s_lshl_b32 s7, s3, 9
  v_add_u32 v4, s7, v4
  v_add_u32 v5, s7, v5
  v_add_u32 v6, s7, v6
  s_waitcnt vmcnt(15)
  s_barrier
  ds_read_b128 v[176:179], v4 offset:0
  ds_read_b128 v[184:187], v6 offset:0
  s_add_u32 s6, s35, 262144
  s_waitcnt vmcnt(9)
  buffer_atomic_add v30, v29, s[48:51], s6 offen sc1
  buffer_load_dwordx4 a[72:75], v31, s[48:51], s11 offen offset:1024 sc1
  v_exp_f32 v104, v104
  v_exp_f32 v105, v105
  v_exp_f32 v106, v106
  v_exp_f32 v107, v107
  v_cvt_pk_bf16_f32 v130, v100, v101
  v_cvt_pk_bf16_f32 v131, v102, v103
  v_mfma_f32_32x32x16_bf16 v[160:175], v[204:207], v[140:143], v[160:175]
  s_waitcnt lgkmcnt(4)
  buffer_load_dwordx4 a[76:79], v31, s[48:51], s11 offen offset:2048 sc1
  v_exp_f32 v108, v108
  v_exp_f32 v109, v109
  v_exp_f32 v110, v110
  v_exp_f32 v111, v111
  v_cvt_pk_bf16_f32 v132, v104, v105
  v_cvt_pk_bf16_f32 v133, v106, v107
  v_mfma_f32_32x32x16_bf16 v[144:159], v[192:195], v[128:131], v[144:159]
  s_waitcnt lgkmcnt(1)
  ds_read_b64_tr_b16 v[200:201], v8 offset:5632
  ds_read_b64_tr_b16 v[202:203], v8 offset:5760
  buffer_load_dwordx4 a[80:83], v31, s[48:51], s11 offen offset:3072 sc1
  v_cvt_pk_bf16_f32 v134, v108, v109
  v_cvt_pk_bf16_f32 v135, v110, v111
  v_exp_f32 v112, v112
  v_exp_f32 v113, v113
  v_exp_f32 v114, v114
  v_exp_f32 v115, v115
  v_mfma_f32_32x32x16_bf16 v[96:111], v[176:179], v[40:43], v[64:79]
  s_waitcnt lgkmcnt(2)
  ds_read_b64_tr_b16 v[204:205], v8 offset:5888
  ds_read_b64_tr_b16 v[206:207], v8 offset:6016
  v_exp_f32 v116, v116
  v_exp_f32 v117, v117
  v_exp_f32 v118, v118
  v_exp_f32 v119, v119
  v_cvt_pk_bf16_f32 v136, v112, v113
  v_cvt_pk_bf16_f32 v137, v114, v115
  v_mfma_f32_32x32x16_bf16 v[96:111], v[184:187], v[48:51], v[96:111]
  ds_read_b128 v[180:183], v5 offset:0
  buffer_load_dwordx4 a[84:87], v32, s[48:51], s11 offen offset:0 sc1
  v_exp_f32 v120, v120
  v_exp_f32 v121, v121
  v_exp_f32 v122, v122
  v_exp_f32 v123, v123
  v_cvt_pk_bf16_f32 v138, v116, v117
  v_cvt_pk_bf16_f32 v139, v118, v119
  v_mfma_f32_32x32x16_bf16 v[144:159], v[196:199], v[132:135], v[144:159]
  s_waitcnt lgkmcnt(3)
  s_mul_i32 s11, s26, 5120
  buffer_load_dwordx4 a[88:91], v31, s[48:51], s11 offen offset:0 sc1
  v_exp_f32 v124, v124
  v_exp_f32 v125, v125
  v_exp_f32 v126, v126
  v_exp_f32 v127, v127
  v_cvt_pk_bf16_f32 v140, v120, v121
  v_cvt_pk_bf16_f32 v141, v122, v123
  v_mfma_f32_32x32x16_bf16 v[160:175], v[200:203], v[136:139], v[160:175]
  s_waitcnt lgkmcnt(0)
  s_lshl_b32 s7, s3, 9
  v_add_u32 v7, s7, v7
  v_add_u32 v8, s7, v8
  ds_read_b64_tr_b16 v[192:193], v7 offset:0
  ds_read_b64_tr_b16 v[194:195], v7 offset:128
  buffer_load_dwordx4 a[92:95], v31, s[48:51], s11 offen offset:1024 sc1
  v_cvt_pk_bf16_f32 v142, v124, v125
  v_cvt_pk_bf16_f32 v143, v126, v127
  v_exp_f32 v96, v96
  v_exp_f32 v97, v97
  v_exp_f32 v98, v98
  v_exp_f32 v99, v99
  v_mfma_f32_32x32x16_bf16 v[112:127], v[180:183], v[44:47], v[64:79]
  ds_read_b64_tr_b16 v[196:197], v7 offset:256
  ds_read_b64_tr_b16 v[198:199], v7 offset:384
  buffer_load_dwordx4 a[96:99], v31, s[48:51], s11 offen offset:2048 sc1
  v_exp_f32 v100, v100
  v_exp_f32 v101, v101
  v_exp_f32 v102, v102
  v_exp_f32 v103, v103
  v_cvt_pk_bf16_f32 v128, v96, v97
  v_cvt_pk_bf16_f32 v129, v98, v99
  v_mfma_f32_32x32x16_bf16 v[112:127], v[184:187], v[50:53], v[112:127]
  ds_read_b128 v[176:179], v4 offset:512
  ds_read_b128 v[188:191], v6 offset:512
  buffer_load_dwordx4 a[100:103], v31, s[48:51], s11 offen offset:3072 sc1
  v_exp_f32 v104, v104
  v_exp_f32 v105, v105
  v_exp_f32 v106, v106
  v_exp_f32 v107, v107
  v_cvt_pk_bf16_f32 v130, v100, v101
  v_cvt_pk_bf16_f32 v131, v102, v103
  v_mfma_f32_32x32x16_bf16 v[160:175], v[204:207], v[140:143], v[160:175]
  s_waitcnt lgkmcnt(4)
  v_exp_f32 v108, v108
  v_exp_f32 v109, v109
  v_exp_f32 v110, v110
  v_exp_f32 v111, v111
  v_cvt_pk_bf16_f32 v132, v104, v105
  v_cvt_pk_bf16_f32 v133, v106, v107
  v_mfma_f32_32x32x16_bf16 v[144:159], v[192:195], v[128:131], v[144:159]
  s_waitcnt lgkmcnt(1)
  ds_read_b64_tr_b16 v[200:201], v8 offset:0
  ds_read_b64_tr_b16 v[202:203], v8 offset:128
  buffer_load_dwordx4 a[104:107], v32, s[48:51], s11 offen offset:0 sc1
  v_cvt_pk_bf16_f32 v134, v108, v109
  v_cvt_pk_bf16_f32 v135, v110, v111
  v_exp_f32 v112, v112
  v_exp_f32 v113, v113
  v_exp_f32 v114, v114
  v_exp_f32 v115, v115
  v_mfma_f32_32x32x16_bf16 v[96:111], v[176:179], v[40:43], 0
  s_waitcnt lgkmcnt(2)
  ds_read_b64_tr_b16 v[204:205], v8 offset:256
  ds_read_b64_tr_b16 v[206:207], v8 offset:384
  s_mul_i32 s11, s27, 5120
  buffer_load_dwordx4 a[108:111], v31, s[48:51], s11 offen offset:0 sc1
  v_exp_f32 v116, v116
  v_exp_f32 v117, v117
  v_exp_f32 v118, v118
  v_exp_f32 v119, v119
  v_cvt_pk_bf16_f32 v136, v112, v113
  v_cvt_pk_bf16_f32 v137, v114, v115
  v_mfma_f32_32x32x16_bf16 v[96:111], v[188:191], v[48:51], v[96:111]
  ds_read_b128 v[180:183], v5 offset:512
  buffer_load_dwordx4 a[112:115], v31, s[48:51], s11 offen offset:1024 sc1
  v_exp_f32 v120, v120
  v_exp_f32 v121, v121
  v_exp_f32 v122, v122
  v_exp_f32 v123, v123
  v_cvt_pk_bf16_f32 v138, v116, v117
  v_cvt_pk_bf16_f32 v139, v118, v119
  v_mfma_f32_32x32x16_bf16 v[144:159], v[196:199], v[132:135], v[144:159]
  s_waitcnt lgkmcnt(3)
  buffer_load_dwordx4 a[116:119], v31, s[48:51], s11 offen offset:2048 sc1
  v_exp_f32 v124, v124
  v_exp_f32 v125, v125
  v_exp_f32 v126, v126
  v_exp_f32 v127, v127
  v_cvt_pk_bf16_f32 v140, v120, v121
  v_cvt_pk_bf16_f32 v141, v122, v123
  v_mfma_f32_32x32x16_bf16 v[160:175], v[200:203], v[136:139], v[160:175]
  s_waitcnt lgkmcnt(0)
  ds_read_b64_tr_b16 v[192:193], v7 offset:512
  ds_read_b64_tr_b16 v[194:195], v7 offset:640
  buffer_load_dwordx4 a[120:123], v31, s[48:51], s11 offen offset:3072 sc1
  v_cvt_pk_bf16_f32 v142, v124, v125
  v_cvt_pk_bf16_f32 v143, v126, v127
  v_exp_f32 v96, v96
  v_exp_f32 v97, v97
  v_exp_f32 v98, v98
  v_exp_f32 v99, v99
  v_mfma_f32_32x32x16_bf16 v[112:127], v[180:183], v[44:47], 0
  ds_read_b64_tr_b16 v[196:197], v7 offset:768
  ds_read_b64_tr_b16 v[198:199], v7 offset:896
  buffer_load_dwordx4 a[124:127], v32, s[48:51], s11 offen offset:0 sc1
  v_exp_f32 v100, v100
  v_exp_f32 v101, v101
  v_exp_f32 v102, v102
  v_exp_f32 v103, v103
  v_cvt_pk_bf16_f32 v128, v96, v97
  v_cvt_pk_bf16_f32 v129, v98, v99
  v_mfma_f32_32x32x16_bf16 v[112:127], v[188:191], v[50:53], v[112:127]
  ds_read_b128 v[176:179], v4 offset:1024
  ds_read_b128 v[184:187], v6 offset:1024
  v_exp_f32 v104, v104
  v_exp_f32 v105, v105
  v_exp_f32 v106, v106
  v_exp_f32 v107, v107
  v_cvt_pk_bf16_f32 v130, v100, v101
  v_cvt_pk_bf16_f32 v131, v102, v103
  v_mfma_f32_32x32x16_bf16 v[160:175], v[204:207], v[140:143], v[160:175]
  s_waitcnt lgkmcnt(4)
  s_add_u32 m0, s8, 81920
  s_add_u32 s11, s8, 245760
  buffer_load_dwordx4 v31, s[48:51], s11 offen offset:0 sc1 lds
  v_exp_f32 v108, v108
  v_exp_f32 v109, v109
  v_exp_f32 v110, v110
  v_exp_f32 v111, v111
  v_cvt_pk_bf16_f32 v132, v104, v105
  v_cvt_pk_bf16_f32 v133, v106, v107
  v_mfma_f32_32x32x16_bf16 v[144:159], v[192:195], v[128:131], v[144:159]
  s_waitcnt lgkmcnt(1)
  ds_read_b64_tr_b16 v[200:201], v8 offset:512
  ds_read_b64_tr_b16 v[202:203], v8 offset:640
  buffer_load_dwordx4 v31, s[48:51], s11 offen offset:1024 sc1 lds
  v_cvt_pk_bf16_f32 v134, v108, v109
  v_cvt_pk_bf16_f32 v135, v110, v111
  v_exp_f32 v112, v112
  v_exp_f32 v113, v113
  v_exp_f32 v114, v114
  v_exp_f32 v115, v115
  v_mfma_f32_32x32x16_bf16 v[96:111], v[176:179], v[40:43], 0
  s_waitcnt lgkmcnt(2)
  ds_read_b64_tr_b16 v[204:205], v8 offset:768
  ds_read_b64_tr_b16 v[206:207], v8 offset:896
  buffer_load_dwordx4 v31, s[48:51], s11 offen offset:2048 sc1 lds
  v_exp_f32 v116, v116
  v_exp_f32 v117, v117
  v_exp_f32 v118, v118
  v_exp_f32 v119, v119
  v_cvt_pk_bf16_f32 v136, v112, v113
  v_cvt_pk_bf16_f32 v137, v114, v115
  v_mfma_f32_32x32x16_bf16 v[96:111], v[184:187], v[48:51], v[96:111]
  ds_read_b128 v[180:183], v5 offset:1024
  buffer_load_dwordx4 v31, s[48:51], s11 offen offset:3072 sc1 lds
  v_exp_f32 v120, v120
  v_exp_f32 v121, v121
  v_exp_f32 v122, v122
  v_exp_f32 v123, v123
  v_cvt_pk_bf16_f32 v138, v116, v117
  v_cvt_pk_bf16_f32 v139, v118, v119
  v_mfma_f32_32x32x16_bf16 v[144:159], v[196:199], v[132:135], v[144:159]
  s_waitcnt lgkmcnt(3)
  s_add_u32 m0, s8, 98304
  s_add_u32 s11, s8, 262144
  buffer_load_dwordx4 v31, s[48:51], s11 offen offset:0 sc1 lds
  v_exp_f32 v124, v124
  v_exp_f32 v125, v125
  v_exp_f32 v126, v126
  v_exp_f32 v127, v127
  v_cvt_pk_bf16_f32 v140, v120, v121
  v_cvt_pk_bf16_f32 v141, v122, v123
  v_mfma_f32_32x32x16_bf16 v[160:175], v[200:203], v[136:139], v[160:175]
  s_waitcnt lgkmcnt(0)
  ds_read_b64_tr_b16 v[192:193], v7 offset:1024
  ds_read_b64_tr_b16 v[194:195], v7 offset:1152
  v_cvt_pk_bf16_f32 v142, v124, v125
  v_cvt_pk_bf16_f32 v143, v126, v127
  v_exp_f32 v96, v96
  v_exp_f32 v97, v97
  v_exp_f32 v98, v98
  v_exp_f32 v99, v99
  v_mfma_f32_32x32x16_bf16 v[112:127], v[180:183], v[44:47], 0
  ds_read_b64_tr_b16 v[196:197], v7 offset:1280
  ds_read_b64_tr_b16 v[198:199], v7 offset:1408
  buffer_load_dwordx4 v31, s[48:51], s11 offen offset:1024 sc1 lds
  v_exp_f32 v100, v100
  v_exp_f32 v101, v101
  v_exp_f32 v102, v102
  v_exp_f32 v103, v103
  v_cvt_pk_bf16_f32 v128, v96, v97
  v_cvt_pk_bf16_f32 v129, v98, v99
  v_mfma_f32_32x32x16_bf16 v[112:127], v[184:187], v[50:53], v[112:127]
  ds_read_b128 v[176:179], v4 offset:1536
  ds_read_b128 v[188:191], v6 offset:1536
  buffer_load_dwordx4 v31, s[48:51], s11 offen offset:2048 sc1 lds
  v_exp_f32 v104, v104
  v_exp_f32 v105, v105
  v_exp_f32 v106, v106
  v_exp_f32 v107, v107
  v_cvt_pk_bf16_f32 v130, v100, v101
  v_cvt_pk_bf16_f32 v131, v102, v103
  v_mfma_f32_32x32x16_bf16 v[160:175], v[204:207], v[140:143], v[160:175]
  s_waitcnt lgkmcnt(4)
  buffer_load_dwordx4 v31, s[48:51], s11 offen offset:3072 sc1 lds
  v_exp_f32 v108, v108
  v_exp_f32 v109, v109
  v_exp_f32 v110, v110
  v_exp_f32 v111, v111
  v_cvt_pk_bf16_f32 v132, v104, v105
  v_cvt_pk_bf16_f32 v133, v106, v107
  v_mfma_f32_32x32x16_bf16 v[144:159], v[192:195], v[128:131], v[144:159]
  s_waitcnt lgkmcnt(1)
  ds_read_b64_tr_b16 v[200:201], v8 offset:1024
  ds_read_b64_tr_b16 v[202:203], v8 offset:1152
  s_add_u32 m0, s8, 114688
  s_add_u32 s11, s8, 278528
  buffer_load_dwordx4 v31, s[48:51], s11 offen offset:0 sc1 lds
  buffer_load_dword v15, v57, s[48:51], 0 offen sc1
  v_cvt_pk_bf16_f32 v134, v108, v109
  v_cvt_pk_bf16_f32 v135, v110, v111
  v_exp_f32 v112, v112
  v_exp_f32 v113, v113
  v_exp_f32 v114, v114
  v_exp_f32 v115, v115
  v_mfma_f32_32x32x16_bf16 v[96:111], v[176:179], v[40:43], 0
  s_waitcnt lgkmcnt(2)
  ds_read_b64_tr_b16 v[204:205], v8 offset:1280
  ds_read_b64_tr_b16 v[206:207], v8 offset:1408
  buffer_load_dwordx4 v31, s[48:51], s11 offen offset:1024 sc1 lds
  v_exp_f32 v116, v116
  v_exp_f32 v117, v117
  v_exp_f32 v118, v118
  v_exp_f32 v119, v119
  v_cvt_pk_bf16_f32 v136, v112, v113
  v_cvt_pk_bf16_f32 v137, v114, v115
  v_mfma_f32_32x32x16_bf16 v[96:111], v[188:191], v[48:51], v[96:111]
  ds_read_b128 v[180:183], v5 offset:1536
  buffer_load_dwordx4 v31, s[48:51], s11 offen offset:2048 sc1 lds
  v_exp_f32 v120, v120
  v_exp_f32 v121, v121
  v_exp_f32 v122, v122
  v_exp_f32 v123, v123
  v_cvt_pk_bf16_f32 v138, v116, v117
  v_cvt_pk_bf16_f32 v139, v118, v119
  v_mfma_f32_32x32x16_bf16 v[144:159], v[196:199], v[132:135], v[144:159]
  s_waitcnt lgkmcnt(3)
  v_exp_f32 v124, v124
  v_exp_f32 v125, v125
  v_exp_f32 v126, v126
  v_exp_f32 v127, v127
  v_cvt_pk_bf16_f32 v140, v120, v121
  v_cvt_pk_bf16_f32 v141, v122, v123
  v_mfma_f32_32x32x16_bf16 v[160:175], v[200:203], v[136:139], v[160:175]
  s_waitcnt lgkmcnt(0)
  ds_read_b64_tr_b16 v[192:193], v7 offset:1536
  ds_read_b64_tr_b16 v[194:195], v7 offset:1664
  buffer_load_dwordx4 v31, s[48:51], s11 offen offset:3072 sc1 lds
  v_cvt_pk_bf16_f32 v142, v124, v125
  v_cvt_pk_bf16_f32 v143, v126, v127
  v_exp_f32 v96, v96
  v_exp_f32 v97, v97
  v_exp_f32 v98, v98
  v_exp_f32 v99, v99
  v_mfma_f32_32x32x16_bf16 v[112:127], v[180:183], v[44:47], 0
  ds_read_b64_tr_b16 v[196:197], v7 offset:1792
  ds_read_b64_tr_b16 v[198:199], v7 offset:1920
  s_add_u32 m0, s8, 131072
  s_add_u32 s11, s8, 294912
  buffer_load_dwordx4 v31, s[48:51], s11 offen offset:0 sc1 lds
  v_exp_f32 v100, v100
  v_exp_f32 v101, v101
  v_exp_f32 v102, v102
  v_exp_f32 v103, v103
  v_cvt_pk_bf16_f32 v128, v96, v97
  v_cvt_pk_bf16_f32 v129, v98, v99
  v_mfma_f32_32x32x16_bf16 v[112:127], v[188:191], v[50:53], v[112:127]
  ds_read_b128 v[176:179], v4 offset:2048
  ds_read_b128 v[184:187], v6 offset:2048
  buffer_load_dwordx4 v31, s[48:51], s11 offen offset:1024 sc1 lds
  v_exp_f32 v104, v104
  v_exp_f32 v105, v105
  v_exp_f32 v106, v106
  v_exp_f32 v107, v107
  v_cvt_pk_bf16_f32 v130, v100, v101
  v_cvt_pk_bf16_f32 v131, v102, v103
  v_mfma_f32_32x32x16_bf16 v[160:175], v[204:207], v[140:143], v[160:175]
  s_waitcnt lgkmcnt(4)
  buffer_load_dwordx4 v31, s[48:51], s11 offen offset:2048 sc1 lds
  v_exp_f32 v108, v108
  v_exp_f32 v109, v109
  v_exp_f32 v110, v110
  v_exp_f32 v111, v111
  v_cvt_pk_bf16_f32 v132, v104, v105
  v_cvt_pk_bf16_f32 v133, v106, v107
  v_mfma_f32_32x32x16_bf16 v[144:159], v[192:195], v[128:131], v[144:159]
  s_waitcnt lgkmcnt(1)
  ds_read_b64_tr_b16 v[200:201], v8 offset:1536
  ds_read_b64_tr_b16 v[202:203], v8 offset:1664
  buffer_load_dwordx4 v31, s[48:51], s11 offen offset:3072 sc1 lds
  v_cvt_pk_bf16_f32 v134, v108, v109
  v_cvt_pk_bf16_f32 v135, v110, v111
  v_exp_f32 v112, v112
  v_exp_f32 v113, v113
  v_exp_f32 v114, v114
  v_exp_f32 v115, v115
  v_mfma_f32_32x32x16_bf16 v[96:111], v[176:179], v[40:43], v[80:95]
  s_waitcnt lgkmcnt(2)
  ds_read_b64_tr_b16 v[204:205], v8 offset:1792
  ds_read_b64_tr_b16 v[206:207], v8 offset:1920
  v_exp_f32 v116, v116
  v_exp_f32 v117, v117
  v_exp_f32 v118, v118
  v_exp_f32 v119, v119
  v_cvt_pk_bf16_f32 v136, v112, v113
  v_cvt_pk_bf16_f32 v137, v114, v115
  v_mfma_f32_32x32x16_bf16 v[96:111], v[184:187], v[48:51], v[96:111]
  ds_read_b128 v[180:183], v5 offset:2048
  v_exp_f32 v120, v120
  v_exp_f32 v121, v121
  v_exp_f32 v122, v122
  v_exp_f32 v123, v123
  v_cvt_pk_bf16_f32 v138, v116, v117
  v_cvt_pk_bf16_f32 v139, v118, v119
  v_mfma_f32_32x32x16_bf16 v[144:159], v[196:199], v[132:135], v[144:159]
  s_waitcnt lgkmcnt(3)
  v_exp_f32 v124, v124
  v_exp_f32 v125, v125
  v_exp_f32 v126, v126
  v_exp_f32 v127, v127
  v_cvt_pk_bf16_f32 v140, v120, v121
  v_cvt_pk_bf16_f32 v141, v122, v123
  v_mfma_f32_32x32x16_bf16 v[160:175], v[200:203], v[136:139], v[160:175]
  ds_read_b64_tr_b16 v[192:193], v7 offset:2048
  ds_read_b64_tr_b16 v[194:195], v7 offset:2176
  v_cvt_pk_bf16_f32 v142, v124, v125
  v_cvt_pk_bf16_f32 v143, v126, v127
  v_exp_f32 v96, v96
  v_exp_f32 v97, v97
  v_exp_f32 v98, v98
  v_exp_f32 v99, v99
  s_waitcnt vmcnt(7)
  v_cmp_gt_u32 vcc, 4, v15
  s_cbranch_vccnz SL_fh
OK_fh:
  s_lshl2_add_u32 s6, s12, s3
  s_lshl_b32 s6, s6, 7
  s_add_u32 s6, s6, 20971520
  v_lshlrev_b32 v63, 2, v2
  buffer_load_dword v56, v63, s[48:51], s6 offen sc1
  s_waitcnt lgkmcnt(2)
  v_mfma_f32_32x32x16_bf16 v[112:127], v[180:183], v[44:47], v[80:95]
  ds_read_b64_tr_b16 v[196:197], v7 offset:2304
  ds_read_b64_tr_b16 v[198:199], v7 offset:2432
  s_lshl_b32 s10, s16, 10
  buffer_load_dwordx4 v[208:211], v17, s[48:51], s10 offen offset:0 sc1
  buffer_load_dwordx4 v[212:215], v17, s[48:51], s10 offen offset:1024 sc1
  v_exp_f32 v100, v100
  v_exp_f32 v101, v101
  v_exp_f32 v102, v102
  v_exp_f32 v103, v103
  v_cvt_pk_bf16_f32 v128, v96, v97
  v_cvt_pk_bf16_f32 v129, v98, v99
  v_mfma_f32_32x32x16_bf16 v[112:127], v[184:187], v[50:53], v[112:127]
  buffer_load_dwordx4 v[216:219], v17, s[48:51], s10 offen offset:2048 sc1
  v_exp_f32 v104, v104
  v_exp_f32 v105, v105
  v_exp_f32 v106, v106
  v_exp_f32 v107, v107
  v_cvt_pk_bf16_f32 v130, v100, v101
  v_cvt_pk_bf16_f32 v131, v102, v103
  v_mfma_f32_32x32x16_bf16 v[160:175], v[204:207], v[140:143], v[160:175]
  s_waitcnt lgkmcnt(2)
  s_lshl_b32 s10, s19, 10
  buffer_load_dwordx4 v[220:223], v17, s[48:51], s10 offen offset:0 sc1
  buffer_load_dwordx4 v[224:227], v17, s[48:51], s10 offen offset:1024 sc1
  v_exp_f32 v108, v108
  v_exp_f32 v109, v109
  v_exp_f32 v110, v110
  v_exp_f32 v111, v111
  v_cvt_pk_bf16_f32 v132, v104, v105
  v_cvt_pk_bf16_f32 v133, v106, v107
  v_mfma_f32_32x32x16_bf16 v[144:159], v[192:195], v[128:131], v[144:159]
  ds_read_b64_tr_b16 v[200:201], v8 offset:2048
  ds_read_b64_tr_b16 v[202:203], v8 offset:2176
  buffer_load_dwordx4 v[228:231], v17, s[48:51], s10 offen offset:2048 sc1
  v_cvt_pk_bf16_f32 v134, v108, v109
  v_cvt_pk_bf16_f32 v135, v110, v111
  v_exp_f32 v112, v112
  v_exp_f32 v113, v113
  v_exp_f32 v114, v114
  v_exp_f32 v115, v115
  ds_read_b64_tr_b16 v[204:205], v8 offset:2304
  ds_read_b64_tr_b16 v[206:207], v8 offset:2432
  s_lshl_b32 s10, s22, 10
  buffer_load_dwordx4 v[232:235], v17, s[48:51], s10 offen offset:0 sc1
  buffer_load_dwordx4 v[236:239], v17, s[48:51], s10 offen offset:1024 sc1
  v_exp_f32 v116, v116
  v_exp_f32 v117, v117
  v_exp_f32 v118, v118
  v_exp_f32 v119, v119
  v_cvt_pk_bf16_f32 v136, v112, v113
  v_cvt_pk_bf16_f32 v137, v114, v115
  buffer_load_dwordx4 v[240:243], v17, s[48:51], s10 offen offset:2048 sc1
  v_exp_f32 v120, v120
  v_exp_f32 v121, v121
  v_exp_f32 v122, v122
  v_exp_f32 v123, v123
  v_cvt_pk_bf16_f32 v138, v116, v117
  v_cvt_pk_bf16_f32 v139, v118, v119
  s_waitcnt lgkmcnt(4)
  v_mfma_f32_32x32x16_bf16 v[144:159], v[196:199], v[132:135], v[144:159]
  s_waitcnt lgkmcnt(2)
  s_lshl_b32 s10, s25, 10
  buffer_load_dwordx4 v[244:247], v17, s[48:51], s10 offen offset:0 sc1
  buffer_load_dwordx4 v[248:251], v17, s[48:51], s10 offen offset:1024 sc1
  v_exp_f32 v124, v124
  v_exp_f32 v125, v125
  v_exp_f32 v126, v126
  v_exp_f32 v127, v127
  v_cvt_pk_bf16_f32 v140, v120, v121
  v_cvt_pk_bf16_f32 v141, v122, v123
  v_mfma_f32_32x32x16_bf16 v[160:175], v[200:203], v[136:139], v[160:175]
  s_waitcnt lgkmcnt(0)
  buffer_load_dwordx4 v[252:255], v17, s[48:51], s10 offen offset:2048 sc1
  v_cvt_pk_bf16_f32 v142, v124, v125
  v_cvt_pk_bf16_f32 v143, v126, v127
  s_nop 1
  v_mfma_f32_32x32x16_bf16 v[160:175], v[204:207], v[140:143], v[160:175]
  v_pk_add_f32 v[96:97], v[144:145], v[146:147]
  s_nop 10
  v_pk_add_f32 v[104:105], v[160:161], v[162:163]
  s_lshl_b32 s10, s16, 10
  buffer_load_dwordx4 v[64:67], v18, s[48:51], s10 offen offset:0 sc1
  v_pk_add_f32 v[98:99], v[148:149], v[150:151]
  v_pk_add_f32 v[106:107], v[164:165], v[166:167]
  v_pk_add_f32 v[100:101], v[152:153], v[154:155]
  v_pk_add_f32 v[108:109], v[168:169], v[170:171]
  v_pk_add_f32 v[96:97], v[96:97], v[98:99]
  v_pk_add_f32 v[104:105], v[104:105], v[106:107]
  v_pk_add_f32 v[96:97], v[96:97], v[100:101]
  v_pk_add_f32 v[104:105], v[104:105], v[108:109]
  v_add_f32 v96, v96, v97
  v_add_f32 v104, v104, v105
  v_fma_f32 v96, v96, 0, v156
  v_fma_f32 v104, v104, 0, v172
  s_mov_b32 s6, 0x2b800000
  s_mov_b32 s7, 0x5f800000
  v_cmp_nle_f32 vcc, s6, v96
  v_cmp_nge_f32 s[64:65], s7, v96
  v_cmp_nle_f32 s[66:67], s6, v104
  v_cmp_nge_f32 s[68:69], s7, v104
  s_or_b64 vcc, vcc, s[64:65]
  s_or_b64 s[66:67], s[66:67], s[68:69]
  s_or_b64 vcc, vcc, s[66:67]
  s_cbranch_scc1 L_SAFE
L_SAFE_DONE:
  v_rcp_f32 v96, v156
  v_rcp_f32 v97, v172
  s_waitcnt vmcnt(13)
  v_mul_f32 v96, v56, v96
  buffer_load_dwordx4 v[68:71], v18, s[48:51], s10 offen offset:1024 sc1
  v_mul_f32 v97, v56, v97
  v_mul_f32 v144, v96, v144
  v_mul_f32 v145, v96, v145
  v_mul_f32 v146, v96, v146
  v_mul_f32 v147, v96, v147
  v_mul_f32 v148, v96, v148
  v_mul_f32 v149, v96, v149
  v_mul_f32 v150, v96, v150
  v_mul_f32 v151, v96, v151
  v_mul_f32 v152, v96, v152
  v_mul_f32 v153, v96, v153
  v_mul_f32 v154, v96, v154
  v_mul_f32 v155, v96, v155
  v_cvt_pk_bf16_f32 v40, v144, v145
  v_cvt_pk_bf16_f32 v41, v146, v147
  v_cvt_pk_bf16_f32 v42, v148, v149
  v_cvt_pk_bf16_f32 v43, v150, v151
  v_cvt_pk_bf16_f32 v48, v152, v153
  v_cvt_pk_bf16_f32 v49, v154, v155
  buffer_store_dwordx4 v[40:43], v54, s[48:51], 0 offen offset:0 sc1
  v_mul_f32 v160, v97, v160
  v_mul_f32 v161, v97, v161
  v_mul_f32 v162, v97, v162
  v_mul_f32 v163, v97, v163
  v_mul_f32 v164, v97, v164
  v_mul_f32 v165, v97, v165
  v_mul_f32 v166, v97, v166
  v_mul_f32 v167, v97, v167
  v_mul_f32 v168, v97, v168
  v_mul_f32 v169, v97, v169
  v_mul_f32 v170, v97, v170
  v_mul_f32 v171, v97, v171
  v_cvt_pk_bf16_f32 v44, v160, v161
  v_cvt_pk_bf16_f32 v45, v162, v163
  v_cvt_pk_bf16_f32 v46, v164, v165
  v_cvt_pk_bf16_f32 v47, v166, v167
  v_cvt_pk_bf16_f32 v50, v168, v169
  v_cvt_pk_bf16_f32 v51, v170, v171
  buffer_store_dwordx4 v[44:47], v54, s[48:51], 0 offen offset:768 sc1
  buffer_store_dwordx4 v[48:51], v55, s[48:51], 0 offen offset:512 sc1
  s_waitcnt vmcnt(16)
  v_mfma_f32_16x16x32_bf16 v[116:119], a[160:163], v[208:211], 0
  s_waitcnt vmcnt(15)
  buffer_load_dwordx4 v[72:75], v18, s[48:51], s10 offen offset:2048 sc1
  v_mfma_f32_16x16x32_bf16 v[116:119], a[180:183], v[212:215], v[116:119]
  s_waitcnt vmcnt(15)
  v_mfma_f32_16x16x32_bf16 v[116:119], a[200:203], v[216:219], v[116:119]
  s_waitcnt vmcnt(14)
  v_mfma_f32_16x16x32_bf16 v[116:119], a[220:223], v[220:223], v[116:119]
  s_lshl2_add_u32 s6, s14, s3
  s_lshl_b32 s6, s6, 6
  s_add_u32 s6, s6, 20971520
  v_and_b32 v60, 15, v1
  v_lshlrev_b32 v60, 2, v60
  buffer_load_dword v23, v60, s[48:51], s6 offen sc1
  v_mfma_f32_16x16x32_bf16 v[120:123], a[224:227], v[220:223], 0
  s_lshl_b32 s10, s19, 10
  buffer_load_dwordx4 v[76:79], v18, s[48:51], s10 offen offset:0 sc1
  v_mfma_f32_16x16x32_bf16 v[120:123], a[204:207], v[216:219], v[120:123]
  v_mfma_f32_16x16x32_bf16 v[120:123], a[184:187], v[212:215], v[120:123]
  v_mfma_f32_16x16x32_bf16 v[120:123], a[164:167], v[208:211], v[120:123]
  v_mfma_f32_16x16x32_bf16 v[124:127], a[168:171], v[208:211], 0
  v_mfma_f32_16x16x32_bf16 v[124:127], a[188:191], v[212:215], v[124:127]
  buffer_load_dwordx4 v[80:83], v18, s[48:51], s10 offen offset:1024 sc1
  v_mfma_f32_16x16x32_bf16 v[124:127], a[208:211], v[216:219], v[124:127]
  v_mfma_f32_16x16x32_bf16 v[124:127], a[228:231], v[220:223], v[124:127]
  v_mfma_f32_16x16x32_bf16 v[128:131], a[232:235], v[220:223], 0
  v_mfma_f32_16x16x32_bf16 v[128:131], a[212:215], v[216:219], v[128:131]
  v_mfma_f32_16x16x32_bf16 v[128:131], a[192:195], v[212:215], v[128:131]
  buffer_load_dwordx4 v[84:87], v18, s[48:51], s10 offen offset:2048 sc1
  v_mfma_f32_16x16x32_bf16 v[128:131], a[172:175], v[208:211], v[128:131]
  v_mfma_f32_16x16x32_bf16 v[132:135], a[176:179], v[208:211], 0
  v_mfma_f32_16x16x32_bf16 v[132:135], a[196:199], v[212:215], v[132:135]
  v_mfma_f32_16x16x32_bf16 v[132:135], a[216:219], v[216:219], v[132:135]
  v_mfma_f32_16x16x32_bf16 v[132:135], a[236:239], v[220:223], v[132:135]
  s_waitcnt vmcnt(17)
  s_lshl_b32 s10, s22, 10
  buffer_load_dwordx4 v[88:91], v18, s[48:51], s10 offen offset:0 sc1
  v_mfma_f32_16x16x32_bf16 v[116:119], a[0:3], v[224:227], v[116:119]
  s_waitcnt vmcnt(17)
  v_mfma_f32_16x16x32_bf16 v[116:119], a[132:135], v[228:231], v[116:119]
  s_waitcnt vmcnt(16)
  v_mfma_f32_16x16x32_bf16 v[116:119], a[152:155], v[232:235], v[116:119]
  s_waitcnt vmcnt(15)
  v_mfma_f32_16x16x32_bf16 v[116:119], a[28:31], v[236:239], v[116:119]
  v_mfma_f32_16x16x32_bf16 v[120:123], a[32:35], v[236:239], v[120:123]
  buffer_load_dwordx4 v[92:95], v18, s[48:51], s10 offen offset:1024 sc1
  v_mfma_f32_16x16x32_bf16 v[120:123], a[156:159], v[232:235], v[120:123]
  v_mfma_f32_16x16x32_bf16 v[120:123], a[136:139], v[228:231], v[120:123]
  v_mfma_f32_16x16x32_bf16 v[120:123], a[4:7], v[224:227], v[120:123]
  v_mfma_f32_16x16x32_bf16 v[124:127], a[8:11], v[224:227], v[124:127]
  v_mfma_f32_16x16x32_bf16 v[124:127], a[140:143], v[228:231], v[124:127]
  buffer_load_dwordx4 v[176:179], v18, s[48:51], s10 offen offset:2048 sc1
  v_mfma_f32_16x16x32_bf16 v[124:127], a[16:19], v[232:235], v[124:127]
  v_mfma_f32_16x16x32_bf16 v[124:127], a[36:39], v[236:239], v[124:127]
  v_mfma_f32_16x16x32_bf16 v[128:131], a[40:43], v[236:239], v[128:131]
  v_mfma_f32_16x16x32_bf16 v[128:131], a[20:23], v[232:235], v[128:131]
  s_lshl_b32 s10, s25, 10
  buffer_load_dwordx4 v[180:183], v18, s[48:51], s10 offen offset:0 sc1
  v_mfma_f32_16x16x32_bf16 v[128:131], a[144:147], v[228:231], v[128:131]
  v_mfma_f32_16x16x32_bf16 v[128:131], a[12:15], v[224:227], v[128:131]
  v_mfma_f32_16x16x32_bf16 v[132:135], a[128:131], v[224:227], v[132:135]
  v_mfma_f32_16x16x32_bf16 v[132:135], a[148:151], v[228:231], v[132:135]
  v_mfma_f32_16x16x32_bf16 v[132:135], a[24:27], v[232:235], v[132:135]
  buffer_load_dwordx4 v[184:187], v18, s[48:51], s10 offen offset:1024 sc1
  v_mfma_f32_16x16x32_bf16 v[132:135], a[44:47], v[236:239], v[132:135]
  s_waitcnt vmcnt(18)
  v_mfma_f32_16x16x32_bf16 v[116:119], a[48:51], v[240:243], v[116:119]
  s_waitcnt vmcnt(17)
  v_mfma_f32_16x16x32_bf16 v[116:119], a[68:71], v[244:247], v[116:119]
  s_waitcnt vmcnt(16)
  v_mfma_f32_16x16x32_bf16 v[116:119], a[88:91], v[248:251], v[116:119]
  s_waitcnt vmcnt(15)
  v_mfma_f32_16x16x32_bf16 v[116:119], a[108:111], v[252:255], v[116:119]
  buffer_load_dwordx4 v[188:191], v18, s[48:51], s10 offen offset:2048 sc1
  v_mfma_f32_16x16x32_bf16 v[120:123], a[112:115], v[252:255], v[120:123]
  v_mfma_f32_16x16x32_bf16 v[120:123], a[92:95], v[248:251], v[120:123]
  v_mfma_f32_16x16x32_bf16 v[120:123], a[72:75], v[244:247], v[120:123]
  v_mfma_f32_16x16x32_bf16 v[120:123], a[52:55], v[240:243], v[120:123]
  v_mfma_f32_16x16x32_bf16 v[124:127], a[56:59], v[240:243], v[124:127]
  s_lshl_b32 s10, s16, 10
  buffer_load_dwordx4 v[192:195], v19, s[48:51], s10 offen offset:0 sc1
  v_mfma_f32_16x16x32_bf16 v[124:127], a[76:79], v[244:247], v[124:127]
  v_mfma_f32_16x16x32_bf16 v[124:127], a[96:99], v[248:251], v[124:127]
  v_mfma_f32_16x16x32_bf16 v[124:127], a[116:119], v[252:255], v[124:127]
  v_mfma_f32_16x16x32_bf16 v[128:131], a[120:123], v[252:255], v[128:131]
  v_mfma_f32_16x16x32_bf16 v[128:131], a[100:103], v[248:251], v[128:131]
  buffer_load_dwordx4 v[196:199], v19, s[48:51], s10 offen offset:1024 sc1
  v_mfma_f32_16x16x32_bf16 v[128:131], a[80:83], v[244:247], v[128:131]
  v_mfma_f32_16x16x32_bf16 v[128:131], a[60:63], v[240:243], v[128:131]
  s_waitcnt vmcnt(13)
  buffer_atomic_add v30, v29, s[48:51], s75 offen sc1
  v_mfma_f32_16x16x32_bf16 v[132:135], a[64:67], v[240:243], v[132:135]
  v_mfma_f32_16x16x32_bf16 v[132:135], a[84:87], v[244:247], v[132:135]
  v_mfma_f32_16x16x32_bf16 v[132:135], a[104:107], v[248:251], v[132:135]
  buffer_load_dwordx4 v[200:203], v19, s[48:51], s10 offen offset:2048 sc1
  v_mfma_f32_16x16x32_bf16 v[132:135], a[124:127], v[252:255], v[132:135]
  v_mfma_f32_16x16x32_bf16 v[136:139], a[160:163], v[64:67], 0
  s_barrier
  v_mfma_f32_16x16x32_bf16 v[136:139], a[180:183], v[68:71], v[136:139]
  s_waitcnt vmcnt(14)
  v_mfma_f32_16x16x32_bf16 v[136:139], a[200:203], v[72:75], v[136:139]
  s_waitcnt vmcnt(12)
  v_mfma_f32_16x16x32_bf16 v[136:139], a[220:223], v[76:79], v[136:139]
  s_lshl_b32 s10, s19, 10
  buffer_load_dwordx4 v[204:207], v19, s[48:51], s10 offen offset:0 sc1
  v_mfma_f32_16x16x32_bf16 v[140:143], a[224:227], v[76:79], 0
  ds_write_b128 v20, v[116:119] offset:0
  v_mfma_f32_16x16x32_bf16 v[140:143], a[204:207], v[72:75], v[140:143]
  v_mfma_f32_16x16x32_bf16 v[140:143], a[184:187], v[68:71], v[140:143]
  v_mfma_f32_16x16x32_bf16 v[140:143], a[164:167], v[64:67], v[140:143]
  buffer_load_dwordx4 v[208:211], v19, s[48:51], s10 offen offset:1024 sc1
  v_mfma_f32_16x16x32_bf16 v[144:147], a[168:171], v[64:67], 0
  ds_write_b128 v20, v[120:123] offset:1024
  v_mfma_f32_16x16x32_bf16 v[144:147], a[188:191], v[68:71], v[144:147]
  v_mfma_f32_16x16x32_bf16 v[144:147], a[208:211], v[72:75], v[144:147]
  v_mfma_f32_16x16x32_bf16 v[144:147], a[228:231], v[76:79], v[144:147]
  v_mfma_f32_16x16x32_bf16 v[148:151], a[232:235], v[76:79], 0
  buffer_load_dwordx4 v[212:215], v19, s[48:51], s10 offen offset:2048 sc1
  ds_write_b128 v20, v[124:127] offset:2048
  v_mfma_f32_16x16x32_bf16 v[148:151], a[212:215], v[72:75], v[148:151]
  v_mfma_f32_16x16x32_bf16 v[148:151], a[192:195], v[68:71], v[148:151]
  v_mfma_f32_16x16x32_bf16 v[148:151], a[172:175], v[64:67], v[148:151]
  v_mfma_f32_16x16x32_bf16 v[152:155], a[176:179], v[64:67], 0
  ds_write_b128 v20, v[128:131] offset:3072
  v_mfma_f32_16x16x32_bf16 v[152:155], a[196:199], v[68:71], v[152:155]
  s_lshl_b32 s10, s22, 10
  buffer_load_dwordx4 v[216:219], v19, s[48:51], s10 offen offset:0 sc1
  v_mfma_f32_16x16x32_bf16 v[152:155], a[216:219], v[72:75], v[152:155]
  v_mfma_f32_16x16x32_bf16 v[152:155], a[236:239], v[76:79], v[152:155]
  s_waitcnt vmcnt(15)
  v_mfma_f32_16x16x32_bf16 v[136:139], a[0:3], v[80:83], v[136:139]
  s_waitcnt vmcnt(14)
  ds_write_b128 v20, v[132:135] offset:4096
  v_mfma_f32_16x16x32_bf16 v[136:139], a[132:135], v[84:87], v[136:139]
  s_waitcnt vmcnt(13)
  v_mfma_f32_16x16x32_bf16 v[136:139], a[152:155], v[88:91], v[136:139]
  s_waitcnt vmcnt(12)
  buffer_load_dwordx4 v[220:223], v19, s[48:51], s10 offen offset:1024 sc1
  v_mfma_f32_16x16x32_bf16 v[136:139], a[28:31], v[92:95], v[136:139]
  v_mfma_f32_16x16x32_bf16 v[140:143], a[32:35], v[92:95], v[140:143]
  v_mfma_f32_16x16x32_bf16 v[140:143], a[156:159], v[88:91], v[140:143]
  v_mfma_f32_16x16x32_bf16 v[140:143], a[136:139], v[84:87], v[140:143]
  v_mfma_f32_16x16x32_bf16 v[140:143], a[4:7], v[80:83], v[140:143]
  buffer_load_dwordx4 v[224:227], v19, s[48:51], s10 offen offset:2048 sc1
  v_mfma_f32_16x16x32_bf16 v[144:147], a[8:11], v[80:83], v[144:147]
  v_mfma_f32_16x16x32_bf16 v[144:147], a[140:143], v[84:87], v[144:147]
  v_mfma_f32_16x16x32_bf16 v[144:147], a[16:19], v[88:91], v[144:147]
  v_mfma_f32_16x16x32_bf16 v[144:147], a[36:39], v[92:95], v[144:147]
  v_mfma_f32_16x16x32_bf16 v[148:151], a[40:43], v[92:95], v[148:151]
  s_lshl_b32 s10, s25, 10
  buffer_load_dwordx4 v[228:231], v19, s[48:51], s10 offen offset:0 sc1
  v_mfma_f32_16x16x32_bf16 v[148:151], a[20:23], v[88:91], v[148:151]
  v_mfma_f32_16x16x32_bf16 v[148:151], a[144:147], v[84:87], v[148:151]
  v_mfma_f32_16x16x32_bf16 v[148:151], a[12:15], v[80:83], v[148:151]
  v_mfma_f32_16x16x32_bf16 v[152:155], a[128:131], v[80:83], v[152:155]
  v_mfma_f32_16x16x32_bf16 v[152:155], a[148:151], v[84:87], v[152:155]
  buffer_load_dwordx4 v[232:235], v19, s[48:51], s10 offen offset:1024 sc1
  v_mfma_f32_16x16x32_bf16 v[152:155], a[24:27], v[88:91], v[152:155]
  v_mfma_f32_16x16x32_bf16 v[152:155], a[44:47], v[92:95], v[152:155]
  s_waitcnt vmcnt(15)
  v_mfma_f32_16x16x32_bf16 v[136:139], a[48:51], v[176:179], v[136:139]
  s_waitcnt vmcnt(14)
  v_mfma_f32_16x16x32_bf16 v[136:139], a[68:71], v[180:183], v[136:139]
  s_waitcnt vmcnt(13)
  buffer_load_dwordx4 v[236:239], v19, s[48:51], s10 offen offset:2048 sc1
  v_mfma_f32_16x16x32_bf16 v[136:139], a[88:91], v[184:187], v[136:139]
  s_waitcnt vmcnt(13)
  v_mfma_f32_16x16x32_bf16 v[136:139], a[108:111], v[188:191], v[136:139]
  v_mfma_f32_16x16x32_bf16 v[140:143], a[112:115], v[188:191], v[140:143]
  v_mfma_f32_16x16x32_bf16 v[140:143], a[92:95], v[184:187], v[140:143]
  v_mfma_f32_16x16x32_bf16 v[140:143], a[72:75], v[180:183], v[140:143]
  s_lshl_b32 s10, s16, 10
  buffer_load_dwordx4 v[240:243], v16, s[48:51], s10 offen offset:0 sc1
  v_mfma_f32_16x16x32_bf16 v[140:143], a[52:55], v[176:179], v[140:143]
  v_mfma_f32_16x16x32_bf16 v[144:147], a[56:59], v[176:179], v[144:147]
  v_mfma_f32_16x16x32_bf16 v[144:147], a[76:79], v[180:183], v[144:147]
  v_mfma_f32_16x16x32_bf16 v[144:147], a[96:99], v[184:187], v[144:147]
  v_mfma_f32_16x16x32_bf16 v[144:147], a[116:119], v[188:191], v[144:147]
  buffer_load_dwordx4 v[244:247], v16, s[48:51], s10 offen offset:1024 sc1
  v_mfma_f32_16x16x32_bf16 v[148:151], a[120:123], v[188:191], v[148:151]
  v_mfma_f32_16x16x32_bf16 v[148:151], a[100:103], v[184:187], v[148:151]
  v_mfma_f32_16x16x32_bf16 v[148:151], a[80:83], v[180:183], v[148:151]
  v_mfma_f32_16x16x32_bf16 v[148:151], a[60:63], v[176:179], v[148:151]
  v_mfma_f32_16x16x32_bf16 v[152:155], a[64:67], v[176:179], v[152:155]
  buffer_load_dwordx4 v[248:251], v16, s[48:51], s10 offen offset:2048 sc1
  v_mfma_f32_16x16x32_bf16 v[152:155], a[84:87], v[180:183], v[152:155]
  v_mfma_f32_16x16x32_bf16 v[152:155], a[104:107], v[184:187], v[152:155]
  v_mfma_f32_16x16x32_bf16 v[152:155], a[124:127], v[188:191], v[152:155]
  s_waitcnt vmcnt(15)
  v_mfma_f32_16x16x32_bf16 v[156:159], a[160:163], v[192:195], 0
  s_waitcnt vmcnt(14)
  v_mfma_f32_16x16x32_bf16 v[156:159], a[180:183], v[196:199], v[156:159]
  s_waitcnt vmcnt(12)
  s_lshl_b32 s10, s19, 10
  buffer_load_dwordx4 v[252:255], v16, s[48:51], s10 offen offset:0 sc1
  v_mfma_f32_16x16x32_bf16 v[156:159], a[200:203], v[200:203], v[156:159]
  s_waitcnt vmcnt(12)
  v_mfma_f32_16x16x32_bf16 v[156:159], a[220:223], v[204:207], v[156:159]
  v_mfma_f32_16x16x32_bf16 v[160:163], a[224:227], v[204:207], 0
  ds_write_b128 v21, v[136:139] offset:0
  v_mfma_f32_16x16x32_bf16 v[160:163], a[204:207], v[200:203], v[160:163]
  v_mfma_f32_16x16x32_bf16 v[160:163], a[184:187], v[196:199], v[160:163]
  buffer_load_dwordx4 v[64:67], v16, s[48:51], s10 offen offset:1024 sc1
  v_mfma_f32_16x16x32_bf16 v[160:163], a[164:167], v[192:195], v[160:163]
  v_mfma_f32_16x16x32_bf16 v[164:167], a[168:171], v[192:195], 0
  ds_write_b128 v21, v[140:143] offset:1024
  v_mfma_f32_16x16x32_bf16 v[164:167], a[188:191], v[196:199], v[164:167]
  v_mfma_f32_16x16x32_bf16 v[164:167], a[208:211], v[200:203], v[164:167]
  v_mfma_f32_16x16x32_bf16 v[164:167], a[228:231], v[204:207], v[164:167]
  buffer_load_dwordx4 v[68:71], v16, s[48:51], s10 offen offset:2048 sc1
  v_mfma_f32_16x16x32_bf16 v[168:171], a[232:235], v[204:207], 0
  ds_write_b128 v21, v[144:147] offset:2048
  v_mfma_f32_16x16x32_bf16 v[168:171], a[212:215], v[200:203], v[168:171]
  v_mfma_f32_16x16x32_bf16 v[168:171], a[192:195], v[196:199], v[168:171]
  v_mfma_f32_16x16x32_bf16 v[168:171], a[172:175], v[192:195], v[168:171]
  s_lshl_b32 s10, s22, 10
  buffer_load_dwordx4 v[72:75], v16, s[48:51], s10 offen offset:0 sc1
  v_mfma_f32_16x16x32_bf16 v[172:175], a[176:179], v[192:195], 0
  ds_write_b128 v21, v[148:151] offset:3072
  v_mfma_f32_16x16x32_bf16 v[172:175], a[196:199], v[196:199], v[172:175]
  v_mfma_f32_16x16x32_bf16 v[172:175], a[216:219], v[200:203], v[172:175]
  v_mfma_f32_16x16x32_bf16 v[172:175], a[236:239], v[204:207], v[172:175]
  s_waitcnt vmcnt(14)
  v_mfma_f32_16x16x32_bf16 v[156:159], a[0:3], v[208:211], v[156:159]
  s_waitcnt vmcnt(13)
  buffer_load_dwordx4 v[76:79], v16, s[48:51], s10 offen offset:1024 sc1
  ds_write_b128 v21, v[152:155] offset:4096
  v_mfma_f32_16x16x32_bf16 v[156:159], a[132:135], v[212:215], v[156:159]
  s_waitcnt vmcnt(13)
  v_mfma_f32_16x16x32_bf16 v[156:159], a[152:155], v[216:219], v[156:159]
  s_waitcnt vmcnt(12)
  v_mfma_f32_16x16x32_bf16 v[156:159], a[28:31], v[220:223], v[156:159]
  v_mfma_f32_16x16x32_bf16 v[160:163], a[32:35], v[220:223], v[160:163]
  v_mfma_f32_16x16x32_bf16 v[160:163], a[156:159], v[216:219], v[160:163]
  buffer_load_dwordx4 v[80:83], v16, s[48:51], s10 offen offset:2048 sc1
  v_mfma_f32_16x16x32_bf16 v[160:163], a[136:139], v[212:215], v[160:163]
  v_mfma_f32_16x16x32_bf16 v[160:163], a[4:7], v[208:211], v[160:163]
  v_mfma_f32_16x16x32_bf16 v[164:167], a[8:11], v[208:211], v[164:167]
  v_mfma_f32_16x16x32_bf16 v[164:167], a[140:143], v[212:215], v[164:167]
  v_mfma_f32_16x16x32_bf16 v[164:167], a[16:19], v[216:219], v[164:167]
  s_lshl_b32 s10, s25, 10
  buffer_load_dwordx4 v[84:87], v16, s[48:51], s10 offen offset:0 sc1
  v_mfma_f32_16x16x32_bf16 v[164:167], a[36:39], v[220:223], v[164:167]
  v_mfma_f32_16x16x32_bf16 v[168:171], a[40:43], v[220:223], v[168:171]
  v_mfma_f32_16x16x32_bf16 v[168:171], a[20:23], v[216:219], v[168:171]
  v_mfma_f32_16x16x32_bf16 v[168:171], a[144:147], v[212:215], v[168:171]
  v_mfma_f32_16x16x32_bf16 v[168:171], a[12:15], v[208:211], v[168:171]
  buffer_load_dwordx4 v[88:91], v16, s[48:51], s10 offen offset:1024 sc1
  v_mfma_f32_16x16x32_bf16 v[172:175], a[128:131], v[208:211], v[172:175]
  v_mfma_f32_16x16x32_bf16 v[172:175], a[148:151], v[212:215], v[172:175]
  v_mfma_f32_16x16x32_bf16 v[172:175], a[24:27], v[216:219], v[172:175]
  v_mfma_f32_16x16x32_bf16 v[172:175], a[44:47], v[220:223], v[172:175]
  s_waitcnt vmcnt(14)
  v_mfma_f32_16x16x32_bf16 v[156:159], a[48:51], v[224:227], v[156:159]
  s_waitcnt vmcnt(13)
  buffer_load_dwordx4 v[92:95], v16, s[48:51], s10 offen offset:2048 sc1
  v_mfma_f32_16x16x32_bf16 v[156:159], a[68:71], v[228:231], v[156:159]
  s_waitcnt vmcnt(13)
  v_mfma_f32_16x16x32_bf16 v[156:159], a[88:91], v[232:235], v[156:159]
  s_waitcnt vmcnt(12)
  v_mfma_f32_16x16x32_bf16 v[156:159], a[108:111], v[236:239], v[156:159]
  v_mfma_f32_16x16x32_bf16 v[160:163], a[112:115], v[236:239], v[160:163]
  v_mfma_f32_16x16x32_bf16 v[160:163], a[92:95], v[232:235], v[160:163]
  s_add_u32 m0, s8, 147456
  s_add_u32 s11, s8, 311296
  buffer_load_dwordx4 v31, s[48:51], s11 offen offset:0 sc1 lds
  v_mfma_f32_16x16x32_bf16 v[160:163], a[72:75], v[228:231], v[160:163]
  v_mfma_f32_16x16x32_bf16 v[160:163], a[52:55], v[224:227], v[160:163]
  v_mfma_f32_16x16x32_bf16 v[164:167], a[56:59], v[224:227], v[164:167]
  v_mfma_f32_16x16x32_bf16 v[164:167], a[76:79], v[228:231], v[164:167]
  buffer_load_dwordx4 v31, s[48:51], s11 offen offset:1024 sc1 lds
  v_mfma_f32_16x16x32_bf16 v[164:167], a[96:99], v[232:235], v[164:167]
  v_mfma_f32_16x16x32_bf16 v[164:167], a[116:119], v[236:239], v[164:167]
  v_mfma_f32_16x16x32_bf16 v[168:171], a[120:123], v[236:239], v[168:171]
  v_mfma_f32_16x16x32_bf16 v[168:171], a[100:103], v[232:235], v[168:171]
  v_mfma_f32_16x16x32_bf16 v[168:171], a[80:83], v[228:231], v[168:171]
  buffer_load_dwordx4 v31, s[48:51], s11 offen offset:2048 sc1 lds
  v_mfma_f32_16x16x32_bf16 v[168:171], a[60:63], v[224:227], v[168:171]
  v_mfma_f32_16x16x32_bf16 v[172:175], a[64:67], v[224:227], v[172:175]
  v_mfma_f32_16x16x32_bf16 v[172:175], a[84:87], v[228:231], v[172:175]
  v_mfma_f32_16x16x32_bf16 v[172:175], a[104:107], v[232:235], v[172:175]
  v_mfma_f32_16x16x32_bf16 v[172:175], a[124:127], v[236:239], v[172:175]
  s_waitcnt vmcnt(14)
  buffer_load_dwordx4 v31, s[48:51], s11 offen offset:3072 sc1 lds
  v_mfma_f32_16x16x32_bf16 v[96:99], a[160:163], v[240:243], 0
  s_waitcnt vmcnt(14)
  v_mfma_f32_16x16x32_bf16 v[96:99], a[180:183], v[244:247], v[96:99]
  s_waitcnt vmcnt(13)
  v_mfma_f32_16x16x32_bf16 v[96:99], a[200:203], v[248:251], v[96:99]
  s_waitcnt vmcnt(12)
  buffer_load_dword v15, v58, s[48:51], 0 offen sc1
  v_mfma_f32_16x16x32_bf16 v[96:99], a[220:223], v[252:255], v[96:99]
  s_mov_b32 m0, s8
  s_add_u32 s11, s8, 327680
  buffer_load_dwordx4 v31, s[48:51], s11 offen offset:0 sc1 lds
  v_mfma_f32_16x16x32_bf16 v[100:103], a[224:227], v[252:255], 0
  ds_write_b128 v22, v[156:159] offset:0
  v_mfma_f32_16x16x32_bf16 v[100:103], a[204:207], v[248:251], v[100:103]
  v_mfma_f32_16x16x32_bf16 v[100:103], a[184:187], v[244:247], v[100:103]
  v_mfma_f32_16x16x32_bf16 v[100:103], a[164:167], v[240:243], v[100:103]
  v_mfma_f32_16x16x32_bf16 v[104:107], a[168:171], v[240:243], 0
  buffer_load_dwordx4 v31, s[48:51], s11 offen offset:1024 sc1 lds
  ds_write_b128 v22, v[160:163] offset:1024
  v_mfma_f32_16x16x32_bf16 v[104:107], a[188:191], v[244:247], v[104:107]
  v_mfma_f32_16x16x32_bf16 v[104:107], a[208:211], v[248:251], v[104:107]
  v_mfma_f32_16x16x32_bf16 v[104:107], a[228:231], v[252:255], v[104:107]
  v_mfma_f32_16x16x32_bf16 v[108:111], a[232:235], v[252:255], 0
  ds_write_b128 v22, v[164:167] offset:2048
  v_mfma_f32_16x16x32_bf16 v[108:111], a[212:215], v[248:251], v[108:111]
  buffer_load_dwordx4 v31, s[48:51], s11 offen offset:2048 sc1 lds
  v_mfma_f32_16x16x32_bf16 v[108:111], a[192:195], v[244:247], v[108:111]
  v_mfma_f32_16x16x32_bf16 v[108:111], a[172:175], v[240:243], v[108:111]
  v_mfma_f32_16x16x32_bf16 v[112:115], a[176:179], v[240:243], 0
  ds_write_b128 v22, v[168:171] offset:3072
  v_mfma_f32_16x16x32_bf16 v[112:115], a[196:199], v[244:247], v[112:115]
  buffer_load_dwordx4 v31, s[48:51], s11 offen offset:3072 sc1 lds
  v_mfma_f32_16x16x32_bf16 v[112:115], a[216:219], v[248:251], v[112:115]
  v_mfma_f32_16x16x32_bf16 v[112:115], a[236:239], v[252:255], v[112:115]
  s_waitcnt vmcnt(16)
  v_mfma_f32_16x16x32_bf16 v[96:99], a[0:3], v[64:67], v[96:99]
  s_waitcnt vmcnt(15)
  ds_write_b128 v22, v[172:175] offset:4096
  v_sub_f32 v23, 1.0, v23
  v_add_u32 v61, 81920, v59
  v_cvt_pk_bf16_f32 v23, v23, v23
  v_add_u32 v62, 147456, v59
  v_lshlrev_b32 v23, 16, v23
  v_mfma_f32_16x16x32_bf16 v[96:99], a[132:135], v[68:71], v[96:99]
  s_waitcnt vmcnt(14)
  v_mfma_f32_16x16x32_bf16 v[96:99], a[152:155], v[72:75], v[96:99]
  s_waitcnt vmcnt(13)
  s_lshl_b32 s6, s3, 10
  s_add_u32 m0, s6, 16384
  s_add_u32 s11, s6, 344064
  buffer_load_dwordx4 v31, s[48:51], s11 offen offset:0 sc1 lds
  v_mfma_f32_16x16x32_bf16 v[96:99], a[28:31], v[76:79], v[96:99]
  v_mfma_f32_16x16x32_bf16 v[100:103], a[32:35], v[76:79], v[100:103]
  v_mfma_f32_16x16x32_bf16 v[100:103], a[156:159], v[72:75], v[100:103]
  v_mfma_f32_16x16x32_bf16 v[100:103], a[136:139], v[68:71], v[100:103]
  v_mfma_f32_16x16x32_bf16 v[100:103], a[4:7], v[64:67], v[100:103]
  s_waitcnt vmcnt(5)
  v_cmp_gt_u32 vcc, 4, v15
  s_cbranch_vccnz SL_fo
OK_fo:
  v_mfma_f32_16x16x32_bf16 v[104:107], a[8:11], v[64:67], v[104:107]
  s_mov_b32 s10, 49152
  buffer_load_dwordx4 v[176:179], v16, s[48:51], s10 offen offset:0 sc1
  v_mfma_f32_16x16x32_bf16 v[104:107], a[140:143], v[68:71], v[104:107]
  v_mfma_f32_16x16x32_bf16 v[104:107], a[16:19], v[72:75], v[104:107]
  v_mfma_f32_16x16x32_bf16 v[104:107], a[36:39], v[76:79], v[104:107]
  v_mfma_f32_16x16x32_bf16 v[108:111], a[40:43], v[76:79], v[108:111]
  buffer_load_dwordx4 v[180:183], v16, s[48:51], s10 offen offset:1024 sc1
  v_mfma_f32_16x16x32_bf16 v[108:111], a[20:23], v[72:75], v[108:111]
  v_mfma_f32_16x16x32_bf16 v[108:111], a[144:147], v[68:71], v[108:111]
  v_mfma_f32_16x16x32_bf16 v[108:111], a[12:15], v[64:67], v[108:111]
  v_mfma_f32_16x16x32_bf16 v[112:115], a[128:131], v[64:67], v[112:115]
  buffer_load_dwordx4 v[184:187], v16, s[48:51], s10 offen offset:2048 sc1
  v_mfma_f32_16x16x32_bf16 v[112:115], a[148:151], v[68:71], v[112:115]
  v_mfma_f32_16x16x32_bf16 v[112:115], a[24:27], v[72:75], v[112:115]
  v_mfma_f32_16x16x32_bf16 v[112:115], a[44:47], v[76:79], v[112:115]
  v_mfma_f32_16x16x32_bf16 v[96:99], a[48:51], v[80:83], v[96:99]
  buffer_load_dwordx4 v[188:191], v16, s[48:51], s10 offen offset:3072 sc1
  v_mfma_f32_16x16x32_bf16 v[96:99], a[68:71], v[84:87], v[96:99]
  v_mfma_f32_16x16x32_bf16 v[96:99], a[88:91], v[88:91], v[96:99]
  v_mfma_f32_16x16x32_bf16 v[96:99], a[108:111], v[92:95], v[96:99]
  v_mfma_f32_16x16x32_bf16 v[100:103], a[112:115], v[92:95], v[100:103]
  s_mov_b32 s10, 53248
  buffer_load_dwordx4 v[192:195], v16, s[48:51], s10 offen offset:0 sc1
  v_mfma_f32_16x16x32_bf16 v[100:103], a[92:95], v[88:91], v[100:103]
  v_mfma_f32_16x16x32_bf16 v[100:103], a[72:75], v[84:87], v[100:103]
  v_mfma_f32_16x16x32_bf16 v[100:103], a[52:55], v[80:83], v[100:103]
  v_mfma_f32_16x16x32_bf16 v[104:107], a[56:59], v[80:83], v[104:107]
  buffer_load_dwordx4 v[196:199], v16, s[48:51], s10 offen offset:1024 sc1
  v_mfma_f32_16x16x32_bf16 v[104:107], a[76:79], v[84:87], v[104:107]
  v_mfma_f32_16x16x32_bf16 v[104:107], a[96:99], v[88:91], v[104:107]
  v_mfma_f32_16x16x32_bf16 v[104:107], a[116:119], v[92:95], v[104:107]
  v_mfma_f32_16x16x32_bf16 v[108:111], a[120:123], v[92:95], v[108:111]
  buffer_load_dwordx4 v[200:203], v16, s[48:51], s10 offen offset:2048 sc1
  v_mfma_f32_16x16x32_bf16 v[108:111], a[100:103], v[88:91], v[108:111]
  v_mfma_f32_16x16x32_bf16 v[108:111], a[80:83], v[84:87], v[108:111]
  v_mfma_f32_16x16x32_bf16 v[108:111], a[60:63], v[80:83], v[108:111]
  v_mfma_f32_16x16x32_bf16 v[112:115], a[64:67], v[80:83], v[112:115]
  buffer_load_dwordx4 v[204:207], v16, s[48:51], s10 offen offset:3072 sc1
  v_mfma_f32_16x16x32_bf16 v[112:115], a[84:87], v[84:87], v[112:115]
  v_mfma_f32_16x16x32_bf16 v[112:115], a[104:107], v[88:91], v[112:115]
  v_mfma_f32_16x16x32_bf16 v[112:115], a[124:127], v[92:95], v[112:115]
  s_mov_b32 s10, 57344
  buffer_load_dwordx4 v[208:211], v16, s[48:51], s10 offen offset:0 sc1
  buffer_load_dwordx4 v[212:215], v16, s[48:51], s10 offen offset:1024 sc1
  buffer_load_dwordx4 v[216:219], v16, s[48:51], s10 offen offset:2048 sc1
  s_waitcnt lgkmcnt(0) vmcnt(11)
  s_barrier
  ds_read_b128 a[0:3], v61 offset:0
  ds_read_b128 a[4:7], v61 offset:1024
  ds_read_b128 a[8:11], v61 offset:2048
  ds_read_b128 a[12:15], v61 offset:3072
  ds_read_b128 a[16:19], v61 offset:4096
  ds_read_b128 a[20:23], v61 offset:5120
  ds_read_b128 a[24:27], v61 offset:6144
  ds_read_b128 a[28:31], v61 offset:7168
  ds_read_b128 a[32:35], v61 offset:8192
  s_waitcnt vmcnt(10) lgkmcnt(8)
  v_mfma_f32_16x16x32_bf16 v[116:119], a[0:3], v[176:179], 0
  s_waitcnt lgkmcnt(7)
  ds_read_b128 a[36:39], v61 offset:9216
  buffer_load_dwordx4 v[220:223], v16, s[48:51], s10 offen offset:3072 sc1
  v_mfma_f32_16x16x32_bf16 v[120:123], a[4:7], v[176:179], 0
  s_waitcnt lgkmcnt(7)
  ds_read_b128 a[40:43], v61 offset:10240
  v_mfma_f32_16x16x32_bf16 v[124:127], a[8:11], v[176:179], 0
  s_waitcnt lgkmcnt(7)
  ds_read_b128 a[44:47], v61 offset:11264
  ds_read_b128 v[136:139], v11 offset:0
  v_mfma_f32_16x16x32_bf16 v[128:131], a[12:15], v[176:179], 0
  s_waitcnt lgkmcnt(8)
  ds_read_b128 a[48:51], v61 offset:12288
  v_mfma_f32_16x16x32_bf16 v[132:135], a[16:19], v[176:179], 0
  s_waitcnt vmcnt(10) lgkmcnt(8)
  ds_read_b128 a[52:55], v61 offset:13312
  v_mfma_f32_16x16x32_bf16 v[116:119], a[20:23], v[180:183], v[116:119]
  s_waitcnt lgkmcnt(8)
  ds_read_b128 a[56:59], v61 offset:14336
  s_mov_b32 s10, 61440
  buffer_load_dwordx4 v[224:227], v16, s[48:51], s10 offen offset:0 sc1
  v_mfma_f32_16x16x32_bf16 v[120:123], a[24:27], v[180:183], v[120:123]
  s_waitcnt lgkmcnt(8)
  ds_read_b128 a[60:63], v61 offset:15360
  v_mfma_f32_16x16x32_bf16 v[124:127], a[28:31], v[180:183], v[124:127]
  s_waitcnt lgkmcnt(8)
  ds_read_b128 a[0:3], v61 offset:16384
  ds_read_b128 v[140:143], v11 offset:5120
  v_mfma_f32_16x16x32_bf16 v[128:131], a[32:35], v[180:183], v[128:131]
  s_waitcnt lgkmcnt(9)
  ds_read_b128 a[4:7], v61 offset:17408
  v_mfma_f32_16x16x32_bf16 v[132:135], a[36:39], v[180:183], v[132:135]
  s_waitcnt vmcnt(10) lgkmcnt(9)
  ds_read_b128 a[8:11], v61 offset:18432
  v_mfma_f32_16x16x32_bf16 v[116:119], a[40:43], v[184:187], v[116:119]
  s_waitcnt lgkmcnt(9)
  ds_read_b128 a[12:15], v61 offset:19456
  buffer_load_dwordx4 v[228:231], v16, s[48:51], s10 offen offset:1024 sc1
  v_mfma_f32_16x16x32_bf16 v[120:123], a[44:47], v[184:187], v[120:123]
  s_waitcnt lgkmcnt(8)
  ds_read_b128 a[16:19], v61 offset:20480
  v_mfma_f32_16x16x32_bf16 v[124:127], a[48:51], v[184:187], v[124:127]
  s_waitcnt lgkmcnt(8)
  ds_read_b128 a[20:23], v61 offset:21504
  ds_read_b128 v[144:147], v11 offset:10240
  v_mfma_f32_16x16x32_bf16 v[128:131], a[52:55], v[184:187], v[128:131]
  s_waitcnt lgkmcnt(9)
  ds_read_b128 a[24:27], v61 offset:22528
  v_add_f32 v96, v96, v136
  v_mfma_f32_16x16x32_bf16 v[132:135], a[56:59], v[184:187], v[132:135]
  s_waitcnt vmcnt(10) lgkmcnt(9)
  ds_read_b128 a[28:31], v61 offset:23552
  v_add_f32 v97, v97, v137
  v_mfma_f32_16x16x32_bf16 v[116:119], a[60:63], v[188:191], v[116:119]
  s_waitcnt lgkmcnt(9)
  ds_read_b128 a[32:35], v61 offset:24576
  buffer_load_dwordx4 v[232:235], v16, s[48:51], s10 offen offset:2048 sc1
  v_add_f32 v98, v98, v138
  v_mfma_f32_16x16x32_bf16 v[120:123], a[0:3], v[188:191], v[120:123]
  s_waitcnt lgkmcnt(8)
  ds_read_b128 a[36:39], v61 offset:25600
  v_add_f32 v99, v99, v139
  v_mfma_f32_16x16x32_bf16 v[124:127], a[4:7], v[188:191], v[124:127]
  s_waitcnt lgkmcnt(8)
  ds_read_b128 a[40:43], v61 offset:26624
  ds_read_b128 v[148:151], v11 offset:1024
  v_mfma_f32_16x16x32_bf16 v[128:131], a[8:11], v[188:191], v[128:131]
  s_waitcnt lgkmcnt(9)
  ds_read_b128 a[44:47], v61 offset:27648
  v_add_f32 v96, v96, v140
  v_mfma_f32_16x16x32_bf16 v[132:135], a[12:15], v[188:191], v[132:135]
  s_waitcnt vmcnt(10) lgkmcnt(9)
  ds_read_b128 a[48:51], v61 offset:28672
  v_add_f32 v97, v97, v141
  v_mfma_f32_16x16x32_bf16 v[116:119], a[16:19], v[192:195], v[116:119]
  s_waitcnt lgkmcnt(9)
  ds_read_b128 a[52:55], v61 offset:29696
  buffer_load_dwordx4 v[236:239], v16, s[48:51], s10 offen offset:3072 sc1
  v_add_f32 v98, v98, v142
  v_mfma_f32_16x16x32_bf16 v[120:123], a[20:23], v[192:195], v[120:123]
  s_waitcnt lgkmcnt(8)
  ds_read_b128 a[56:59], v61 offset:30720
  v_add_f32 v99, v99, v143
  v_mfma_f32_16x16x32_bf16 v[124:127], a[24:27], v[192:195], v[124:127]
  s_waitcnt lgkmcnt(8)
  ds_read_b128 a[60:63], v61 offset:31744
  ds_read_b128 v[152:155], v11 offset:6144
  v_mfma_f32_16x16x32_bf16 v[128:131], a[28:31], v[192:195], v[128:131]
  s_waitcnt lgkmcnt(9)
  ds_read_b128 a[0:3], v61 offset:32768
  v_add_f32 v96, v96, v144
  v_mfma_f32_16x16x32_bf16 v[132:135], a[32:35], v[192:195], v[132:135]
  s_waitcnt vmcnt(10) lgkmcnt(9)
  ds_read_b128 a[4:7], v61 offset:33792
  v_add_f32 v97, v97, v145
  v_mfma_f32_16x16x32_bf16 v[116:119], a[36:39], v[196:199], v[116:119]
  s_waitcnt lgkmcnt(9)
  ds_read_b128 a[8:11], v61 offset:34816
  s_mov_b32 s10, 65536
  buffer_load_dwordx4 v[240:243], v16, s[48:51], s10 offen offset:0 sc1
  v_add_f32 v98, v98, v146
  v_mfma_f32_16x16x32_bf16 v[120:123], a[40:43], v[196:199], v[120:123]
  s_waitcnt lgkmcnt(8)
  ds_read_b128 a[12:15], v61 offset:35840
  v_add_f32 v99, v99, v147
  v_mfma_f32_16x16x32_bf16 v[124:127], a[44:47], v[196:199], v[124:127]
  s_waitcnt lgkmcnt(8)
  ds_read_b128 a[16:19], v61 offset:36864
  ds_read_b128 v[156:159], v11 offset:11264
  v_mfma_f32_16x16x32_bf16 v[128:131], a[48:51], v[196:199], v[128:131]
  s_waitcnt lgkmcnt(9)
  ds_read_b128 a[20:23], v61 offset:37888
  v_add_f32 v100, v100, v148
  v_mfma_f32_16x16x32_bf16 v[132:135], a[52:55], v[196:199], v[132:135]
  s_waitcnt vmcnt(10) lgkmcnt(9)
  ds_read_b128 a[24:27], v61 offset:38912
  v_add_f32 v101, v101, v149
  v_mfma_f32_16x16x32_bf16 v[116:119], a[56:59], v[200:203], v[116:119]
  s_waitcnt lgkmcnt(9)
  ds_read_b128 a[28:31], v61 offset:39936
  buffer_load_dwordx4 v[244:247], v16, s[48:51], s10 offen offset:1024 sc1
  v_add_f32 v102, v102, v150
  v_mfma_f32_16x16x32_bf16 v[120:123], a[60:63], v[200:203], v[120:123]
  s_waitcnt lgkmcnt(8)
  ds_read_b128 a[32:35], v61 offset:40960
  v_add_f32 v103, v103, v151
  v_mfma_f32_16x16x32_bf16 v[124:127], a[0:3], v[200:203], v[124:127]
  s_waitcnt lgkmcnt(8)
  ds_read_b128 a[36:39], v61 offset:41984
  ds_read_b128 v[160:163], v11 offset:2048
  v_mfma_f32_16x16x32_bf16 v[128:131], a[4:7], v[200:203], v[128:131]
  s_waitcnt lgkmcnt(9)
  ds_read_b128 a[40:43], v61 offset:43008
  v_add_f32 v100, v100, v152
  v_mfma_f32_16x16x32_bf16 v[132:135], a[8:11], v[200:203], v[132:135]
  s_waitcnt vmcnt(10) lgkmcnt(9)
  ds_read_b128 a[44:47], v61 offset:44032
  v_add_f32 v101, v101, v153
  v_mfma_f32_16x16x32_bf16 v[116:119], a[12:15], v[204:207], v[116:119]
  s_waitcnt lgkmcnt(9)
  ds_read_b128 a[48:51], v61 offset:45056
  buffer_load_dwordx4 v[248:251], v16, s[48:51], s10 offen offset:2048 sc1
  v_add_f32 v102, v102, v154
  v_mfma_f32_16x16x32_bf16 v[120:123], a[16:19], v[204:207], v[120:123]
  s_waitcnt lgkmcnt(8)
  ds_read_b128 a[52:55], v61 offset:46080
  v_add_f32 v103, v103, v155
  v_mfma_f32_16x16x32_bf16 v[124:127], a[20:23], v[204:207], v[124:127]
  s_waitcnt lgkmcnt(8)
  ds_read_b128 a[56:59], v61 offset:47104
  ds_read_b128 v[164:167], v11 offset:7168
  v_mfma_f32_16x16x32_bf16 v[128:131], a[24:27], v[204:207], v[128:131]
  s_waitcnt lgkmcnt(9)
  ds_read_b128 a[60:63], v61 offset:48128
  v_add_f32 v100, v100, v156
  v_mfma_f32_16x16x32_bf16 v[132:135], a[28:31], v[204:207], v[132:135]
  s_waitcnt vmcnt(10) lgkmcnt(9)
  ds_read_b128 a[0:3], v61 offset:49152
  v_add_f32 v101, v101, v157
  v_mfma_f32_16x16x32_bf16 v[116:119], a[32:35], v[208:211], v[116:119]
  s_waitcnt lgkmcnt(9)
  ds_read_b128 a[4:7], v61 offset:50176
  buffer_load_dwordx4 v[252:255], v16, s[48:51], s10 offen offset:3072 sc1
  v_add_f32 v102, v102, v158
  v_mfma_f32_16x16x32_bf16 v[120:123], a[36:39], v[208:211], v[120:123]
  s_waitcnt lgkmcnt(8)
  ds_read_b128 a[8:11], v61 offset:51200
  v_add_f32 v103, v103, v159
  v_mfma_f32_16x16x32_bf16 v[124:127], a[40:43], v[208:211], v[124:127]
  s_waitcnt lgkmcnt(8)
  ds_read_b128 a[12:15], v61 offset:52224
  ds_read_b128 v[168:171], v11 offset:12288
  v_mfma_f32_16x16x32_bf16 v[128:131], a[44:47], v[208:211], v[128:131]
  s_waitcnt lgkmcnt(9)
  ds_read_b128 a[16:19], v61 offset:53248
  v_add_f32 v104, v104, v160
  v_mfma_f32_16x16x32_bf16 v[132:135], a[48:51], v[208:211], v[132:135]
  s_waitcnt vmcnt(10) lgkmcnt(9)
  ds_read_b128 a[20:23], v61 offset:54272
  v_add_f32 v105, v105, v161
  v_mfma_f32_16x16x32_bf16 v[116:119], a[52:55], v[212:215], v[116:119]
  s_waitcnt lgkmcnt(9)
  ds_read_b128 a[24:27], v61 offset:55296
  v_add_f32 v106, v106, v162
  v_mfma_f32_16x16x32_bf16 v[120:123], a[56:59], v[212:215], v[120:123]
  s_waitcnt lgkmcnt(8)
  ds_read_b128 a[28:31], v61 offset:56320
  v_add_f32 v107, v107, v163
  v_mfma_f32_16x16x32_bf16 v[124:127], a[60:63], v[212:215], v[124:127]
  s_waitcnt lgkmcnt(8)
  ds_read_b128 a[32:35], v61 offset:57344
  ds_read_b128 v[172:175], v11 offset:3072
  v_mfma_f32_16x16x32_bf16 v[128:131], a[0:3], v[212:215], v[128:131]
  s_waitcnt lgkmcnt(9)
  ds_read_b128 a[36:39], v61 offset:58368
  v_add_f32 v104, v104, v164
  v_mfma_f32_16x16x32_bf16 v[132:135], a[4:7], v[212:215], v[132:135]
  s_waitcnt vmcnt(9) lgkmcnt(9)
  ds_read_b128 a[40:43], v61 offset:59392
  v_add_f32 v105, v105, v165
  v_mfma_f32_16x16x32_bf16 v[116:119], a[8:11], v[216:219], v[116:119]
  s_waitcnt lgkmcnt(9)
  ds_read_b128 a[44:47], v61 offset:60416
  v_add_f32 v106, v106, v166
  v_mfma_f32_16x16x32_bf16 v[120:123], a[12:15], v[216:219], v[120:123]
  s_waitcnt lgkmcnt(8)
  ds_read_b128 a[48:51], v61 offset:61440
  v_add_f32 v107, v107, v167
  v_mfma_f32_16x16x32_bf16 v[124:127], a[16:19], v[216:219], v[124:127]
  s_waitcnt lgkmcnt(8)
  ds_read_b128 a[52:55], v61 offset:62464
  ds_read_b128 v[136:139], v11 offset:8192
  v_mfma_f32_16x16x32_bf16 v[128:131], a[20:23], v[216:219], v[128:131]
  s_waitcnt lgkmcnt(9)
  ds_read_b128 a[56:59], v61 offset:63488
  v_add_f32 v104, v104, v168
  v_mfma_f32_16x16x32_bf16 v[132:135], a[24:27], v[216:219], v[132:135]
  s_waitcnt vmcnt(8) lgkmcnt(9)
  ds_read_b128 a[60:63], v61 offset:64512
  v_add_f32 v105, v105, v169
  v_mfma_f32_16x16x32_bf16 v[116:119], a[28:31], v[220:223], v[116:119]
  s_waitcnt lgkmcnt(9)
  ds_read_b128 a[0:3], v62 offset:0
  v_add_f32 v106, v106, v170
  v_mfma_f32_16x16x32_bf16 v[120:123], a[32:35], v[220:223], v[120:123]
  s_waitcnt lgkmcnt(8)
  ds_read_b128 a[4:7], v62 offset:1024
  v_add_f32 v107, v107, v171
  v_mfma_f32_16x16x32_bf16 v[124:127], a[36:39], v[220:223], v[124:127]
  s_waitcnt lgkmcnt(8)
  ds_read_b128 a[8:11], v62 offset:2048
  ds_read_b128 v[140:143], v11 offset:13312
  v_mfma_f32_16x16x32_bf16 v[128:131], a[40:43], v[220:223], v[128:131]
  s_waitcnt lgkmcnt(9)
  ds_read_b128 a[12:15], v62 offset:3072
  v_add_f32 v108, v108, v172
  v_mfma_f32_16x16x32_bf16 v[132:135], a[44:47], v[220:223], v[132:135]
  s_waitcnt vmcnt(7) lgkmcnt(9)
  ds_read_b128 a[16:19], v62 offset:4096
  v_add_f32 v109, v109, v173
  v_mfma_f32_16x16x32_bf16 v[116:119], a[48:51], v[224:227], v[116:119]
  s_waitcnt lgkmcnt(9)
  ds_read_b128 a[20:23], v62 offset:5120
  v_add_f32 v110, v110, v174
  v_mfma_f32_16x16x32_bf16 v[120:123], a[52:55], v[224:227], v[120:123]
  s_waitcnt lgkmcnt(8)
  ds_read_b128 a[24:27], v62 offset:6144
  v_add_f32 v111, v111, v175
  v_mfma_f32_16x16x32_bf16 v[124:127], a[56:59], v[224:227], v[124:127]
  s_waitcnt lgkmcnt(8)
  ds_read_b128 a[28:31], v62 offset:11264
  ds_read_b128 v[144:147], v11 offset:4096
  v_mfma_f32_16x16x32_bf16 v[128:131], a[60:63], v[224:227], v[128:131]
  s_waitcnt lgkmcnt(9)
  ds_read_b128 a[32:35], v59 offset:0
  v_add_f32 v108, v108, v136
  v_mfma_f32_16x16x32_bf16 v[132:135], a[0:3], v[224:227], v[132:135]
  s_waitcnt vmcnt(6) lgkmcnt(9)
  ds_read_b128 a[36:39], v59 offset:5120
  v_add_f32 v109, v109, v137
  v_mfma_f32_16x16x32_bf16 v[116:119], a[4:7], v[228:231], v[116:119]
  s_waitcnt lgkmcnt(9)
  ds_read_b128 a[40:43], v59 offset:10240
  v_add_f32 v110, v110, v138
  v_mfma_f32_16x16x32_bf16 v[120:123], a[8:11], v[228:231], v[120:123]
  s_waitcnt lgkmcnt(8)
  ds_read_b128 a[44:47], v59 offset:15360
  v_add_f32 v111, v111, v139
  v_mfma_f32_16x16x32_bf16 v[124:127], a[12:15], v[228:231], v[124:127]
  s_waitcnt lgkmcnt(8)
  ds_read_b128 a[48:51], v62 offset:7168
  ds_read_b128 v[148:151], v11 offset:9216
  v_mfma_f32_16x16x32_bf16 v[128:131], a[16:19], v[228:231], v[128:131]
  s_waitcnt lgkmcnt(9)
  ds_read_b128 a[52:55], v62 offset:12288
  v_add_f32 v108, v108, v140
  v_mfma_f32_16x16x32_bf16 v[132:135], a[20:23], v[228:231], v[132:135]
  s_waitcnt vmcnt(5) lgkmcnt(9)
  ds_read_b128 a[56:59], v59 offset:1024
  v_add_f32 v109, v109, v141
  v_mfma_f32_16x16x32_bf16 v[116:119], a[24:27], v[232:235], v[116:119]
  s_waitcnt vmcnt(4) lgkmcnt(9)
  ds_read_b128 a[60:63], v59 offset:6144
  v_add_f32 v110, v110, v142
  v_mfma_f32_16x16x32_bf16 v[116:119], a[28:31], v[236:239], v[116:119]
  s_waitcnt vmcnt(3) lgkmcnt(8)
  ds_read_b128 a[0:3], v59 offset:11264
  v_add_f32 v111, v111, v143
  v_mfma_f32_16x16x32_bf16 v[116:119], a[32:35], v[240:243], v[116:119]
  s_waitcnt vmcnt(2) lgkmcnt(8)
  ds_read_b128 a[4:7], v59 offset:16384
  ds_read_b128 v[152:155], v11 offset:14336
  v_mfma_f32_16x16x32_bf16 v[116:119], a[36:39], v[244:247], v[116:119]
  s_waitcnt vmcnt(1) lgkmcnt(9)
  ds_read_b128 a[8:11], v62 offset:8192
  v_add_f32 v112, v112, v144
  v_mfma_f32_16x16x32_bf16 v[116:119], a[40:43], v[248:251], v[116:119]
  s_waitcnt vmcnt(0) lgkmcnt(9)
  ds_read_b128 a[12:15], v62 offset:13312
  v_add_f32 v113, v113, v145
  v_mfma_f32_16x16x32_bf16 v[116:119], a[44:47], v[252:255], v[116:119]
  s_waitcnt lgkmcnt(9)
  ds_read_b128 a[16:19], v59 offset:2048
  v_add_f32 v114, v114, v146
  v_mfma_f32_16x16x32_bf16 v[120:123], a[48:51], v[232:235], v[120:123]
  s_waitcnt lgkmcnt(8)
  ds_read_b128 a[20:23], v59 offset:7168
  v_add_f32 v115, v115, v147
  v_mfma_f32_16x16x32_bf16 v[120:123], a[52:55], v[236:239], v[120:123]
  s_waitcnt lgkmcnt(8)
  ds_read_b128 a[24:27], v59 offset:12288
  v_mfma_f32_16x16x32_bf16 v[120:123], a[56:59], v[240:243], v[120:123]
  s_waitcnt lgkmcnt(8)
  ds_read_b128 a[28:31], v59 offset:17408
  v_add_f32 v112, v112, v148
  v_fmac_f32 v116, v23, v96
  v_mfma_f32_16x16x32_bf16 v[120:123], a[60:63], v[244:247], v[120:123]
  s_waitcnt lgkmcnt(8)
  ds_read_b128 a[32:35], v62 offset:9216
  v_add_f32 v113, v113, v149
  v_fmac_f32 v117, v23, v97
  v_mfma_f32_16x16x32_bf16 v[120:123], a[0:3], v[248:251], v[120:123]
  s_waitcnt lgkmcnt(8)
  ds_read_b128 a[36:39], v62 offset:14336
  v_add_f32 v114, v114, v150
  v_fmac_f32 v118, v23, v98
  v_mfma_f32_16x16x32_bf16 v[120:123], a[4:7], v[252:255], v[120:123]
  s_waitcnt lgkmcnt(7)
  ds_read_b128 a[40:43], v59 offset:3072
  v_add_f32 v115, v115, v151
  v_fmac_f32 v119, v23, v99
  v_mfma_f32_16x16x32_bf16 v[124:127], a[8:11], v[232:235], v[124:127]
  s_waitcnt lgkmcnt(7)
  ds_read_b128 a[44:47], v59 offset:8192
  v_cvt_pk_bf16_f32 v40, v116, v117
  v_mfma_f32_16x16x32_bf16 v[124:127], a[12:15], v[236:239], v[124:127]
  s_waitcnt lgkmcnt(7)
  ds_read_b128 a[48:51], v59 offset:13312
  v_add_f32 v112, v112, v152
  v_cvt_pk_bf16_f32 v41, v118, v119
  v_mfma_f32_16x16x32_bf16 v[124:127], a[16:19], v[240:243], v[124:127]
  s_waitcnt lgkmcnt(7)
  ds_read_b128 a[52:55], v59 offset:18432
  v_add_f32 v113, v113, v153
  v_fmac_f32 v120, v23, v100
  v_fmac_f32 v121, v23, v101
  v_mfma_f32_16x16x32_bf16 v[124:127], a[20:23], v[244:247], v[124:127]
  s_waitcnt lgkmcnt(7)
  ds_read_b128 a[56:59], v62 offset:10240
  v_add_f32 v114, v114, v154
  v_fmac_f32 v122, v23, v102
  v_mfma_f32_16x16x32_bf16 v[124:127], a[24:27], v[248:251], v[124:127]
  s_waitcnt lgkmcnt(7)
  ds_read_b128 a[60:63], v62 offset:15360
  v_add_f32 v115, v115, v155
  v_fmac_f32 v123, v23, v103
  v_mfma_f32_16x16x32_bf16 v[124:127], a[28:31], v[252:255], v[124:127]
  s_waitcnt lgkmcnt(7)
  ds_read_b128 a[0:3], v59 offset:4096
  v_cvt_pk_bf16_f32 v42, v120, v121
  v_mfma_f32_16x16x32_bf16 v[128:131], a[32:35], v[232:235], v[128:131]
  s_waitcnt lgkmcnt(7)
  ds_read_b128 a[4:7], v59 offset:9216
  v_cvt_pk_bf16_f32 v43, v122, v123
  v_mfma_f32_16x16x32_bf16 v[128:131], a[36:39], v[236:239], v[128:131]
  s_waitcnt lgkmcnt(7)
  ds_read_b128 a[8:11], v59 offset:14336
  buffer_store_dwordx4 v[40:43], v9, s[52:55], 0 offen offset:0 nt
  v_mfma_f32_16x16x32_bf16 v[128:131], a[40:43], v[240:243], v[128:131]
  s_waitcnt lgkmcnt(7)
  ds_read_b128 a[12:15], v59 offset:19456
  v_fmac_f32 v124, v23, v104
  v_mfma_f32_16x16x32_bf16 v[128:131], a[44:47], v[244:247], v[128:131]
  s_waitcnt lgkmcnt(7)
  v_fmac_f32 v125, v23, v105
  v_mfma_f32_16x16x32_bf16 v[128:131], a[48:51], v[248:251], v[128:131]
  s_waitcnt lgkmcnt(6)
  v_fmac_f32 v126, v23, v106
  v_mfma_f32_16x16x32_bf16 v[128:131], a[52:55], v[252:255], v[128:131]
  s_waitcnt lgkmcnt(5)
  v_fmac_f32 v127, v23, v107
  v_mfma_f32_16x16x32_bf16 v[132:135], a[56:59], v[232:235], v[132:135]
  s_waitcnt lgkmcnt(4)
  v_cvt_pk_bf16_f32 v44, v124, v125
  v_mfma_f32_16x16x32_bf16 v[132:135], a[60:63], v[236:239], v[132:135]
  s_waitcnt lgkmcnt(3)
  v_cvt_pk_bf16_f32 v45, v126, v127
  v_mfma_f32_16x16x32_bf16 v[132:135], a[0:3], v[240:243], v[132:135]
  s_waitcnt lgkmcnt(2)
  v_fmac_f32 v128, v23, v108
  v_fmac_f32 v129, v23, v109
  v_mfma_f32_16x16x32_bf16 v[132:135], a[4:7], v[244:247], v[132:135]
  s_waitcnt lgkmcnt(1)
  v_fmac_f32 v130, v23, v110
  v_fmac_f32 v131, v23, v111
  v_mfma_f32_16x16x32_bf16 v[132:135], a[8:11], v[248:251], v[132:135]
  s_waitcnt lgkmcnt(0)
  v_cvt_pk_bf16_f32 v46, v128, v129
  v_cvt_pk_bf16_f32 v47, v130, v131
  v_mfma_f32_16x16x32_bf16 v[132:135], a[12:15], v[252:255], v[132:135]
  buffer_store_dwordx4 v[44:47], v9, s[52:55], 0 offen offset:64 nt
  s_nop 6
  v_fmac_f32 v132, v23, v112
  v_fmac_f32 v133, v23, v113
  v_fmac_f32 v134, v23, v114
  v_fmac_f32 v135, v23, v115
  v_cvt_pk_bf16_f32 v48, v132, v133
  v_cvt_pk_bf16_f32 v49, v134, v135
  buffer_store_dwordx2 v[48:49], v10, s[52:55], 0 offen offset:0 nt
L_END:
  s_endpgm
L_GATE:
  v_and_b32 v2, 31, v1
  v_lshrrev_b32 v3, 5, v1
  s_mul_i32 s9, s3, 3072
  s_bfe_u32 s12, s2, 0x40003
  s_lshr_b32 s7, s2, 7
  s_and_b32 s6, s2, 7
  s_lshl1_add_u32 s13, s6, s7
  s_mov_b32 s48, s34
  s_mov_b32 s49, s35
  s_mov_b32 s50, 24117248
  s_mov_b32 s51, 0x20000
  s_mov_b32 s60, s32
  s_mov_b32 s61, s33
  s_mov_b32 s62, 256
  s_mov_b32 s63, 0x20000
  v_lshlrev_b32 v29, 25, v1
  v_mov_b32 v30, 1
  v_mov_b32 v48, 0
  v_mov_b32 v49, 0
  v_mov_b32 v50, 0
  v_mov_b32 v51, 0
  v_and_b32 v60, 15, v1
  v_lshlrev_b32 v60, 10, v60
  v_lshrrev_b32 v61, 4, v1
  v_min_u32 v61, 2, v61
  v_lshl_add_u32 v60, v61, 18, v60
  v_lshlrev_b32 v61, 4, v2
  s_lshl_b32 s6, s4, 14
  s_add_u32 s6, s6, 22020096
  s_lshr_b32 s7, s4, 1
  s_lshl_b32 s7, s7, 13
  s_and_b32 s74, s4, 1
  s_lshl_b32 s74, s74, 9
  s_add_u32 s7, s7, s74
  s_add_u32 s7, s7, 22806528
  s_cmp_eq_u32 s3, 0
  s_cselect_b64 vcc, -1, 0
  s_cselect_b32 s6, s6, s7
  s_cmp_lt_u32 s3, 2
  s_cselect_b32 s7, 0, 2146435072
  v_cndmask_b32 v60, v61, v60, vcc
  v_or_b32 v52, s7, v29
  v_or_b32 v60, s7, v60
  buffer_store_dwordx4 v[48:51], v60, s[48:51], s6 offen sc1
  s_mov_b32 s40, s28
  s_mov_b32 s41, s29
  s_mov_b32 s42, 1280
  s_mov_b32 s43, 0x20000
  v_lshlrev_b32 v60, 4, v0
  buffer_load_dwordx4 v[64:67], v60, s[40:43], 0 offen
  s_lshr_b32 s6, s3, 1
  s_lshl_b32 s6, s6, 5
  s_add_u32 s75, s14, s6
  s_mov_b32 s7, 819200
  s_mov_b32 s59, 0x20000
  s_cmp_lt_u32 s75, 48
  s_cselect_b32 s58, 1966080, s7
  s_cselect_b32 s56, s26, s20
  s_cselect_b32 s57, s27, s21
  s_cmp_lt_u32 s75, 48
  s_cselect_b32 s6, 0, 48
  s_sub_u32 s6, s75, s6
  s_and_b32 s74, s3, 1
  s_lshl1_add_u32 s6, s6, s74
  s_mul_i32 s6, s6, 20480
  s_mul_i32 s7, s15, 160
  s_add_u32 s6, s6, s7
  v_add_u32 v60, 0, v1
  v_mul_u32_u24 v60, 6554, v60
  v_lshrrev_b32 v60, 16, v60
  v_mul_u32_u24 v60, 1120, v60
  v_lshl_add_u32 v60, v1, 4, v60
  v_add_u32 v240, s6, v60
  v_add_u32 v60, 64, v1
  v_mul_u32_u24 v60, 6554, v60
  v_lshrrev_b32 v60, 16, v60
  v_mul_u32_u24 v60, 1120, v60
  v_lshl_add_u32 v60, v1, 4, v60
  v_add_u32 v241, s6, v60
  v_add_u32 v60, 128, v1
  v_mul_u32_u24 v60, 6554, v60
  v_lshrrev_b32 v60, 16, v60
  v_mul_u32_u24 v60, 1120, v60
  v_lshl_add_u32 v60, v1, 4, v60
  v_add_u32 v242, s6, v60
  v_lshl_add_u32 v242, v3, 30, v242
  s_add_u32 s6, s9, 143360
  v_bfe_u32 v60, v1, 4, 1
  v_bfe_u32 v61, v1, 2, 2
  v_lshl_add_u32 v60, v60, 3, v61
  v_mul_u32_u24 v60, 160, v60
  v_add_u32 v60, s6, v60
  v_and_b32 v61, 3, v1
  v_lshl_add_u32 v244, v61, 3, v60
  v_lshl_add_u32 v60, v3, 3, v60
  v_lshl_add_u32 v243, v61, 4, v60
  s_and_b32 s6, s15, 1
  s_lshl_b32 s7, s6, 5
  v_add_u32 v243, s7, v243
  s_xor_b32 s6, s6, 1
  s_lshl_b32 s7, s6, 7
  v_add_u32 v244, s7, v244
  s_mul_i32 s6, s15, 348160
  s_mul_i32 s7, s75, 5120
  s_add_u32 s6, s6, s7
  s_lshl_b32 s7, s74, 9
  s_add_u32 s6, s6, s7
  s_add_u32 s6, s6, 17825792
  v_lshl_add_u32 v60, v2, 4, s6
  v_lshl_add_u32 v245, v3, 10, v60
  v_lshl_add_u32 v60, v3, 30, v60
  v_add_u32 v246, 4096, v60
  s_lshl1_add_u32 s7, s75, s74
  s_lshl_b32 s6, s15, 13
  s_lshl2_add_u32 s6, s7, s6
  s_add_u32 s6, s6, 22806528
  v_lshl_add_u32 v247, v1, 25, s6
  s_add_u32 m0, s9, 143360
  s_nop 0
  buffer_load_dwordx4 v240, s[56:59], 0 offen offset:0 lds
  buffer_load_dwordx4 v241, s[56:59], 0 offen offset:1024 lds
  buffer_load_dwordx4 v242, s[56:59], 0 offen offset:2048 lds
  s_and_b32 s6, s4, 1
  s_lshr_b32 s7, s3, 1
  s_lshl1_add_u32 s75, s6, s7
  s_add_u32 s75, s75, 64
  s_lshr_b32 s1, s4, 1
  s_cmp_lt_u32 s75, 48
  s_cselect_b32 s6, 0, 48
  s_sub_u32 s6, s75, s6
  s_and_b32 s74, s3, 1
  s_lshl1_add_u32 s6, s6, s74
  s_mul_i32 s6, s6, 20480
  s_mul_i32 s7, s1, 160
  s_add_u32 s6, s6, s7
  v_add_u32 v60, 0, v1
  v_mul_u32_u24 v60, 6554, v60
  v_lshrrev_b32 v60, 16, v60
  v_mul_u32_u24 v60, 1120, v60
  v_lshl_add_u32 v60, v1, 4, v60
  v_add_u32 v128, s6, v60
  v_add_u32 v60, 64, v1
  v_mul_u32_u24 v60, 6554, v60
  v_lshrrev_b32 v60, 16, v60
  v_mul_u32_u24 v60, 1120, v60
  v_lshl_add_u32 v60, v1, 4, v60
  v_add_u32 v129, s6, v60
  v_add_u32 v60, 128, v1
  v_mul_u32_u24 v60, 6554, v60
  v_lshrrev_b32 v60, 16, v60
  v_mul_u32_u24 v60, 1120, v60
  v_lshl_add_u32 v60, v1, 4, v60
  v_add_u32 v130, s6, v60
  v_lshl_add_u32 v130, v3, 30, v130
  s_add_u32 s6, s9, 0
  v_bfe_u32 v60, v1, 4, 1
  v_bfe_u32 v61, v1, 2, 2
  v_lshl_add_u32 v60, v60, 3, v61
  v_mul_u32_u24 v60, 160, v60
  v_add_u32 v60, s6, v60
  v_and_b32 v61, 3, v1
  v_lshl_add_u32 v132, v61, 3, v60
  v_lshl_add_u32 v60, v3, 3, v60
  v_lshl_add_u32 v131, v61, 4, v60
  s_and_b32 s6, s1, 1
  s_lshl_b32 s7, s6, 5
  v_add_u32 v131, s7, v131
  s_xor_b32 s6, s6, 1
  s_lshl_b32 s7, s6, 7
  v_add_u32 v132, s7, v132
  s_mul_i32 s6, s1, 348160
  s_mul_i32 s7, s75, 5120
  s_add_u32 s6, s6, s7
  s_lshl_b32 s7, s74, 9
  s_add_u32 s6, s6, s7
  s_add_u32 s6, s6, 17825792
  v_lshl_add_u32 v60, v2, 4, s6
  v_lshl_add_u32 v133, v3, 10, v60
  v_lshl_add_u32 v60, v3, 30, v60
  v_add_u32 v134, 4096, v60
  s_lshl1_add_u32 s7, s75, s74
  s_lshl_b32 s6, s1, 13
  s_lshl2_add_u32 s6, s7, s6
  s_add_u32 s6, s6, 22806528
  v_lshl_add_u32 v135, v1, 25, s6
  s_mov_b32 s40, s20
  s_mov_b32 s41, s21
  s_mov_b32 s42, 819200
  s_mov_b32 s43, 0x20000
  s_add_u32 m0, s9, 0
  s_nop 0
  buffer_load_dwordx4 v128, s[40:43], 0 offen offset:0 lds
  buffer_load_dwordx4 v129, s[40:43], 0 offen offset:1024 lds
  buffer_load_dwordx4 v130, s[40:43], 0 offen offset:2048 lds
  s_lshr_b32 s6, 1198064421, s73
  s_and_b32 s65, s6, 15
  s_lshr_b32 s6, 1409618017, s73
  s_and_b32 s66, s6, 15
  s_lshr_b32 s6, 1635133234, s73
  s_and_b32 s67, s6, 15
  s_lshr_b32 s6, 2235711752, s73
  s_and_b32 s68, s6, 15
  s_lshr_b32 s6, 2568443251, s73
  s_and_b32 s69, s6, 15
  s_lshr_b32 s6, 36726934, s73
  s_and_b32 s70, s6, 15
  s_lshr_b32 s6, 679576647, s73
  s_and_b32 s71, s6, 15
  s_lshr_b32 s6, 278427220, s73
  s_and_b32 s72, s6, 15
  s_lshr_b32 s6, 857971081, s73
  s_and_b32 s73, s6, 15
  s_mov_b32 s44, s24
  s_mov_b32 s45, s25
  s_mov_b32 s46, 1966080
  s_mov_b32 s47, 0x20000
  s_mov_b32 s52, s30
  s_mov_b32 s53, s31
  s_mov_b32 s54, 2621440
  s_mov_b32 s55, 0x20000
  v_lshlrev_b32 v59, 4, v1
  s_mul_i32 s6, s15, 348160
  s_add_u32 s6, s6, 17825792
  v_add_u32 v31, s6, v59
  v_add_u32 v32, 4096, v31
  v_and_b32 v61, 15, v1
  v_lshrrev_b32 v60, 1, v61
  v_lshrrev_b32 v62, 4, v1
  v_xor_b32 v60, v60, v62
  v_lshlrev_b32 v60, 4, v60
  v_lshl_add_u32 v60, v61, 7, v60
  s_add_u32 s6, s8, 65536
  v_add_u32 v24, s6, v60
  v_xor_b32 v25, 64, v24
  v_bfe_u32 v60, v1, 2, 2
  v_lshrrev_b32 v61, 4, v1
  v_lshl_add_u32 v61, v61, 3, v60
  v_and_b32 v62, 3, v1
  v_lshlrev_b32 v62, 3, v62
  v_bfe_u32 v60, v1, 2, 3
  v_lshl_add_u32 v63, v61, 8, v62
  v_lshl_add_u32 v16, v60, 5, v63
  s_and_b32 s6, s3, 1
  s_lshl_b32 s6, s6, 7
  v_xor_b32 v16, s6, v16
  v_xor_b32 v20, 0x1000, v24
  v_xor_b32 v21, 0x1000, v25
  v_xor_b32 v17, 32, v16
  v_xor_b32 v18, 64, v16
  v_xor_b32 v19, 96, v16
  v_mul_u32_u24 v63, 192, v61
  v_add_u32 v63, v63, v62
  v_bfe_u32 v60, v1, 4, 1
  v_lshl_add_u32 v40, v60, 5, v63
  v_xor_b32 v41, 32, v40
  v_add_u32 v42, 65536, v40
  v_add_u32 v43, 65536, v41
  v_add_u32 v44, 131072, v40
  v_add_u32 v45, 131072, v41
  s_add_u32 m0, s8, 81920
  s_mul_i32 s10, s65, 128
  buffer_load_dwordx4 v4, s[36:39], s10 offen offset:0 lds
  buffer_load_dwordx4 v5, s[36:39], s10 offen offset:1024 lds
  buffer_load_dwordx4 v6, s[36:39], s10 offen offset:2048 lds
  buffer_load_dwordx4 v7, s[36:39], s10 offen offset:3072 lds
  s_waitcnt vmcnt(11)
  buffer_atomic_add v30, v52, s[60:63], 0 offen sc1
  s_waitcnt vmcnt(11)
  v_and_b32 v220, 0xffff, v64
  v_and_b32 v221, 0xffff0000, v64
  v_and_b32 v222, 0xffff, v65
  v_and_b32 v223, 0xffff0000, v65
  v_and_b32 v224, 0xffff, v66
  v_and_b32 v225, 0xffff0000, v66
  v_and_b32 v226, 0xffff, v67
  v_and_b32 v227, 0xffff0000, v67
  v_lshlrev_b32 v60, 5, v0
  v_add_u32 v60, 16384, v60
  ds_write_b128 v60, v[220:223]
  ds_write_b128 v60, v[224:227] offset:16
  v_lshrrev_b32 v46, 4, v1
  v_lshlrev_b32 v46, 5, v46
  v_add_u32 v46, 16384, v46
  v_mov_b32 v48, 0x3f803f80
  v_mov_b32 v49, 0x3f803f80
  v_mov_b32 v50, 0x3f803f80
  v_mov_b32 v51, 0x3f803f80
  s_add_u32 m0, s8, 98304
  s_mul_i32 s10, s66, 128
  buffer_load_dwordx4 v4, s[36:39], s10 offen offset:0 lds
  buffer_load_dwordx4 v5, s[36:39], s10 offen offset:1024 lds
  buffer_load_dwordx4 v6, s[36:39], s10 offen offset:2048 lds
  buffer_load_dwordx4 v7, s[36:39], s10 offen offset:3072 lds
  s_add_u32 m0, s8, 114688
  s_mul_i32 s10, s67, 128
  buffer_load_dwordx4 v4, s[36:39], s10 offen offset:0 lds
  buffer_load_dwordx4 v5, s[36:39], s10 offen offset:1024 lds
  buffer_load_dwordx4 v6, s[36:39], s10 offen offset:2048 lds
  buffer_load_dwordx4 v7, s[36:39], s10 offen offset:3072 lds
  s_mul_i32 s6, s3, 49152
  s_mul_i32 s7, s5, 192
  s_add_u32 s6, s6, s7
  s_sub_u32 s6, s6, 0
  v_add_u32 v60, 0, v1
  v_mul_u32_u24 v61, 43691, v60
  v_lshrrev_b32 v61, 19, v61
  v_lshrrev_b32 v62, 2, v61
  v_and_b32 v62, 2, v62
  v_xor_b32 v60, v60, v62
  v_mul_u32_u24 v61, 2880, v61
  v_lshl_add_u32 v60, v60, 4, v61
  v_add_u32 v12, s6, v60
  s_mul_i32 s6, s3, 49152
  s_mul_i32 s7, s5, 192
  s_add_u32 s6, s6, s7
  s_sub_u32 s6, s6, 1024
  v_add_u32 v60, 64, v1
  v_mul_u32_u24 v61, 43691, v60
  v_lshrrev_b32 v61, 19, v61
  v_lshrrev_b32 v62, 2, v61
  v_and_b32 v62, 2, v62
  v_xor_b32 v60, v60, v62
  v_mul_u32_u24 v61, 2880, v61
  v_lshl_add_u32 v60, v60, 4, v61
  v_add_u32 v13, s6, v60
  s_mul_i32 s6, s3, 49152
  s_mul_i32 s7, s5, 192
  s_add_u32 s6, s6, s7
  s_sub_u32 s6, s6, 2048
  v_add_u32 v60, 128, v1
  v_mul_u32_u24 v61, 43691, v60
  v_lshrrev_b32 v61, 19, v61
  v_lshrrev_b32 v62, 2, v61
  v_and_b32 v62, 2, v62
  v_xor_b32 v60, v60, v62
  v_mul_u32_u24 v61, 2880, v61
  v_lshl_add_u32 v60, v60, 4, v61
  v_add_u32 v14, s6, v60
  s_waitcnt vmcnt(13)
  ds_read_b64_tr_b16 v[208:209], v243 offset:0
  ds_read_b64_tr_b16 v[210:211], v243 offset:640
  ds_read_b64_tr_b16 v[212:213], v243 offset:64
  ds_read_b64_tr_b16 v[214:215], v243 offset:704
  ds_read_b64_tr_b16 v[216:217], v244 offset:0
  ds_read_b64_tr_b16 v[218:219], v244 offset:640
  ds_read_b64_tr_b16 v[136:137], v131 offset:0
  ds_read_b64_tr_b16 v[138:139], v131 offset:640
  ds_read_b64_tr_b16 v[140:141], v131 offset:64
  ds_read_b64_tr_b16 v[142:143], v131 offset:704
  ds_read_b64_tr_b16 v[144:145], v132 offset:0
  ds_read_b64_tr_b16 v[146:147], v132 offset:640
  s_waitcnt lgkmcnt(0)
  s_barrier
  s_lshl_b32 s6, s64, 8
  v_add_u32 v47, s6, v46
  ds_read_b128 v[72:75], v24 offset:0
  ds_read_b128 v[80:83], v47 offset:0
  ds_read_b128 v[84:87], v47 offset:16
  ds_read_b128 v[76:79], v24 offset:2048
  ds_read_b128 a[0:3], v24 offset:0
  ds_read_b128 a[4:7], v24 offset:2048
  ds_read_b128 v[88:91], v25 offset:0
  ds_read_b128 v[96:99], v47 offset:128
  ds_read_b128 v[100:103], v47 offset:144
  ds_read_b128 v[92:95], v25 offset:2048
  ds_read_b128 a[8:11], v25 offset:0
  ds_read_b128 a[12:15], v25 offset:2048
  s_waitcnt lgkmcnt(0)
  s_lshl_b32 s6, s65, 8
  v_add_u32 v47, s6, v46
  s_waitcnt vmcnt(9)
  ds_read_b128 v[176:179], v24 offset:16384
  ds_read_b128 v[184:187], v47 offset:0
  ds_read_b128 v[188:191], v47 offset:16
  ds_read_b128 v[180:183], v24 offset:18432
  ds_read_b128 a[16:19], v24 offset:16384
  ds_read_b128 a[20:23], v24 offset:18432
  ds_read_b128 v[192:195], v25 offset:16384
  ds_read_b128 v[200:203], v47 offset:128
  ds_read_b128 v[204:207], v47 offset:144
  ds_read_b128 v[196:199], v25 offset:18432
  ds_read_b128 a[24:27], v25 offset:16384
  ds_read_b128 a[28:31], v25 offset:18432
  v_dot2_f32_bf16 v220, v72, v80, 0
  v_dot2_f32_bf16 v221, v72, v81, 0
  v_dot2_f32_bf16 v222, v73, v82, 0
  v_dot2_f32_bf16 v223, v73, v83, 0
  v_dot2_f32_bf16 v224, v74, v84, 0
  v_dot2_f32_bf16 v225, v74, v85, 0
  v_dot2_f32_bf16 v226, v75, v86, 0
  v_dot2_f32_bf16 v227, v75, v87, 0
  s_add_u32 m0, s8, 65536
  s_mul_i32 s10, s68, 128
  buffer_load_dwordx4 v4, s[36:39], s10 offen offset:0 lds
  buffer_load_dwordx4 v5, s[36:39], s10 offen offset:1024 lds
  v_dot2_f32_bf16 v228, v76, v80, 0
  v_dot2_f32_bf16 v229, v76, v81, 0
  v_dot2_f32_bf16 v230, v77, v82, 0
  v_dot2_f32_bf16 v231, v77, v83, 0
  v_dot2_f32_bf16 v232, v78, v84, 0
  v_dot2_f32_bf16 v233, v78, v85, 0
  v_dot2_f32_bf16 v234, v79, v86, 0
  v_dot2_f32_bf16 v235, v79, v87, 0
  buffer_load_dwordx4 v6, s[36:39], s10 offen offset:2048 lds
  v_cvt_pk_bf16_f32 v104, v220, v221
  v_cvt_pk_bf16_f32 v105, v222, v223
  v_cvt_pk_bf16_f32 v106, v224, v225
  v_cvt_pk_bf16_f32 v107, v226, v227
  buffer_load_dwordx4 v7, s[36:39], s10 offen offset:3072 lds
  v_cvt_pk_bf16_f32 v108, v228, v229
  v_cvt_pk_bf16_f32 v109, v230, v231
  v_cvt_pk_bf16_f32 v110, v232, v233
  v_cvt_pk_bf16_f32 v111, v234, v235
  buffer_store_dwordx4 v[208:211], v245, s[48:51], 0 offen offset:0 sc1
  v_dot2_f32_bf16 v220, v88, v96, 0
  v_dot2_f32_bf16 v221, v88, v97, 0
  v_dot2_f32_bf16 v222, v89, v98, 0
  v_dot2_f32_bf16 v223, v89, v99, 0
  v_dot2_f32_bf16 v224, v90, v100, 0
  v_dot2_f32_bf16 v225, v90, v101, 0
  v_dot2_f32_bf16 v226, v91, v102, 0
  v_dot2_f32_bf16 v227, v91, v103, 0
  buffer_store_dwordx4 v[212:215], v245, s[48:51], 0 offen offset:2048 sc1
  buffer_store_dwordx4 v[216:219], v246, s[48:51], 0 offen offset:0 sc1
  v_dot2_f32_bf16 v228, v92, v96, 0
  v_dot2_f32_bf16 v229, v92, v97, 0
  v_dot2_f32_bf16 v230, v93, v98, 0
  v_dot2_f32_bf16 v231, v93, v99, 0
  v_dot2_f32_bf16 v232, v94, v100, 0
  v_dot2_f32_bf16 v233, v94, v101, 0
  v_dot2_f32_bf16 v234, v95, v102, 0
  v_dot2_f32_bf16 v235, v95, v103, 0
  buffer_store_dwordx4 v[136:139], v133, s[48:51], 0 offen offset:0 sc1
  v_cvt_pk_bf16_f32 v112, v220, v221
  v_cvt_pk_bf16_f32 v113, v222, v223
  v_cvt_pk_bf16_f32 v114, v224, v225
  v_cvt_pk_bf16_f32 v115, v226, v227
  buffer_store_dwordx4 v[140:143], v133, s[48:51], 0 offen offset:2048 sc1
  v_cvt_pk_bf16_f32 v116, v228, v229
  v_cvt_pk_bf16_f32 v117, v230, v231
  v_cvt_pk_bf16_f32 v118, v232, v233
  v_cvt_pk_bf16_f32 v119, v234, v235
  buffer_store_dwordx4 v[144:147], v134, s[48:51], 0 offen offset:0 sc1
  v_lshlrev_b32 v60, 4, v2
  v_lshl_add_u32 v38, v3, 10, v60
  v_lshl_add_u32 v39, v3, 30, v60
  s_lshr_b32 s7, s3, 1
  s_lshl1_add_u32 s6, s4, s7
  s_mul_i32 s6, s6, 245760
  s_lshl_b32 s7, s5, 14
  s_add_u32 s6, s6, s7
  s_and_b32 s7, s3, 1
  s_mul_i32 s7, s7, 8704
  s_add_u32 s6, s6, s7
  s_cmp_eq_u32 s5, 15
  s_cselect_b32 s6, 2146435072, s6
  v_bfe_u32 v60, v1, 4, 1
  v_lshl_add_u32 v60, v60, 1, v3
  v_and_b32 v61, 15, v1
  v_lshlrev_b32 v61, 4, v61
  v_lshl_add_u32 v62, v60, 10, v61
  v_add_u32 v27, s6, v62
  v_lshl_add_u32 v28, v60, 8, v61
  v_xor_b32 v26, 0x200, v27
  v_lshrrev_b32 v60, 4, v2
  v_mul_u32_u24 v60, 71680, v60
  v_and_b32 v61, 15, v2
  v_lshl_add_u32 v60, v61, 4, v60
  v_lshl_add_u32 v61, v3, 8, v60
  v_lshl_add_u32 v60, v3, 30, v60
  s_lshl_b32 s7, s3, 1
  s_lshl3_add_u32 s6, s4, s7
  s_mul_i32 s6, s6, 71680
  s_mul_i32 s74, s5, 3072
  s_add_u32 s6, s6, s74
  s_add_u32 s6, s6, 8388608
  v_add_u32 v28, s6, v28
  s_lshl3_add_u32 s6, s12, s7
  s_mul_i32 s6, s6, 71680
  s_mul_i32 s7, s13, 1280
  s_add_u32 s6, s6, s7
  s_add_u32 s6, s6, 8437760
  v_add_u32 v54, s6, v61
  v_add_u32 v55, s6, v60
  s_movk_i32 s30, 4096
  s_movk_i32 s31, 8192
  s_movk_i32 s32, 12288
  s_cmp_lt_u32 s5, 5
  s_cselect_b32 s28, 0x3ea52b5c, 1.0
  s_mov_b32 s29, 71680
  v_mfma_f32_16x16x32_bf16 v[64:67], v[48:51], v[104:107], 0
  v_mfma_f32_16x16x32_bf16 v[68:71], v[48:51], v[108:111], 0
  v_mfma_f32_16x16x32_bf16 v[64:67], v[48:51], v[112:115], v[64:67]
  v_mfma_f32_16x16x32_bf16 v[68:71], v[48:51], v[116:119], v[68:71]
  s_waitcnt lgkmcnt(0)
  s_lshl_b32 s6, s66, 8
  v_add_u32 v47, s6, v46
  s_waitcnt vmcnt(14)
  ds_read_b128 v[72:75], v24 offset:32768
  ds_read_b128 v[80:83], v47 offset:0
  ds_read_b128 v[84:87], v47 offset:16
  ds_read_b128 v[76:79], v24 offset:34816
  ds_read_b128 a[32:35], v24 offset:32768
  ds_read_b128 a[36:39], v24 offset:34816
  ds_read_b128 v[88:91], v25 offset:32768
  ds_read_b128 v[96:99], v47 offset:128
  ds_read_b128 v[100:103], v47 offset:144
  ds_read_b128 v[92:95], v25 offset:34816
  ds_read_b128 a[40:43], v25 offset:32768
  ds_read_b128 a[44:47], v25 offset:34816
  v_dot2_f32_bf16 v220, v176, v184, 0
  v_dot2_f32_bf16 v221, v176, v185, 0
  v_dot2_f32_bf16 v222, v177, v186, 0
  v_dot2_f32_bf16 v223, v177, v187, 0
  v_dot2_f32_bf16 v224, v178, v188, 0
  v_dot2_f32_bf16 v225, v178, v189, 0
  v_dot2_f32_bf16 v226, v179, v190, 0
  v_dot2_f32_bf16 v227, v179, v191, 0
  s_add_u32 m0, s8, 81920
  s_mul_i32 s10, s69, 128
  buffer_load_dwordx4 v4, s[36:39], s10 offen offset:0 lds
  v_dot2_f32_bf16 v228, v180, v184, 0
  v_dot2_f32_bf16 v229, v180, v185, 0
  v_dot2_f32_bf16 v230, v181, v186, 0
  v_dot2_f32_bf16 v231, v181, v187, 0
  v_dot2_f32_bf16 v232, v182, v188, 0
  v_dot2_f32_bf16 v233, v182, v189, 0
  v_dot2_f32_bf16 v234, v183, v190, 0
  v_dot2_f32_bf16 v235, v183, v191, 0
  v_cvt_pk_bf16_f32 v104, v220, v221
  v_cvt_pk_bf16_f32 v105, v222, v223
  v_cvt_pk_bf16_f32 v106, v224, v225
  v_cvt_pk_bf16_f32 v107, v226, v227
  buffer_load_dwordx4 v5, s[36:39], s10 offen offset:1024 lds
  v_cvt_pk_bf16_f32 v108, v228, v229
  v_cvt_pk_bf16_f32 v109, v230, v231
  v_cvt_pk_bf16_f32 v110, v232, v233
  v_cvt_pk_bf16_f32 v111, v234, v235
  v_dot2_f32_bf16 v220, v192, v200, 0
  v_dot2_f32_bf16 v221, v192, v201, 0
  v_dot2_f32_bf16 v222, v193, v202, 0
  v_dot2_f32_bf16 v223, v193, v203, 0
  v_dot2_f32_bf16 v224, v194, v204, 0
  v_dot2_f32_bf16 v225, v194, v205, 0
  v_dot2_f32_bf16 v226, v195, v206, 0
  v_dot2_f32_bf16 v227, v195, v207, 0
  buffer_load_dwordx4 v6, s[36:39], s10 offen offset:2048 lds
  v_dot2_f32_bf16 v228, v196, v200, 0
  v_dot2_f32_bf16 v229, v196, v201, 0
  v_dot2_f32_bf16 v230, v197, v202, 0
  v_dot2_f32_bf16 v231, v197, v203, 0
  v_dot2_f32_bf16 v232, v198, v204, 0
  v_dot2_f32_bf16 v233, v198, v205, 0
  v_dot2_f32_bf16 v234, v199, v206, 0
  v_dot2_f32_bf16 v235, v199, v207, 0
  v_cvt_pk_bf16_f32 v112, v220, v221
  v_cvt_pk_bf16_f32 v113, v222, v223
  v_cvt_pk_bf16_f32 v114, v224, v225
  v_cvt_pk_bf16_f32 v115, v226, v227
  buffer_load_dwordx4 v7, s[36:39], s10 offen offset:3072 lds
  v_cvt_pk_bf16_f32 v116, v228, v229
  v_cvt_pk_bf16_f32 v117, v230, v231
  v_cvt_pk_bf16_f32 v118, v232, v233
  v_cvt_pk_bf16_f32 v119, v234, v235
  s_and_b32 s6, s14, 0
  s_mul_i32 s7, s3, 12
  s_cmp_eq_u32 s6, 0
  s_cselect_b32 s16, 0, 6
  s_cselect_b32 s17, 1, 7
  s_cselect_b32 s18, 2, 8
  s_cselect_b32 s19, 3, 9
  s_cselect_b32 s20, 4, 10
  s_cselect_b32 s21, 5, 11
  s_cselect_b32 s22, 6, 0
  s_cselect_b32 s23, 7, 1
  s_cselect_b32 s24, 8, 2
  s_cselect_b32 s25, 9, 3
  s_cselect_b32 s26, 10, 4
  s_cselect_b32 s27, 11, 5
  s_add_u32 s16, s16, s7
  s_add_u32 s17, s17, s7
  s_add_u32 s18, s18, s7
  s_add_u32 s19, s19, s7
  s_add_u32 s20, s20, s7
  s_add_u32 s21, s21, s7
  s_add_u32 s22, s22, s7
  s_add_u32 s23, s23, s7
  s_add_u32 s24, s24, s7
  s_add_u32 s25, s25, s7
  s_add_u32 s26, s26, s7
  s_add_u32 s27, s27, s7
  s_lshl4_add_u32 s6, s4, s5
  s_lshl_b32 s6, s6, 10
  s_add_u32 s35, s6, 22020096
  s_lshl4_add_u32 s6, s12, s13
  s_lshl_b32 s6, s6, 10
  s_add_u32 s75, s6, 22544384
  s_and_b32 s6, s3, 1
  s_lshr_b32 s7, s3, 1
  s_mul_i32 s33, s7, 31232
  s_lshl_b32 s74, s6, 10
  s_add_u32 s33, s33, s74
  s_lshl1_add_u32 s6, s12, s6
  s_sub_u32 s6, s6, 4
  s_mul_i32 s7, s7, 80
  s_mul_i32 s74, s13, 5
  s_add_u32 s7, s7, s74
  s_add_u32 s7, s7, 80
  s_lshl_b32 s7, s7, 10
  s_mul_i32 s74, s6, 245760
  s_add_u32 s74, s74, s7
  s_cmp_lt_i32 s6, 0
  s_cselect_b32 s74, 2146435072, s74
  v_add_u32 v35, s74, v59
  s_add_u32 s6, s6, 2
  s_mul_i32 s74, s6, 245760
  s_add_u32 s74, s74, s7
  s_cmp_lt_i32 s6, 0
  s_cselect_b32 s74, 2146435072, s74
  v_add_u32 v36, s74, v59
  s_add_u32 s6, s6, 2
  s_mul_i32 s74, s6, 245760
  s_add_u32 s74, s74, s7
  s_cmp_lt_i32 s6, 0
  s_cselect_b32 s74, 2146435072, s74
  v_add_u32 v37, s74, v59
  s_add_u32 s6, s6, 2
  v_mfma_f32_16x16x32_bf16 v[64:67], v[48:51], v[104:107], v[64:67]
  v_mfma_f32_16x16x32_bf16 v[68:71], v[48:51], v[108:111], v[68:71]
  v_mfma_f32_16x16x32_bf16 v[64:67], v[48:51], v[112:115], v[64:67]
  v_mfma_f32_16x16x32_bf16 v[68:71], v[48:51], v[116:119], v[68:71]
  s_waitcnt lgkmcnt(0)
  s_lshl_b32 s6, s67, 8
  v_add_u32 v47, s6, v46
  s_waitcnt vmcnt(14)
  ds_read_b128 v[176:179], v24 offset:49152
  ds_read_b128 v[184:187], v47 offset:0
  ds_read_b128 v[188:191], v47 offset:16
  ds_read_b128 v[180:183], v24 offset:51200
  ds_read_b128 a[48:51], v24 offset:49152
  ds_read_b128 a[52:55], v24 offset:51200
  ds_read_b128 v[192:195], v25 offset:49152
  ds_read_b128 v[200:203], v47 offset:128
  ds_read_b128 v[204:207], v47 offset:144
  ds_read_b128 v[196:199], v25 offset:51200
  ds_read_b128 a[56:59], v25 offset:49152
  ds_read_b128 a[60:63], v25 offset:51200
  v_dot2_f32_bf16 v220, v72, v80, 0
  v_dot2_f32_bf16 v221, v72, v81, 0
  v_dot2_f32_bf16 v222, v73, v82, 0
  v_dot2_f32_bf16 v223, v73, v83, 0
  v_dot2_f32_bf16 v224, v74, v84, 0
  v_dot2_f32_bf16 v225, v74, v85, 0
  v_dot2_f32_bf16 v226, v75, v86, 0
  v_dot2_f32_bf16 v227, v75, v87, 0
  s_add_u32 m0, s8, 98304
  s_mul_i32 s10, s70, 128
  buffer_load_dwordx4 v4, s[36:39], s10 offen offset:0 lds
  v_dot2_f32_bf16 v228, v76, v80, 0
  v_dot2_f32_bf16 v229, v76, v81, 0
  v_dot2_f32_bf16 v230, v77, v82, 0
  v_dot2_f32_bf16 v231, v77, v83, 0
  v_dot2_f32_bf16 v232, v78, v84, 0
  v_dot2_f32_bf16 v233, v78, v85, 0
  v_dot2_f32_bf16 v234, v79, v86, 0
  v_dot2_f32_bf16 v235, v79, v87, 0
  v_cvt_pk_bf16_f32 v104, v220, v221
  v_cvt_pk_bf16_f32 v105, v222, v223
  v_cvt_pk_bf16_f32 v106, v224, v225
  v_cvt_pk_bf16_f32 v107, v226, v227
  buffer_load_dwordx4 v5, s[36:39], s10 offen offset:1024 lds
  v_cvt_pk_bf16_f32 v108, v228, v229
  v_cvt_pk_bf16_f32 v109, v230, v231
  v_cvt_pk_bf16_f32 v110, v232, v233
  v_cvt_pk_bf16_f32 v111, v234, v235
  v_dot2_f32_bf16 v220, v88, v96, 0
  v_dot2_f32_bf16 v221, v88, v97, 0
  v_dot2_f32_bf16 v222, v89, v98, 0
  v_dot2_f32_bf16 v223, v89, v99, 0
  v_dot2_f32_bf16 v224, v90, v100, 0
  v_dot2_f32_bf16 v225, v90, v101, 0
  v_dot2_f32_bf16 v226, v91, v102, 0
  v_dot2_f32_bf16 v227, v91, v103, 0
  buffer_load_dwordx4 v6, s[36:39], s10 offen offset:2048 lds
  v_dot2_f32_bf16 v228, v92, v96, 0
  v_dot2_f32_bf16 v229, v92, v97, 0
  v_dot2_f32_bf16 v230, v93, v98, 0
  v_dot2_f32_bf16 v231, v93, v99, 0
  v_dot2_f32_bf16 v232, v94, v100, 0
  v_dot2_f32_bf16 v233, v94, v101, 0
  v_dot2_f32_bf16 v234, v95, v102, 0
  v_dot2_f32_bf16 v235, v95, v103, 0
  v_cvt_pk_bf16_f32 v112, v220, v221
  v_cvt_pk_bf16_f32 v113, v222, v223
  v_cvt_pk_bf16_f32 v114, v224, v225
  v_cvt_pk_bf16_f32 v115, v226, v227
  buffer_load_dwordx4 v7, s[36:39], s10 offen offset:3072 lds
  v_cvt_pk_bf16_f32 v116, v228, v229
  v_cvt_pk_bf16_f32 v117, v230, v231
  v_cvt_pk_bf16_f32 v118, v232, v233
  v_cvt_pk_bf16_f32 v119, v234, v235
  s_lshr_b32 s7, s3, 1
  s_lshl1_add_u32 s6, s12, s7
  s_mul_i32 s6, s6, 245760
  s_mul_i32 s7, s13, 5120
  s_add_u32 s6, s6, s7
  s_and_b32 s7, s3, 1
  s_lshl_b32 s7, s7, 9
  s_add_u32 s34, s6, s7
  v_lshlrev_b32 v60, 4, v2
  v_mul_u32_u24 v61, 6208, v3
  v_add_u32 v61, v60, v61
  v_add_u32 v62, 18688, v61
  v_add_u32 v60, 12416, v60
  v_accvgpr_write_b32 a240, v61
  v_accvgpr_write_b32 a241, v62
  v_accvgpr_write_b32 a242, v60
  v_bfe_u32 v60, v1, 2, 2
  v_lshl_add_u32 v60, v3, 2, v60
  v_lshlrev_b32 v60, 4, v60
  v_add_u32 v60, 31232, v60
  v_and_b32 v61, 1, v1
  v_mul_u32_u24 v61, 6208, v61
  v_bfe_u32 v62, v1, 1, 1
  v_lshl_add_u32 v61, v62, 3, v61
  v_and_b32 v62, 3, v1
  v_cmp_eq_u32 vcc, 0, v62
  v_mov_b32 v63, 31168
  v_mov_b32 v254, 12416
  v_mov_b32 v255, 12424
  v_cndmask_b32 v254, v63, v254, vcc
  v_cndmask_b32 v255, v63, v255, vcc
  v_and_b32 v62, 16, v1
  v_cmp_eq_u32 vcc, 0, v62
  v_add_u32 v63, 18688, v61
  s_nop 0
  v_cndmask_b32 v254, v254, v61, vcc
  v_cndmask_b32 v255, v255, v63, vcc
  v_add_u32 v254, v60, v254
  v_add_u32 v255, v60, v255
  v_accvgpr_write_b32 a243, v254
  v_accvgpr_write_b32 a244, v255
  v_mfma_f32_16x16x32_bf16 v[64:67], v[48:51], v[104:107], v[64:67]
  v_mfma_f32_16x16x32_bf16 v[68:71], v[48:51], v[108:111], v[68:71]
  v_mfma_f32_16x16x32_bf16 v[64:67], v[48:51], v[112:115], v[64:67]
  v_mfma_f32_16x16x32_bf16 v[68:71], v[48:51], v[116:119], v[68:71]
  s_waitcnt lgkmcnt(0)
  s_lshl_b32 s6, s68, 8
  v_add_u32 v47, s6, v46
  s_waitcnt vmcnt(14)
  ds_read_b128 v[72:75], v24 offset:0
  ds_read_b128 v[80:83], v47 offset:0
  ds_read_b128 v[84:87], v47 offset:16
  ds_read_b128 v[76:79], v24 offset:2048
  ds_read_b128 a[64:67], v24 offset:0
  ds_read_b128 a[68:71], v24 offset:2048
  ds_read_b128 v[88:91], v25 offset:0
  ds_read_b128 v[96:99], v47 offset:128
  ds_read_b128 v[100:103], v47 offset:144
  ds_read_b128 v[92:95], v25 offset:2048
  ds_read_b128 a[72:75], v25 offset:0
  ds_read_b128 a[76:79], v25 offset:2048
  v_dot2_f32_bf16 v220, v176, v184, 0
  v_dot2_f32_bf16 v221, v176, v185, 0
  v_dot2_f32_bf16 v222, v177, v186, 0
  v_dot2_f32_bf16 v223, v177, v187, 0
  v_dot2_f32_bf16 v224, v178, v188, 0
  v_dot2_f32_bf16 v225, v178, v189, 0
  v_dot2_f32_bf16 v226, v179, v190, 0
  v_dot2_f32_bf16 v227, v179, v191, 0
  s_add_u32 m0, s8, 114688
  s_mul_i32 s10, s71, 128
  buffer_load_dwordx4 v4, s[36:39], s10 offen offset:0 lds
  v_dot2_f32_bf16 v228, v180, v184, 0
  v_dot2_f32_bf16 v229, v180, v185, 0
  v_dot2_f32_bf16 v230, v181, v186, 0
  v_dot2_f32_bf16 v231, v181, v187, 0
  v_dot2_f32_bf16 v232, v182, v188, 0
  v_dot2_f32_bf16 v233, v182, v189, 0
  v_dot2_f32_bf16 v234, v183, v190, 0
  v_dot2_f32_bf16 v235, v183, v191, 0
  v_cvt_pk_bf16_f32 v104, v220, v221
  v_cvt_pk_bf16_f32 v105, v222, v223
  v_cvt_pk_bf16_f32 v106, v224, v225
  v_cvt_pk_bf16_f32 v107, v226, v227
  buffer_load_dwordx4 v5, s[36:39], s10 offen offset:1024 lds
  v_cvt_pk_bf16_f32 v108, v228, v229
  v_cvt_pk_bf16_f32 v109, v230, v231
  v_cvt_pk_bf16_f32 v110, v232, v233
  v_cvt_pk_bf16_f32 v111, v234, v235
  v_dot2_f32_bf16 v220, v192, v200, 0
  v_dot2_f32_bf16 v221, v192, v201, 0
  v_dot2_f32_bf16 v222, v193, v202, 0
  v_dot2_f32_bf16 v223, v193, v203, 0
  v_dot2_f32_bf16 v224, v194, v204, 0
  v_dot2_f32_bf16 v225, v194, v205, 0
  v_dot2_f32_bf16 v226, v195, v206, 0
  v_dot2_f32_bf16 v227, v195, v207, 0
  buffer_load_dwordx4 v6, s[36:39], s10 offen offset:2048 lds
  v_dot2_f32_bf16 v228, v196, v200, 0
  v_dot2_f32_bf16 v229, v196, v201, 0
  v_dot2_f32_bf16 v230, v197, v202, 0
  v_dot2_f32_bf16 v231, v197, v203, 0
  v_dot2_f32_bf16 v232, v198, v204, 0
  v_dot2_f32_bf16 v233, v198, v205, 0
  v_dot2_f32_bf16 v234, v199, v206, 0
  v_dot2_f32_bf16 v235, v199, v207, 0
  v_cvt_pk_bf16_f32 v112, v220, v221
  v_cvt_pk_bf16_f32 v113, v222, v223
  v_cvt_pk_bf16_f32 v114, v224, v225
  v_cvt_pk_bf16_f32 v115, v226, v227
  buffer_load_dwordx4 v7, s[36:39], s10 offen offset:3072 lds
  v_cvt_pk_bf16_f32 v116, v228, v229
  v_cvt_pk_bf16_f32 v117, v230, v231
  v_cvt_pk_bf16_f32 v118, v232, v233
  v_cvt_pk_bf16_f32 v119, v234, v235
  s_add_u32 s6, s3, 0
  s_and_b32 s6, s6, 3
  s_lshl2_add_u32 s7, s14, s6
  s_mul_i32 s7, s7, 71680
  s_add_u32 s7, s7, 8388608
  v_add_u32 v60, s7, v59
  s_mul_i32 s6, s6, 15360
  s_add_u32 s6, s6, 20480
  v_lshl_add_u32 v61, v1, 4, s6
  v_accvgpr_write_b32 a248, v60
  v_accvgpr_write_b32 a247, v61
  s_add_u32 s6, s3, 1
  s_and_b32 s6, s6, 3
  s_lshl2_add_u32 s7, s14, s6
  s_mul_i32 s7, s7, 71680
  s_add_u32 s7, s7, 8388608
  v_add_u32 v60, s7, v59
  s_mul_i32 s6, s6, 15360
  s_add_u32 s6, s6, 20480
  v_lshl_add_u32 v61, v1, 4, s6
  v_accvgpr_write_b32 a249, v60
  v_accvgpr_write_b32 a252, v61
  s_add_u32 s6, s3, 2
  s_and_b32 s6, s6, 3
  s_lshl2_add_u32 s7, s14, s6
  s_mul_i32 s7, s7, 71680
  s_add_u32 s7, s7, 8388608
  v_add_u32 v60, s7, v59
  s_mul_i32 s6, s6, 15360
  s_add_u32 s6, s6, 25600
  v_lshl_add_u32 v61, v1, 4, s6
  v_accvgpr_write_b32 a250, v60
  v_accvgpr_write_b32 a253, v61
  v_mfma_f32_16x16x32_bf16 v[64:67], v[48:51], v[104:107], v[64:67]
  v_mfma_f32_16x16x32_bf16 v[68:71], v[48:51], v[108:111], v[68:71]
  v_mfma_f32_16x16x32_bf16 v[64:67], v[48:51], v[112:115], v[64:67]
  v_mfma_f32_16x16x32_bf16 v[68:71], v[48:51], v[116:119], v[68:71]
  s_waitcnt lgkmcnt(0)
  s_lshl_b32 s6, s69, 8
  v_add_u32 v47, s6, v46
  s_waitcnt vmcnt(8)
  ds_read_b128 v[176:179], v24 offset:16384
  ds_read_b128 v[184:187], v47 offset:0
  ds_read_b128 v[188:191], v47 offset:16
  ds_read_b128 v[180:183], v24 offset:18432
  ds_read_b128 a[80:83], v24 offset:16384
  ds_read_b128 a[84:87], v24 offset:18432
  ds_read_b128 v[192:195], v25 offset:16384
  ds_read_b128 v[200:203], v47 offset:128
  ds_read_b128 v[204:207], v47 offset:144
  ds_read_b128 v[196:199], v25 offset:18432
  ds_read_b128 a[88:91], v25 offset:16384
  ds_read_b128 a[92:95], v25 offset:18432
  v_dot2_f32_bf16 v220, v72, v80, 0
  v_dot2_f32_bf16 v221, v72, v81, 0
  v_dot2_f32_bf16 v222, v73, v82, 0
  v_dot2_f32_bf16 v223, v73, v83, 0
  v_dot2_f32_bf16 v224, v74, v84, 0
  v_dot2_f32_bf16 v225, v74, v85, 0
  v_dot2_f32_bf16 v226, v75, v86, 0
  v_dot2_f32_bf16 v227, v75, v87, 0
  s_add_u32 m0, s8, 65536
  s_mul_i32 s10, s72, 128
  buffer_load_dwordx4 v4, s[36:39], s10 offen offset:0 lds
  v_dot2_f32_bf16 v228, v76, v80, 0
  v_dot2_f32_bf16 v229, v76, v81, 0
  v_dot2_f32_bf16 v230, v77, v82, 0
  v_dot2_f32_bf16 v231, v77, v83, 0
  v_dot2_f32_bf16 v232, v78, v84, 0
  v_dot2_f32_bf16 v233, v78, v85, 0
  v_dot2_f32_bf16 v234, v79, v86, 0
  v_dot2_f32_bf16 v235, v79, v87, 0
  v_cvt_pk_bf16_f32 v104, v220, v221
  v_cvt_pk_bf16_f32 v105, v222, v223
  v_cvt_pk_bf16_f32 v106, v224, v225
  v_cvt_pk_bf16_f32 v107, v226, v227
  buffer_load_dwordx4 v5, s[36:39], s10 offen offset:1024 lds
  v_cvt_pk_bf16_f32 v108, v228, v229
  v_cvt_pk_bf16_f32 v109, v230, v231
  v_cvt_pk_bf16_f32 v110, v232, v233
  v_cvt_pk_bf16_f32 v111, v234, v235
  v_dot2_f32_bf16 v220, v88, v96, 0
  v_dot2_f32_bf16 v221, v88, v97, 0
  v_dot2_f32_bf16 v222, v89, v98, 0
  v_dot2_f32_bf16 v223, v89, v99, 0
  v_dot2_f32_bf16 v224, v90, v100, 0
  v_dot2_f32_bf16 v225, v90, v101, 0
  v_dot2_f32_bf16 v226, v91, v102, 0
  v_dot2_f32_bf16 v227, v91, v103, 0
  buffer_load_dwordx4 v6, s[36:39], s10 offen offset:2048 lds
  v_dot2_f32_bf16 v228, v92, v96, 0
  v_dot2_f32_bf16 v229, v92, v97, 0
  v_dot2_f32_bf16 v230, v93, v98, 0
  v_dot2_f32_bf16 v231, v93, v99, 0
  v_dot2_f32_bf16 v232, v94, v100, 0
  v_dot2_f32_bf16 v233, v94, v101, 0
  v_dot2_f32_bf16 v234, v95, v102, 0
  v_dot2_f32_bf16 v235, v95, v103, 0
  v_cvt_pk_bf16_f32 v112, v220, v221
  v_cvt_pk_bf16_f32 v113, v222, v223
  v_cvt_pk_bf16_f32 v114, v224, v225
  v_cvt_pk_bf16_f32 v115, v226, v227
  buffer_load_dwordx4 v7, s[36:39], s10 offen offset:3072 lds
  v_cvt_pk_bf16_f32 v116, v228, v229
  v_cvt_pk_bf16_f32 v117, v230, v231
  v_cvt_pk_bf16_f32 v118, v232, v233
  v_cvt_pk_bf16_f32 v119, v234, v235
  s_add_u32 s6, s3, 3
  s_and_b32 s6, s6, 3
  s_lshl2_add_u32 s7, s14, s6
  s_mul_i32 s7, s7, 71680
  s_add_u32 s7, s7, 8388608
  v_add_u32 v60, s7, v59
  s_mul_i32 s6, s6, 15360
  s_add_u32 s6, s6, 30720
  v_lshl_add_u32 v61, v1, 4, s6
  v_accvgpr_write_b32 a251, v60
  v_accvgpr_write_b32 a254, v61
  s_lshl2_add_u32 s6, s14, s3
  s_mul_i32 s6, s6, 20480
  s_mul_i32 s7, s15, 160
  s_add_u32 s6, s6, s7
  v_and_b32 v60, 15, v1
  v_mul_u32_u24 v60, 1280, v60
  v_add_u32 v60, s6, v60
  v_lshrrev_b32 v61, 4, v1
  v_lshl_add_u32 v62, v61, 4, v60
  v_lshl_add_u32 v61, v61, 3, v60
  s_and_b32 s6, s15, 1
  s_lshl_b32 s7, s6, 5
  v_add_u32 v62, s7, v62
  s_xor_b32 s6, s6, 1
  s_lshl_b32 s7, s6, 7
  v_add_u32 v61, s7, v61
  v_accvgpr_write_b32 a245, v62
  v_accvgpr_write_b32 a246, v61
  s_mul_i32 s6, s3, 24
  v_add_u32 v61, s6, v1
  v_add_u32 v60, 72, v1
  v_cmp_gt_u32 vcc, 24, v1
  s_lshl_b32 s6, s15, 13
  s_add_u32 s6, s6, 22806528
  v_cndmask_b32 v60, v60, v61, vcc
  v_lshl_add_u32 v33, v60, 2, s6
  v_mfma_f32_16x16x32_bf16 v[64:67], v[48:51], v[104:107], v[64:67]
  v_mfma_f32_16x16x32_bf16 v[68:71], v[48:51], v[108:111], v[68:71]
  v_mfma_f32_16x16x32_bf16 v[64:67], v[48:51], v[112:115], v[64:67]
  v_mfma_f32_16x16x32_bf16 v[68:71], v[48:51], v[116:119], v[68:71]
  s_waitcnt lgkmcnt(0)
  s_lshl_b32 s6, s70, 8
  v_add_u32 v47, s6, v46
  s_waitcnt vmcnt(8)
  ds_read_b128 v[72:75], v24 offset:32768
  ds_read_b128 v[80:83], v47 offset:0
  ds_read_b128 v[84:87], v47 offset:16
  ds_read_b128 v[76:79], v24 offset:34816
  ds_read_b128 a[96:99], v24 offset:32768
  ds_read_b128 a[100:103], v24 offset:34816
  ds_read_b128 v[88:91], v25 offset:32768
  ds_read_b128 v[96:99], v47 offset:128
  ds_read_b128 v[100:103], v47 offset:144
  ds_read_b128 v[92:95], v25 offset:34816
  ds_read_b128 a[104:107], v25 offset:32768
  ds_read_b128 a[108:111], v25 offset:34816
  v_dot2_f32_bf16 v220, v176, v184, 0
  v_dot2_f32_bf16 v221, v176, v185, 0
  v_dot2_f32_bf16 v222, v177, v186, 0
  v_dot2_f32_bf16 v223, v177, v187, 0
  v_dot2_f32_bf16 v224, v178, v188, 0
  v_dot2_f32_bf16 v225, v178, v189, 0
  v_dot2_f32_bf16 v226, v179, v190, 0
  v_dot2_f32_bf16 v227, v179, v191, 0
  s_add_u32 m0, s8, 81920
  s_mul_i32 s10, s73, 128
  buffer_load_dwordx4 v4, s[36:39], s10 offen offset:0 lds
  v_dot2_f32_bf16 v228, v180, v184, 0
  v_dot2_f32_bf16 v229, v180, v185, 0
  v_dot2_f32_bf16 v230, v181, v186, 0
  v_dot2_f32_bf16 v231, v181, v187, 0
  v_dot2_f32_bf16 v232, v182, v188, 0
  v_dot2_f32_bf16 v233, v182, v189, 0
  v_dot2_f32_bf16 v234, v183, v190, 0
  v_dot2_f32_bf16 v235, v183, v191, 0
  buffer_load_dwordx4 v5, s[36:39], s10 offen offset:1024 lds
  v_cvt_pk_bf16_f32 v104, v220, v221
  v_cvt_pk_bf16_f32 v105, v222, v223
  v_cvt_pk_bf16_f32 v106, v224, v225
  v_cvt_pk_bf16_f32 v107, v226, v227
  buffer_load_dwordx4 v6, s[36:39], s10 offen offset:2048 lds
  v_cvt_pk_bf16_f32 v108, v228, v229
  v_cvt_pk_bf16_f32 v109, v230, v231
  v_cvt_pk_bf16_f32 v110, v232, v233
  v_cvt_pk_bf16_f32 v111, v234, v235
  buffer_load_dwordx4 v7, s[36:39], s10 offen offset:3072 lds
  v_dot2_f32_bf16 v220, v192, v200, 0
  v_dot2_f32_bf16 v221, v192, v201, 0
  v_dot2_f32_bf16 v222, v193, v202, 0
  v_dot2_f32_bf16 v223, v193, v203, 0
  v_dot2_f32_bf16 v224, v194, v204, 0
  v_dot2_f32_bf16 v225, v194, v205, 0
  v_dot2_f32_bf16 v226, v195, v206, 0
  v_dot2_f32_bf16 v227, v195, v207, 0
  s_add_u32 m0, s9, 131072
  s_mul_i32 s10, s64, 196608
  buffer_load_dwordx4 v12, s[44:47], s10 offen offset:0 lds
  v_dot2_f32_bf16 v228, v196, v200, 0
  v_dot2_f32_bf16 v229, v196, v201, 0
  v_dot2_f32_bf16 v230, v197, v202, 0
  v_dot2_f32_bf16 v231, v197, v203, 0
  v_dot2_f32_bf16 v232, v198, v204, 0
  v_dot2_f32_bf16 v233, v198, v205, 0
  v_dot2_f32_bf16 v234, v199, v206, 0
  v_dot2_f32_bf16 v235, v199, v207, 0
  buffer_load_dwordx4 v13, s[44:47], s10 offen offset:1024 lds
  v_cvt_pk_bf16_f32 v112, v220, v221
  v_cvt_pk_bf16_f32 v113, v222, v223
  v_cvt_pk_bf16_f32 v114, v224, v225
  v_cvt_pk_bf16_f32 v115, v226, v227
  buffer_load_dwordx4 v14, s[44:47], s10 offen offset:2048 lds
  v_cvt_pk_bf16_f32 v116, v228, v229
  v_cvt_pk_bf16_f32 v117, v230, v231
  v_cvt_pk_bf16_f32 v118, v232, v233
  v_cvt_pk_bf16_f32 v119, v234, v235
  buffer_load_dword v15, off, s[60:63], 0 sc1
  s_mul_i32 s6, s13, 40
  s_lshr_b32 s7, s3, 1
  s_mul_i32 s7, s7, 5
  s_add_u32 s7, s7, 5
  v_and_b32 v60, 1, v1
  v_mul_u32_u24 v60, 39, v60
  v_add_u32 v60, s6, v60
  v_lshrrev_b32 v60, 7, v60
  v_add_u32 v61, s7, v60
  v_cmp_gt_u32 vcc, 6, v1
  v_lshrrev_b32 v62, 1, v1
  v_min_u32 v62, 2, v62
  v_cndmask_b32 v60, v60, v61, vcc
  s_sub_u32 s6, s12, 2
  v_add_u32 v62, s6, v62
  v_max_i32 v62, 0, v62
  v_lshl_add_u32 v60, v62, 4, v60
  v_lshlrev_b32 v60, 10, v60
  v_add_u32 v34, 22020096, v60
  s_lshr_b32 s6, s14, 1
  s_lshl_b32 s6, s6, 14
  s_lshl_b32 s7, s3, 12
  s_add_u32 s7, s7, s6
  s_add_u32 s7, s7, 22282240
  v_lshl_add_u32 v61, v1, 10, s7
  s_add_u32 s7, s6, 22035456
  v_mov_b32 v60, s7
  v_cmp_gt_u32 vcc, 4, v1
  s_add_u32 s6, s6, 22544384
  v_and_b32 v62, 15, v1
  v_cndmask_b32 v57, v60, v61, vcc
  v_lshl_add_u32 v58, v62, 10, s6
  s_lshl_b32 s6, s12, 14
  s_add_u32 s6, s6, 22035456
  v_cmp_gt_u32 vcc, 5, v1
  v_mov_b32 v60, s6
  s_nop 0
  v_cndmask_b32 v57, v60, v57, vcc
  v_mfma_f32_16x16x32_bf16 v[64:67], v[48:51], v[104:107], v[64:67]
  v_mfma_f32_16x16x32_bf16 v[68:71], v[48:51], v[108:111], v[68:71]
  v_mfma_f32_16x16x32_bf16 v[64:67], v[48:51], v[112:115], v[64:67]
  v_mfma_f32_16x16x32_bf16 v[68:71], v[48:51], v[116:119], v[68:71]
  s_waitcnt lgkmcnt(0)
  s_barrier
  s_lshl_b32 s6, s71, 8
  v_add_u32 v47, s6, v46
  s_waitcnt vmcnt(12)
  ds_read_b128 v[176:179], v24 offset:49152
  ds_read_b128 v[184:187], v47 offset:0
  ds_read_b128 v[188:191], v47 offset:16
  ds_read_b128 v[180:183], v24 offset:51200
  ds_read_b128 a[112:115], v24 offset:49152
  ds_read_b128 a[116:119], v24 offset:51200
  ds_read_b128 v[192:195], v25 offset:49152
  ds_read_b128 v[200:203], v47 offset:128
  ds_read_b128 v[204:207], v47 offset:144
  ds_read_b128 v[196:199], v25 offset:51200
  ds_read_b128 a[120:123], v25 offset:49152
  ds_read_b128 a[124:127], v25 offset:51200
  v_dot2_f32_bf16 v220, v72, v80, 0
  v_dot2_f32_bf16 v221, v72, v81, 0
  v_dot2_f32_bf16 v222, v73, v82, 0
  v_dot2_f32_bf16 v223, v73, v83, 0
  v_dot2_f32_bf16 v224, v74, v84, 0
  v_dot2_f32_bf16 v225, v74, v85, 0
  v_dot2_f32_bf16 v226, v75, v86, 0
  v_dot2_f32_bf16 v227, v75, v87, 0
  s_add_u32 m0, s9, 98304
  s_mul_i32 s10, s65, 196608
  buffer_load_dwordx4 v12, s[44:47], s10 offen offset:0 lds
  v_dot2_f32_bf16 v228, v76, v80, 0
  v_dot2_f32_bf16 v229, v76, v81, 0
  v_dot2_f32_bf16 v230, v77, v82, 0
  v_dot2_f32_bf16 v231, v77, v83, 0
  v_dot2_f32_bf16 v232, v78, v84, 0
  v_dot2_f32_bf16 v233, v78, v85, 0
  v_dot2_f32_bf16 v234, v79, v86, 0
  v_dot2_f32_bf16 v235, v79, v87, 0
  buffer_load_dwordx4 v13, s[44:47], s10 offen offset:1024 lds
  v_cvt_pk_bf16_f32 v104, v220, v221
  v_cvt_pk_bf16_f32 v105, v222, v223
  v_cvt_pk_bf16_f32 v106, v224, v225
  v_cvt_pk_bf16_f32 v107, v226, v227
  buffer_load_dwordx4 v14, s[44:47], s10 offen offset:2048 lds
  v_cvt_pk_bf16_f32 v108, v228, v229
  v_cvt_pk_bf16_f32 v109, v230, v231
  v_cvt_pk_bf16_f32 v110, v232, v233
  v_cvt_pk_bf16_f32 v111, v234, v235
  v_dot2_f32_bf16 v220, v88, v96, 0
  v_dot2_f32_bf16 v221, v88, v97, 0
  v_dot2_f32_bf16 v222, v89, v98, 0
  v_dot2_f32_bf16 v223, v89, v99, 0
  v_dot2_f32_bf16 v224, v90, v100, 0
  v_dot2_f32_bf16 v225, v90, v101, 0
  v_dot2_f32_bf16 v226, v91, v102, 0
  v_dot2_f32_bf16 v227, v91, v103, 0
  s_add_u32 m0, s9, 143360
  s_mul_i32 s10, s72, 196608
  buffer_load_dwordx4 v12, s[44:47], s10 offen offset:0 lds
  v_dot2_f32_bf16 v228, v92, v96, 0
  v_dot2_f32_bf16 v229, v92, v97, 0
  v_dot2_f32_bf16 v230, v93, v98, 0
  v_dot2_f32_bf16 v231, v93, v99, 0
  v_dot2_f32_bf16 v232, v94, v100, 0
  v_dot2_f32_bf16 v233, v94, v101, 0
  v_dot2_f32_bf16 v234, v95, v102, 0
  v_dot2_f32_bf16 v235, v95, v103, 0
  buffer_load_dwordx4 v13, s[44:47], s10 offen offset:1024 lds
  v_cvt_pk_bf16_f32 v112, v220, v221
  v_cvt_pk_bf16_f32 v113, v222, v223
  v_cvt_pk_bf16_f32 v114, v224, v225
  v_cvt_pk_bf16_f32 v115, v226, v227
  buffer_load_dwordx4 v14, s[44:47], s10 offen offset:2048 lds
  v_cvt_pk_bf16_f32 v116, v228, v229
  v_cvt_pk_bf16_f32 v117, v230, v231
  v_cvt_pk_bf16_f32 v118, v232, v233
  v_cvt_pk_bf16_f32 v119, v234, v235
  v_mfma_f32_16x16x32_bf16 v[64:67], v[48:51], v[104:107], v[64:67]
  v_mfma_f32_16x16x32_bf16 v[68:71], v[48:51], v[108:111], v[68:71]
  v_mfma_f32_16x16x32_bf16 v[64:67], v[48:51], v[112:115], v[64:67]
  v_mfma_f32_16x16x32_bf16 v[68:71], v[48:51], v[116:119], v[68:71]
  s_waitcnt lgkmcnt(0)
  s_barrier
  s_lshl_b32 s6, s72, 8
  v_add_u32 v47, s6, v46
  s_waitcnt vmcnt(14)
  ds_read_b128 v[72:75], v24 offset:0
  ds_read_b128 v[80:83], v47 offset:0
  ds_read_b128 v[84:87], v47 offset:16
  ds_read_b128 v[76:79], v24 offset:2048
  ds_read_b128 a[128:131], v24 offset:0
  ds_read_b128 a[132:135], v24 offset:2048
  ds_read_b128 v[88:91], v25 offset:0
  ds_read_b128 v[96:99], v47 offset:128
  ds_read_b128 v[100:103], v47 offset:144
  ds_read_b128 v[92:95], v25 offset:2048
  ds_read_b128 a[136:139], v25 offset:0
  ds_read_b128 a[140:143], v25 offset:2048
  v_dot2_f32_bf16 v220, v176, v184, 0
  v_dot2_f32_bf16 v221, v176, v185, 0
  v_dot2_f32_bf16 v222, v177, v186, 0
  v_dot2_f32_bf16 v223, v177, v187, 0
  v_dot2_f32_bf16 v224, v178, v188, 0
  v_dot2_f32_bf16 v225, v178, v189, 0
  v_dot2_f32_bf16 v226, v179, v190, 0
  v_dot2_f32_bf16 v227, v179, v191, 0
  s_add_u32 m0, s9, 114688
  s_mul_i32 s10, s67, 196608
  buffer_load_dwordx4 v12, s[44:47], s10 offen offset:0 lds
  v_dot2_f32_bf16 v228, v180, v184, 0
  v_dot2_f32_bf16 v229, v180, v185, 0
  v_dot2_f32_bf16 v230, v181, v186, 0
  v_dot2_f32_bf16 v231, v181, v187, 0
  v_dot2_f32_bf16 v232, v182, v188, 0
  v_dot2_f32_bf16 v233, v182, v189, 0
  v_dot2_f32_bf16 v234, v183, v190, 0
  v_dot2_f32_bf16 v235, v183, v191, 0
  buffer_load_dwordx4 v13, s[44:47], s10 offen offset:1024 lds
  v_cvt_pk_bf16_f32 v104, v220, v221
  v_cvt_pk_bf16_f32 v105, v222, v223
  v_cvt_pk_bf16_f32 v106, v224, v225
  v_cvt_pk_bf16_f32 v107, v226, v227
  buffer_load_dwordx4 v14, s[44:47], s10 offen offset:2048 lds
  v_cvt_pk_bf16_f32 v108, v228, v229
  v_cvt_pk_bf16_f32 v109, v230, v231
  v_cvt_pk_bf16_f32 v110, v232, v233
  v_cvt_pk_bf16_f32 v111, v234, v235
  v_dot2_f32_bf16 v220, v192, v200, 0
  v_dot2_f32_bf16 v221, v192, v201, 0
  v_dot2_f32_bf16 v222, v193, v202, 0
  v_dot2_f32_bf16 v223, v193, v203, 0
  v_dot2_f32_bf16 v224, v194, v204, 0
  v_dot2_f32_bf16 v225, v194, v205, 0
  v_dot2_f32_bf16 v226, v195, v206, 0
  v_dot2_f32_bf16 v227, v195, v207, 0
  s_add_u32 m0, s9, 32768
  s_mul_i32 s10, s73, 196608
  buffer_load_dwordx4 v12, s[44:47], s10 offen offset:0 lds
  v_dot2_f32_bf16 v228, v196, v200, 0
  v_dot2_f32_bf16 v229, v196, v201, 0
  v_dot2_f32_bf16 v230, v197, v202, 0
  v_dot2_f32_bf16 v231, v197, v203, 0
  v_dot2_f32_bf16 v232, v198, v204, 0
  v_dot2_f32_bf16 v233, v198, v205, 0
  v_dot2_f32_bf16 v234, v199, v206, 0
  v_dot2_f32_bf16 v235, v199, v207, 0
  buffer_load_dwordx4 v13, s[44:47], s10 offen offset:1024 lds
  v_cvt_pk_bf16_f32 v112, v220, v221
  v_cvt_pk_bf16_f32 v113, v222, v223
  v_cvt_pk_bf16_f32 v114, v224, v225
  v_cvt_pk_bf16_f32 v115, v226, v227
  buffer_load_dwordx4 v14, s[44:47], s10 offen offset:2048 lds
  v_cvt_pk_bf16_f32 v116, v228, v229
  v_cvt_pk_bf16_f32 v117, v230, v231
  v_cvt_pk_bf16_f32 v118, v232, v233
  v_cvt_pk_bf16_f32 v119, v234, v235
  v_mfma_f32_16x16x32_bf16 v[64:67], v[48:51], v[104:107], v[64:67]
  v_mfma_f32_16x16x32_bf16 v[68:71], v[48:51], v[108:111], v[68:71]
  v_mfma_f32_16x16x32_bf16 v[64:67], v[48:51], v[112:115], v[64:67]
  v_mfma_f32_16x16x32_bf16 v[68:71], v[48:51], v[116:119], v[68:71]
  s_waitcnt lgkmcnt(0)
  s_lshl_b32 s6, s73, 8
  v_add_u32 v47, s6, v46
  s_waitcnt vmcnt(16)
  ds_read_b128 v[176:179], v24 offset:16384
  ds_read_b128 v[184:187], v47 offset:0
  ds_read_b128 v[188:191], v47 offset:16
  ds_read_b128 v[180:183], v24 offset:18432
  ds_read_b128 a[144:147], v24 offset:16384
  ds_read_b128 a[148:151], v24 offset:18432
  ds_read_b128 v[192:195], v25 offset:16384
  ds_read_b128 v[200:203], v47 offset:128
  ds_read_b128 v[204:207], v47 offset:144
  ds_read_b128 v[196:199], v25 offset:18432
  ds_read_b128 a[152:155], v25 offset:16384
  ds_read_b128 a[156:159], v25 offset:18432
  v_dot2_f32_bf16 v220, v72, v80, 0
  v_dot2_f32_bf16 v221, v72, v81, 0
  v_dot2_f32_bf16 v222, v73, v82, 0
  v_dot2_f32_bf16 v223, v73, v83, 0
  v_dot2_f32_bf16 v224, v74, v84, 0
  v_dot2_f32_bf16 v225, v74, v85, 0
  v_dot2_f32_bf16 v226, v75, v86, 0
  v_dot2_f32_bf16 v227, v75, v87, 0
  s_add_u32 m0, s9, 49152
  s_mul_i32 s10, s66, 196608
  buffer_load_dwordx4 v12, s[44:47], s10 offen offset:0 lds
  v_dot2_f32_bf16 v228, v76, v80, 0
  v_dot2_f32_bf16 v229, v76, v81, 0
  v_dot2_f32_bf16 v230, v77, v82, 0
  v_dot2_f32_bf16 v231, v77, v83, 0
  v_dot2_f32_bf16 v232, v78, v84, 0
  v_dot2_f32_bf16 v233, v78, v85, 0
  v_dot2_f32_bf16 v234, v79, v86, 0
  v_dot2_f32_bf16 v235, v79, v87, 0
  v_cvt_pk_bf16_f32 v104, v220, v221
  v_cvt_pk_bf16_f32 v105, v222, v223
  v_cvt_pk_bf16_f32 v106, v224, v225
  v_cvt_pk_bf16_f32 v107, v226, v227
  buffer_load_dwordx4 v13, s[44:47], s10 offen offset:1024 lds
  v_cvt_pk_bf16_f32 v108, v228, v229
  v_cvt_pk_bf16_f32 v109, v230, v231
  v_cvt_pk_bf16_f32 v110, v232, v233
  v_cvt_pk_bf16_f32 v111, v234, v235
  v_dot2_f32_bf16 v220, v88, v96, 0
  v_dot2_f32_bf16 v221, v88, v97, 0
  v_dot2_f32_bf16 v222, v89, v98, 0
  v_dot2_f32_bf16 v223, v89, v99, 0
  v_dot2_f32_bf16 v224, v90, v100, 0
  v_dot2_f32_bf16 v225, v90, v101, 0
  v_dot2_f32_bf16 v226, v91, v102, 0
  v_dot2_f32_bf16 v227, v91, v103, 0
  buffer_load_dwordx4 v14, s[44:47], s10 offen offset:2048 lds
  v_dot2_f32_bf16 v228, v92, v96, 0
  v_dot2_f32_bf16 v229, v92, v97, 0
  v_dot2_f32_bf16 v230, v93, v98, 0
  v_dot2_f32_bf16 v231, v93, v99, 0
  v_dot2_f32_bf16 v232, v94, v100, 0
  v_dot2_f32_bf16 v233, v94, v101, 0
  v_dot2_f32_bf16 v234, v95, v102, 0
  v_dot2_f32_bf16 v235, v95, v103, 0
  v_cvt_pk_bf16_f32 v112, v220, v221
  v_cvt_pk_bf16_f32 v113, v222, v223
  v_cvt_pk_bf16_f32 v114, v224, v225
  v_cvt_pk_bf16_f32 v115, v226, v227
  s_waitcnt vmcnt(15)
  v_cmp_gt_u32 vcc, 32, v15
  s_cbranch_vccnz SL_rdyg
OK_rdyg:
  buffer_store_dword v30, v247, s[48:51], 0 offen sc1
  buffer_store_dword v30, v135, s[48:51], 0 offen sc1
  v_cvt_pk_bf16_f32 v116, v228, v229
  v_cvt_pk_bf16_f32 v117, v230, v231
  v_cvt_pk_bf16_f32 v118, v232, v233
  v_cvt_pk_bf16_f32 v119, v234, v235
  v_mfma_f32_16x16x32_bf16 v[64:67], v[48:51], v[104:107], v[64:67]
  v_mfma_f32_16x16x32_bf16 v[68:71], v[48:51], v[108:111], v[68:71]
  v_mfma_f32_16x16x32_bf16 v[64:67], v[48:51], v[112:115], v[64:67]
  v_mfma_f32_16x16x32_bf16 v[68:71], v[48:51], v[116:119], v[68:71]
  s_waitcnt lgkmcnt(0)
  v_dot2_f32_bf16 v220, v176, v184, 0
  v_dot2_f32_bf16 v221, v176, v185, 0
  v_dot2_f32_bf16 v222, v177, v186, 0
  v_dot2_f32_bf16 v223, v177, v187, 0
  v_dot2_f32_bf16 v224, v178, v188, 0
  v_dot2_f32_bf16 v225, v178, v189, 0
  v_dot2_f32_bf16 v226, v179, v190, 0
  v_dot2_f32_bf16 v227, v179, v191, 0
  v_dot2_f32_bf16 v228, v180, v184, 0
  v_dot2_f32_bf16 v229, v180, v185, 0
  v_dot2_f32_bf16 v230, v181, v186, 0
  v_dot2_f32_bf16 v231, v181, v187, 0
  v_dot2_f32_bf16 v232, v182, v188, 0
  v_dot2_f32_bf16 v233, v182, v189, 0
  v_dot2_f32_bf16 v234, v183, v190, 0
  v_dot2_f32_bf16 v235, v183, v191, 0
  v_cvt_pk_bf16_f32 v104, v220, v221
  v_cvt_pk_bf16_f32 v105, v222, v223
  v_cvt_pk_bf16_f32 v106, v224, v225
  v_cvt_pk_bf16_f32 v107, v226, v227
  v_cvt_pk_bf16_f32 v108, v228, v229
  v_cvt_pk_bf16_f32 v109, v230, v231
  v_cvt_pk_bf16_f32 v110, v232, v233
  v_cvt_pk_bf16_f32 v111, v234, v235
  v_dot2_f32_bf16 v220, v192, v200, 0
  v_dot2_f32_bf16 v221, v192, v201, 0
  v_dot2_f32_bf16 v222, v193, v202, 0
  v_dot2_f32_bf16 v223, v193, v203, 0
  v_dot2_f32_bf16 v224, v194, v204, 0
  v_dot2_f32_bf16 v225, v194, v205, 0
  v_dot2_f32_bf16 v226, v195, v206, 0
  v_dot2_f32_bf16 v227, v195, v207, 0
  v_dot2_f32_bf16 v228, v196, v200, 0
  v_dot2_f32_bf16 v229, v196, v201, 0
  v_dot2_f32_bf16 v230, v197, v202, 0
  v_dot2_f32_bf16 v231, v197, v203, 0
  v_dot2_f32_bf16 v232, v198, v204, 0
  v_dot2_f32_bf16 v233, v198, v205, 0
  v_dot2_f32_bf16 v234, v199, v206, 0
  v_dot2_f32_bf16 v235, v199, v207, 0
  v_cvt_pk_bf16_f32 v112, v220, v221
  v_cvt_pk_bf16_f32 v113, v222, v223
  v_cvt_pk_bf16_f32 v114, v224, v225
  v_cvt_pk_bf16_f32 v115, v226, v227
  v_cvt_pk_bf16_f32 v116, v228, v229
  v_cvt_pk_bf16_f32 v117, v230, v231
  v_cvt_pk_bf16_f32 v118, v232, v233
  v_cvt_pk_bf16_f32 v119, v234, v235
  v_mfma_f32_16x16x32_bf16 v[64:67], v[48:51], v[104:107], v[64:67]
  v_mfma_f32_16x16x32_bf16 v[68:71], v[48:51], v[108:111], v[68:71]
  v_mfma_f32_16x16x32_bf16 v[64:67], v[48:51], v[112:115], v[64:67]
  v_mfma_f32_16x16x32_bf16 v[68:71], v[48:51], v[116:119], v[68:71]
  v_and_b32 v60, 16, v1
  v_cmp_eq_u32 vcc, 0, v60
  s_nop 7
  v_cndmask_b32 v46, v68, v64, vcc
  v_cvt_pk_bf16_f32 v46, v46, v46
  v_lshlrev_b32 v46, 16, v46
  v_mul_f32 v46, 0xbfb8aa3b, v46
  v_exp_f32 v46, v46
  s_nop 0
  v_add_f32 v46, 1.0, v46
  v_rcp_f32 v46, v46
  s_nop 0
  v_cvt_pk_bf16_f32 v46, v46, v46
  v_lshlrev_b32 v46, 16, v46
  s_lshl2_add_u32 s6, s4, s3
  s_lshl_b32 s6, s6, 7
  s_add_u32 s6, s6, 20971520
  v_lshlrev_b32 v47, 2, v2
  v_lshl_add_u32 v47, v3, 30, v47
  s_waitcnt vmcnt(2)
  s_barrier
  ds_read_b64_tr_b16 v[176:177], v44 offset:0
  ds_read_b64_tr_b16 v[178:179], v44 offset:768
  ds_read_b64_tr_b16 v[180:181], v45 offset:0
  ds_read_b64_tr_b16 v[182:183], v45 offset:768
  ds_read_b64_tr_b16 v[184:185], v44 offset:64
  ds_read_b64_tr_b16 v[186:187], v44 offset:832
  ds_read_b64_tr_b16 v[188:189], v45 offset:64
  ds_read_b64_tr_b16 v[190:191], v45 offset:832
  ds_read_b64_tr_b16 v[192:193], v44 offset:128
  ds_read_b64_tr_b16 v[194:195], v44 offset:896
  buffer_store_dword v46, v47, s[48:51], s6 offen sc1
  s_waitcnt lgkmcnt(0)
  s_branch L_R2
SL_rdy:
  s_mov_b32 s0, 0
SLL_rdy:
  s_sleep 1
  buffer_load_dword v15, off, s[60:63], 0 sc1
  s_add_u32 s0, s0, 1
  s_waitcnt vmcnt(0)
  v_cmp_gt_u32 vcc, 32, v15
  s_cbranch_vccz OK_rdy
  s_cmp_lt_u32 s0, 0x40000
  s_cbranch_scc1 SLL_rdy
  s_branch OK_rdy
SL_fw:
  s_mov_b32 s0, 0
SLL_fw:
  s_sleep 1
  buffer_load_dword v15, v33, s[48:51], 0 offen sc1
  s_add_u32 s0, s0, 1
  s_waitcnt vmcnt(0)
  v_cmp_gt_u32 vcc, 1, v15
  s_cbranch_vccz OK_fw
  s_cmp_lt_u32 s0, 0x40000
  s_cbranch_scc1 SLL_fw
  s_branch OK_fw
SL_fq:
  s_mov_b32 s0, 0
SLL_fq:
  s_sleep 1
  buffer_load_dword v15, v34, s[48:51], 0 offen sc1
  s_add_u32 s0, s0, 1
  s_waitcnt vmcnt(0)
  v_cmp_gt_u32 vcc, 4, v15
  s_cbranch_vccz OK_fq
  s_cmp_lt_u32 s0, 0x40000
  s_cbranch_scc1 SLL_fq
  s_branch OK_fq
SL_fh:
  s_mov_b32 s0, 0
SLL_fh:
  s_sleep 1
  buffer_load_dword v15, v57, s[48:51], 0 offen sc1
  s_add_u32 s0, s0, 1
  s_waitcnt vmcnt(0)
  v_cmp_gt_u32 vcc, 4, v15
  s_cbranch_vccz OK_fh
  s_cmp_lt_u32 s0, 0x40000
  s_cbranch_scc1 SLL_fh
  s_branch OK_fh
L_SAFE:
  v_lshlrev_b32 v60, 2, v3
  v_sub_u32 v60, v2, v60
  v_subrev_u32 v61, 0, v60
  v_ashrrev_i32 v61, 31, v61
  v_and_b32 v112, 0xff800000, v61
  v_subrev_u32 v61, 1, v60
  v_ashrrev_i32 v61, 31, v61
  v_and_b32 v113, 0xff800000, v61
  v_subrev_u32 v61, 2, v60
  v_ashrrev_i32 v61, 31, v61
  v_and_b32 v114, 0xff800000, v61
  v_subrev_u32 v61, 3, v60
  v_ashrrev_i32 v61, 31, v61
  v_and_b32 v115, 0xff800000, v61
  v_subrev_u32 v61, 8, v60
  v_ashrrev_i32 v61, 31, v61
  v_and_b32 v116, 0xff800000, v61
  v_subrev_u32 v61, 9, v60
  v_ashrrev_i32 v61, 31, v61
  v_and_b32 v117, 0xff800000, v61
  v_subrev_u32 v61, 10, v60
  v_ashrrev_i32 v61, 31, v61
  v_and_b32 v118, 0xff800000, v61
  v_subrev_u32 v61, 11, v60
  v_ashrrev_i32 v61, 31, v61
  v_and_b32 v119, 0xff800000, v61
  v_subrev_u32 v61, 16, v60
  v_ashrrev_i32 v61, 31, v61
  v_and_b32 v120, 0xff800000, v61
  v_subrev_u32 v61, 17, v60
  v_ashrrev_i32 v61, 31, v61
  v_and_b32 v121, 0xff800000, v61
  v_subrev_u32 v61, 18, v60
  v_ashrrev_i32 v61, 31, v61
  v_and_b32 v122, 0xff800000, v61
  v_subrev_u32 v61, 19, v60
  v_ashrrev_i32 v61, 31, v61
  v_and_b32 v123, 0xff800000, v61
  v_subrev_u32 v61, 24, v60
  v_ashrrev_i32 v61, 31, v61
  v_and_b32 v124, 0xff800000, v61
  v_subrev_u32 v61, 25, v60
  v_ashrrev_i32 v61, 31, v61
  v_and_b32 v125, 0xff800000, v61
  v_subrev_u32 v61, 26, v60
  v_ashrrev_i32 v61, 31, v61
  v_and_b32 v126, 0xff800000, v61
  v_subrev_u32 v61, 27, v60
  v_ashrrev_i32 v61, 31, v61
  v_and_b32 v127, 0xff800000, v61
  v_mov_b32 v63, 0xff800000
  s_mov_b32 s64, 0
SF0A:
  s_cmp_lt_u32 s64, 4
  s_cbranch_scc0 SF0A_B
  s_cmp_ge_u32 s12, 1
  s_cbranch_scc0 SF0A_N
  s_add_u32 s65, s64, 8
  s_sub_u32 s65, s65, s3
  s_branch SF0A_C
SF0A_B:
  s_sub_u32 s65, s64, 4
  s_add_u32 s6, s65, s3
  s_cmp_ge_u32 s6, 4
  s_cbranch_scc1 SF0A_C
  s_cmp_ge_u32 s12, 2
  s_cbranch_scc0 SF0A_N
SF0A_C:
  s_lshl_b32 s65, s65, 9
  v_add_u32 v60, s65, v4
  v_add_u32 v61, s65, v6
  v_add_u32 v62, s65, v7
  ds_read_b128 v[176:179], v60
  ds_read_b128 v[180:183], v61
  s_waitcnt lgkmcnt(0)
  v_mfma_f32_32x32x16_bf16 v[96:111], v[176:179], v[40:43], 0
  v_mfma_f32_32x32x16_bf16 v[96:111], v[180:183], v[48:51], v[96:111]
  s_nop 15
  s_cmp_eq_u32 s64, 4
  s_cbranch_scc0 SF0A_M4
  v_xor_b32 v60, 0xff800000, v112
  v_add_f32 v96, v96, v60
  v_xor_b32 v60, 0xff800000, v113
  v_add_f32 v97, v97, v60
  v_xor_b32 v60, 0xff800000, v114
  v_add_f32 v98, v98, v60
  v_xor_b32 v60, 0xff800000, v115
  v_add_f32 v99, v99, v60
  v_xor_b32 v60, 0xff800000, v116
  v_add_f32 v100, v100, v60
  v_xor_b32 v60, 0xff800000, v117
  v_add_f32 v101, v101, v60
  v_xor_b32 v60, 0xff800000, v118
  v_add_f32 v102, v102, v60
  v_xor_b32 v60, 0xff800000, v119
  v_add_f32 v103, v103, v60
  v_xor_b32 v60, 0xff800000, v120
  v_add_f32 v104, v104, v60
  v_xor_b32 v60, 0xff800000, v121
  v_add_f32 v105, v105, v60
  v_xor_b32 v60, 0xff800000, v122
  v_add_f32 v106, v106, v60
  v_xor_b32 v60, 0xff800000, v123
  v_add_f32 v107, v107, v60
  v_xor_b32 v60, 0xff800000, v124
  v_add_f32 v108, v108, v60
  v_xor_b32 v60, 0xff800000, v125
  v_add_f32 v109, v109, v60
  v_xor_b32 v60, 0xff800000, v126
  v_add_f32 v110, v110, v60
  v_xor_b32 v60, 0xff800000, v127
  v_add_f32 v111, v111, v60
SF0A_M4:
  s_cmp_eq_u32 s64, 8
  s_cbranch_scc0 SF0A_M8
  v_add_f32 v96, v96, v112
  v_add_f32 v97, v97, v113
  v_add_f32 v98, v98, v114
  v_add_f32 v99, v99, v115
  v_add_f32 v100, v100, v116
  v_add_f32 v101, v101, v117
  v_add_f32 v102, v102, v118
  v_add_f32 v103, v103, v119
  v_add_f32 v104, v104, v120
  v_add_f32 v105, v105, v121
  v_add_f32 v106, v106, v122
  v_add_f32 v107, v107, v123
  v_add_f32 v108, v108, v124
  v_add_f32 v109, v109, v125
  v_add_f32 v110, v110, v126
  v_add_f32 v111, v111, v127
SF0A_M8:
  v_max3_f32 v63, v63, v96, v97
  v_max3_f32 v63, v63, v98, v99
  v_max3_f32 v63, v63, v100, v101
  v_max3_f32 v63, v63, v102, v103
  v_max3_f32 v63, v63, v104, v105
  v_max3_f32 v63, v63, v106, v107
  v_max3_f32 v63, v63, v108, v109
  v_max3_f32 v63, v63, v110, v111
SF0A_N:
  s_add_u32 s64, s64, 1
  s_cmp_lt_u32 s64, 9
  s_cbranch_scc1 SF0A
  v_mov_b32 v60, v63
  s_nop 1
  v_permlane32_swap_b32 v60, v63
  s_nop 1
  v_max_f32 v63, v60, v63
  v_mov_b32 v144, 0
  v_mov_b32 v145, 0
  v_mov_b32 v146, 0
  v_mov_b32 v147, 0
  v_mov_b32 v148, 0
  v_mov_b32 v149, 0
  v_mov_b32 v150, 0
  v_mov_b32 v151, 0
  v_mov_b32 v152, 0
  v_mov_b32 v153, 0
  v_mov_b32 v154, 0
  v_mov_b32 v155, 0
  v_mov_b32 v156, 0
  v_mov_b32 v157, 0
  v_mov_b32 v158, 0
  v_mov_b32 v159, 0
  s_mov_b32 s64, 0
SF0B:
  s_cmp_lt_u32 s64, 4
  s_cbranch_scc0 SF0B_B
  s_cmp_ge_u32 s12, 1
  s_cbranch_scc0 SF0B_N
  s_add_u32 s65, s64, 8
  s_sub_u32 s65, s65, s3
  s_branch SF0B_C
SF0B_B:
  s_sub_u32 s65, s64, 4
  s_add_u32 s6, s65, s3
  s_cmp_ge_u32 s6, 4
  s_cbranch_scc1 SF0B_C
  s_cmp_ge_u32 s12, 2
  s_cbranch_scc0 SF0B_N
SF0B_C:
  s_lshl_b32 s65, s65, 9
  v_add_u32 v60, s65, v4
  v_add_u32 v61, s65, v6
  v_add_u32 v62, s65, v7
  ds_read_b128 v[176:179], v60
  ds_read_b128 v[180:183], v61
  s_waitcnt lgkmcnt(0)
  v_mfma_f32_32x32x16_bf16 v[96:111], v[176:179], v[40:43], 0
  v_mfma_f32_32x32x16_bf16 v[96:111], v[180:183], v[48:51], v[96:111]
  s_nop 15
  s_cmp_eq_u32 s64, 4
  s_cbranch_scc0 SF0B_M4
  v_xor_b32 v60, 0xff800000, v112
  v_add_f32 v96, v96, v60
  v_xor_b32 v60, 0xff800000, v113
  v_add_f32 v97, v97, v60
  v_xor_b32 v60, 0xff800000, v114
  v_add_f32 v98, v98, v60
  v_xor_b32 v60, 0xff800000, v115
  v_add_f32 v99, v99, v60
  v_xor_b32 v60, 0xff800000, v116
  v_add_f32 v100, v100, v60
  v_xor_b32 v60, 0xff800000, v117
  v_add_f32 v101, v101, v60
  v_xor_b32 v60, 0xff800000, v118
  v_add_f32 v102, v102, v60
  v_xor_b32 v60, 0xff800000, v119
  v_add_f32 v103, v103, v60
  v_xor_b32 v60, 0xff800000, v120
  v_add_f32 v104, v104, v60
  v_xor_b32 v60, 0xff800000, v121
  v_add_f32 v105, v105, v60
  v_xor_b32 v60, 0xff800000, v122
  v_add_f32 v106, v106, v60
  v_xor_b32 v60, 0xff800000, v123
  v_add_f32 v107, v107, v60
  v_xor_b32 v60, 0xff800000, v124
  v_add_f32 v108, v108, v60
  v_xor_b32 v60, 0xff800000, v125
  v_add_f32 v109, v109, v60
  v_xor_b32 v60, 0xff800000, v126
  v_add_f32 v110, v110, v60
  v_xor_b32 v60, 0xff800000, v127
  v_add_f32 v111, v111, v60
SF0B_M4:
  s_cmp_eq_u32 s64, 8
  s_cbranch_scc0 SF0B_M8
  v_add_f32 v96, v96, v112
  v_add_f32 v97, v97, v113
  v_add_f32 v98, v98, v114
  v_add_f32 v99, v99, v115
  v_add_f32 v100, v100, v116
  v_add_f32 v101, v101, v117
  v_add_f32 v102, v102, v118
  v_add_f32 v103, v103, v119
  v_add_f32 v104, v104, v120
  v_add_f32 v105, v105, v121
  v_add_f32 v106, v106, v122
  v_add_f32 v107, v107, v123
  v_add_f32 v108, v108, v124
  v_add_f32 v109, v109, v125
  v_add_f32 v110, v110, v126
  v_add_f32 v111, v111, v127
SF0B_M8:
  ds_read_b64_tr_b16 v[192:193], v62 offset:0
  ds_read_b64_tr_b16 v[194:195], v62 offset:128
  ds_read_b64_tr_b16 v[196:197], v62 offset:256
  ds_read_b64_tr_b16 v[198:199], v62 offset:384
  v_sub_f32 v96, v96, v63
  v_sub_f32 v97, v97, v63
  v_sub_f32 v98, v98, v63
  v_sub_f32 v99, v99, v63
  v_sub_f32 v100, v100, v63
  v_sub_f32 v101, v101, v63
  v_sub_f32 v102, v102, v63
  v_sub_f32 v103, v103, v63
  v_sub_f32 v104, v104, v63
  v_sub_f32 v105, v105, v63
  v_sub_f32 v106, v106, v63
  v_sub_f32 v107, v107, v63
  v_sub_f32 v108, v108, v63
  v_sub_f32 v109, v109, v63
  v_sub_f32 v110, v110, v63
  v_sub_f32 v111, v111, v63
  v_exp_f32 v96, v96
  v_exp_f32 v97, v97
  v_exp_f32 v98, v98
  v_exp_f32 v99, v99
  v_exp_f32 v100, v100
  v_exp_f32 v101, v101
  v_exp_f32 v102, v102
  v_exp_f32 v103, v103
  v_exp_f32 v104, v104
  v_exp_f32 v105, v105
  v_exp_f32 v106, v106
  v_exp_f32 v107, v107
  v_exp_f32 v108, v108
  v_exp_f32 v109, v109
  v_exp_f32 v110, v110
  v_exp_f32 v111, v111
  v_cvt_pk_bf16_f32 v128, v96, v97
  v_cvt_pk_bf16_f32 v129, v98, v99
  v_cvt_pk_bf16_f32 v130, v100, v101
  v_cvt_pk_bf16_f32 v131, v102, v103
  v_cvt_pk_bf16_f32 v132, v104, v105
  v_cvt_pk_bf16_f32 v133, v106, v107
  v_cvt_pk_bf16_f32 v134, v108, v109
  v_cvt_pk_bf16_f32 v135, v110, v111
  s_waitcnt lgkmcnt(0)
  s_nop 1
  v_mfma_f32_32x32x16_bf16 v[144:159], v[192:195], v[128:131], v[144:159]
  v_mfma_f32_32x32x16_bf16 v[144:159], v[196:199], v[132:135], v[144:159]
  s_nop 15
SF0B_N:
  s_add_u32 s64, s64, 1
  s_cmp_lt_u32 s64, 9
  s_cbranch_scc1 SF0B
  v_mov_b32 v63, 0xff800000
  s_mov_b32 s64, 0
SF1A:
  s_cmp_lt_u32 s64, 4
  s_cbranch_scc0 SF1A_B
  s_cmp_ge_u32 s12, 1
  s_cbranch_scc0 SF1A_N
  s_add_u32 s65, s64, 8
  s_sub_u32 s65, s65, s3
  s_branch SF1A_C
SF1A_B:
  s_sub_u32 s65, s64, 4
  s_add_u32 s6, s65, s3
  s_cmp_ge_u32 s6, 4
  s_cbranch_scc1 SF1A_C
  s_cmp_ge_u32 s12, 2
  s_cbranch_scc0 SF1A_N
SF1A_C:
  s_lshl_b32 s65, s65, 9
  v_add_u32 v60, s65, v5
  v_add_u32 v61, s65, v6
  v_add_u32 v62, s65, v8
  ds_read_b128 v[176:179], v60
  ds_read_b128 v[180:183], v61
  s_waitcnt lgkmcnt(0)
  v_mfma_f32_32x32x16_bf16 v[96:111], v[176:179], v[44:47], 0
  v_mfma_f32_32x32x16_bf16 v[96:111], v[180:183], v[50:53], v[96:111]
  s_nop 15
  s_cmp_eq_u32 s64, 4
  s_cbranch_scc0 SF1A_M4
  v_xor_b32 v60, 0xff800000, v112
  v_add_f32 v96, v96, v60
  v_xor_b32 v60, 0xff800000, v113
  v_add_f32 v97, v97, v60
  v_xor_b32 v60, 0xff800000, v114
  v_add_f32 v98, v98, v60
  v_xor_b32 v60, 0xff800000, v115
  v_add_f32 v99, v99, v60
  v_xor_b32 v60, 0xff800000, v116
  v_add_f32 v100, v100, v60
  v_xor_b32 v60, 0xff800000, v117
  v_add_f32 v101, v101, v60
  v_xor_b32 v60, 0xff800000, v118
  v_add_f32 v102, v102, v60
  v_xor_b32 v60, 0xff800000, v119
  v_add_f32 v103, v103, v60
  v_xor_b32 v60, 0xff800000, v120
  v_add_f32 v104, v104, v60
  v_xor_b32 v60, 0xff800000, v121
  v_add_f32 v105, v105, v60
  v_xor_b32 v60, 0xff800000, v122
  v_add_f32 v106, v106, v60
  v_xor_b32 v60, 0xff800000, v123
  v_add_f32 v107, v107, v60
  v_xor_b32 v60, 0xff800000, v124
  v_add_f32 v108, v108, v60
  v_xor_b32 v60, 0xff800000, v125
  v_add_f32 v109, v109, v60
  v_xor_b32 v60, 0xff800000, v126
  v_add_f32 v110, v110, v60
  v_xor_b32 v60, 0xff800000, v127
  v_add_f32 v111, v111, v60
SF1A_M4:
  s_cmp_eq_u32 s64, 8
  s_cbranch_scc0 SF1A_M8
  v_add_f32 v96, v96, v112
  v_add_f32 v97, v97, v113
  v_add_f32 v98, v98, v114
  v_add_f32 v99, v99, v115
  v_add_f32 v100, v100, v116
  v_add_f32 v101, v101, v117
  v_add_f32 v102, v102, v118
  v_add_f32 v103, v103, v119
  v_add_f32 v104, v104, v120
  v_add_f32 v105, v105, v121
  v_add_f32 v106, v106, v122
  v_add_f32 v107, v107, v123
  v_add_f32 v108, v108, v124
  v_add_f32 v109, v109, v125
  v_add_f32 v110, v110, v126
  v_add_f32 v111, v111, v127
SF1A_M8:
  v_max3_f32 v63, v63, v96, v97
  v_max3_f32 v63, v63, v98, v99
  v_max3_f32 v63, v63, v100, v101
  v_max3_f32 v63, v63, v102, v103
  v_max3_f32 v63, v63, v104, v105
  v_max3_f32 v63, v63, v106, v107
  v_max3_f32 v63, v63, v108, v109
  v_max3_f32 v63, v63, v110, v111
SF1A_N:
  s_add_u32 s64, s64, 1
  s_cmp_lt_u32 s64, 9
  s_cbranch_scc1 SF1A
  v_mov_b32 v60, v63
  s_nop 1
  v_permlane32_swap_b32 v60, v63
  s_nop 1
  v_max_f32 v63, v60, v63
  v_mov_b32 v160, 0
  v_mov_b32 v161, 0
  v_mov_b32 v162, 0
  v_mov_b32 v163, 0
  v_mov_b32 v164, 0
  v_mov_b32 v165, 0
  v_mov_b32 v166, 0
  v_mov_b32 v167, 0
  v_mov_b32 v168, 0
  v_mov_b32 v169, 0
  v_mov_b32 v170, 0
  v_mov_b32 v171, 0
  v_mov_b32 v172, 0
  v_mov_b32 v173, 0
  v_mov_b32 v174, 0
  v_mov_b32 v175, 0
  s_mov_b32 s64, 0
SF1B:
  s_cmp_lt_u32 s64, 4
  s_cbranch_scc0 SF1B_B
  s_cmp_ge_u32 s12, 1
  s_cbranch_scc0 SF1B_N
  s_add_u32 s65, s64, 8
  s_sub_u32 s65, s65, s3
  s_branch SF1B_C
SF1B_B:
  s_sub_u32 s65, s64, 4
  s_add_u32 s6, s65, s3
  s_cmp_ge_u32 s6, 4
  s_cbranch_scc1 SF1B_C
  s_cmp_ge_u32 s12, 2
  s_cbranch_scc0 SF1B_N
SF1B_C:
  s_lshl_b32 s65, s65, 9
  v_add_u32 v60, s65, v5
  v_add_u32 v61, s65, v6
  v_add_u32 v62, s65, v8
  ds_read_b128 v[176:179], v60
  ds_read_b128 v[180:183], v61
  s_waitcnt lgkmcnt(0)
  v_mfma_f32_32x32x16_bf16 v[96:111], v[176:179], v[44:47], 0
  v_mfma_f32_32x32x16_bf16 v[96:111], v[180:183], v[50:53], v[96:111]
  s_nop 15
  s_cmp_eq_u32 s64, 4
  s_cbranch_scc0 SF1B_M4
  v_xor_b32 v60, 0xff800000, v112
  v_add_f32 v96, v96, v60
  v_xor_b32 v60, 0xff800000, v113
  v_add_f32 v97, v97, v60
  v_xor_b32 v60, 0xff800000, v114
  v_add_f32 v98, v98, v60
  v_xor_b32 v60, 0xff800000, v115
  v_add_f32 v99, v99, v60
  v_xor_b32 v60, 0xff800000, v116
  v_add_f32 v100, v100, v60
  v_xor_b32 v60, 0xff800000, v117
  v_add_f32 v101, v101, v60
  v_xor_b32 v60, 0xff800000, v118
  v_add_f32 v102, v102, v60
  v_xor_b32 v60, 0xff800000, v119
  v_add_f32 v103, v103, v60
  v_xor_b32 v60, 0xff800000, v120
  v_add_f32 v104, v104, v60
  v_xor_b32 v60, 0xff800000, v121
  v_add_f32 v105, v105, v60
  v_xor_b32 v60, 0xff800000, v122
  v_add_f32 v106, v106, v60
  v_xor_b32 v60, 0xff800000, v123
  v_add_f32 v107, v107, v60
  v_xor_b32 v60, 0xff800000, v124
  v_add_f32 v108, v108, v60
  v_xor_b32 v60, 0xff800000, v125
  v_add_f32 v109, v109, v60
  v_xor_b32 v60, 0xff800000, v126
  v_add_f32 v110, v110, v60
  v_xor_b32 v60, 0xff800000, v127
  v_add_f32 v111, v111, v60
SF1B_M4:
  s_cmp_eq_u32 s64, 8
  s_cbranch_scc0 SF1B_M8
  v_add_f32 v96, v96, v112
  v_add_f32 v97, v97, v113
  v_add_f32 v98, v98, v114
  v_add_f32 v99, v99, v115
  v_add_f32 v100, v100, v116
  v_add_f32 v101, v101, v117
  v_add_f32 v102, v102, v118
  v_add_f32 v103, v103, v119
  v_add_f32 v104, v104, v120
  v_add_f32 v105, v105, v121
  v_add_f32 v106, v106, v122
  v_add_f32 v107, v107, v123
  v_add_f32 v108, v108, v124
  v_add_f32 v109, v109, v125
  v_add_f32 v110, v110, v126
  v_add_f32 v111, v111, v127
SF1B_M8:
  ds_read_b64_tr_b16 v[192:193], v62 offset:0
  ds_read_b64_tr_b16 v[194:195], v62 offset:128
  ds_read_b64_tr_b16 v[196:197], v62 offset:256
  ds_read_b64_tr_b16 v[198:199], v62 offset:384
  v_sub_f32 v96, v96, v63
  v_sub_f32 v97, v97, v63
  v_sub_f32 v98, v98, v63
  v_sub_f32 v99, v99, v63
  v_sub_f32 v100, v100, v63
  v_sub_f32 v101, v101, v63
  v_sub_f32 v102, v102, v63
  v_sub_f32 v103, v103, v63
  v_sub_f32 v104, v104, v63
  v_sub_f32 v105, v105, v63
  v_sub_f32 v106, v106, v63
  v_sub_f32 v107, v107, v63
  v_sub_f32 v108, v108, v63
  v_sub_f32 v109, v109, v63
  v_sub_f32 v110, v110, v63
  v_sub_f32 v111, v111, v63
  v_exp_f32 v96, v96
  v_exp_f32 v97, v97
  v_exp_f32 v98, v98
  v_exp_f32 v99, v99
  v_exp_f32 v100, v100
  v_exp_f32 v101, v101
  v_exp_f32 v102, v102
  v_exp_f32 v103, v103
  v_exp_f32 v104, v104
  v_exp_f32 v105, v105
  v_exp_f32 v106, v106
  v_exp_f32 v107, v107
  v_exp_f32 v108, v108
  v_exp_f32 v109, v109
  v_exp_f32 v110, v110
  v_exp_f32 v111, v111
  v_cvt_pk_bf16_f32 v128, v96, v97
  v_cvt_pk_bf16_f32 v129, v98, v99
  v_cvt_pk_bf16_f32 v130, v100, v101
  v_cvt_pk_bf16_f32 v131, v102, v103
  v_cvt_pk_bf16_f32 v132, v104, v105
  v_cvt_pk_bf16_f32 v133, v106, v107
  v_cvt_pk_bf16_f32 v134, v108, v109
  v_cvt_pk_bf16_f32 v135, v110, v111
  s_waitcnt lgkmcnt(0)
  s_nop 1
  v_mfma_f32_32x32x16_bf16 v[160:175], v[192:195], v[128:131], v[160:175]
  v_mfma_f32_32x32x16_bf16 v[160:175], v[196:199], v[132:135], v[160:175]
  s_nop 15
SF1B_N:
  s_add_u32 s64, s64, 1
  s_cmp_lt_u32 s64, 9
  s_cbranch_scc1 SF1B
  s_branch L_SAFE_DONE
SL_fo:
  s_mov_b32 s0, 0
SLL_fo:
  s_sleep 1
  buffer_load_dword v15, v58, s[48:51], 0 offen sc1
  s_add_u32 s0, s0, 1
  s_waitcnt vmcnt(0)
  v_cmp_gt_u32 vcc, 4, v15
  s_cbranch_vccz OK_fo
  s_cmp_lt_u32 s0, 0x40000
  s_cbranch_scc1 SLL_fo
  s_branch OK_fo
SL_rdyg:
  s_mov_b32 s0, 0
SLL_rdyg:
  s_sleep 1
  buffer_load_dword v15, off, s[60:63], 0 sc1
  s_add_u32 s0, s0, 1
  s_waitcnt vmcnt(0)
  v_cmp_gt_u32 vcc, 32, v15
  s_cbranch_vccz OK_rdyg
  s_cmp_lt_u32 s0, 0x40000
  s_cbranch_scc1 SLL_rdyg
  s_branch OK_rdyg
L_CODE_END:
.section .rodata,"a"
.p2align 6
.amdhsa_kernel gated_mix__sliding_block__dense_activation_silu__prompt_kernel
  .amdhsa_next_free_vgpr 512
  .amdhsa_next_free_sgpr 102
  .amdhsa_accum_offset 256
  .amdhsa_group_segment_fixed_size 0
  .amdhsa_kernarg_size 80
  .amdhsa_user_sgpr_count 2
  .amdhsa_user_sgpr_kernarg_segment_ptr 1
  .amdhsa_system_sgpr_workgroup_id_x 1
.end_amdhsa_kernel
```
